```python
import torch

def _softmax(x, axis=-1):
    return torch.softmax(x, dim=axis)
def _gelu(x):
    return torch.nn.functional.gelu(x, approximate="tanh")
def _silu(x):
    return torch.nn.functional.silu(x)
def _sigmoid(x):
    return torch.sigmoid(x)
def _layernorm(x, axis=-1, eps=1e-5):
    m = x.mean(dim=axis, keepdim=True)
    v = x.var(dim=axis, keepdim=True, unbiased=False)
    return (x - m) / torch.sqrt(v + eps)
def _scatter_add(tgt, idx, src, axis=0):
    return tgt.clone().index_add_(axis, idx, src)
def _segment_sum(src, seg, n):
    out = torch.zeros((n,) + src.shape[1:], dtype=src.dtype)
    return out.index_add_(0, seg, src)
def _pad(x, pw):
    flat = tuple(v for pair in reversed(pw) for v in pair)
    return torch.nn.functional.pad(x, flat)

kernel_name = 'standalone__mha_softmax__near_ridge'

def setup_inputs():

    _w = (lambda a: (lambda t: t.to(torch.bfloat16) if t.is_floating_point() else t)(torch.as_tensor(a)))
    B, H, Sq, Sk, D = 8, 32, 496, 512, 128
    return {
        "q": _w((lambda *s: torch.randn(*s, dtype=torch.bfloat16) * 0.8)(B, H, Sq, D)),
        "k": _w((lambda *s: torch.randn(*s, dtype=torch.bfloat16) * 0.8)(B, H, Sk, D)),
        "v": _w((lambda *s: torch.randn(*s, dtype=torch.bfloat16) * 0.05)(B, H, Sk, D)),
    }

def reference(q, k, v):
    scale = q.shape[-1] ** -0.5
    scores = torch.einsum("bhqd,bhkd->bhqk", q, k) * scale
    p = _softmax(scores, axis=-1)
    return torch.einsum("bhqk,bhkd->bhqd", p, v)
```

```asm
; @launch grid=(256,1,1) block=(256,1,1) lds=163840
.amdgcn_target "amdgcn-amd-amdhsa--gfx950"
.text
.globl standalone__mha_softmax__near_ridge_kernel
.p2align 8
.type standalone__mha_softmax__near_ridge_kernel,@function
standalone__mha_softmax__near_ridge_kernel:
    s_cmp_ge_u32 s2, 256
    s_cbranch_scc1 L_end
    s_load_dwordx4 s[28:31], s[0:1], 0
    s_load_dwordx4 s[32:35], s[0:1], 16
    v_lshrrev_b32 v1, 6, v0
    v_lshlrev_b32 v252, 7, v0
    v_and_b32 v0, 63, v0
    v_readfirstlane_b32 s20, v1
    s_getpc_b64 s[44:45]
L_w:
    v_min_u32 v252, L_end-L_w, v252
    global_load_dword v253, v252, s[44:45]
    v_add_u32 v252, 32768, v252
    v_min_u32 v252, L_end-L_w, v252
    global_load_dword v253, v252, s[44:45]
    v_lshrrev_b32 v2, 3, v0
    v_lshl_add_u32 v2, v1, 3, v2
    v_lshlrev_b32 v2, 8, v2
    v_lshrrev_b32 v3, 4, v0
    v_and_b32 v4, 1, v1
    v_lshl_add_u32 v4, v3, 1, v4
    v_and_b32 v5, 7, v0
    v_xor_b32 v4, v4, v5
    v_lshl_add_u32 v244, v4, 4, v2
    v_xor_b32 v249, 16, v244
    s_mul_i32 s36, s2, 126976
    s_lshl_b32 s37, s2, 17
    s_lshl_b32 s21, s20, 10
    s_and_b32 s26, s20, 1
    s_lshl_b32 s26, s26, 10
    s_mul_i32 s27, s20, 6144
    s_lshl_b32 s25, s20, 13
    s_add_u32 s25, s25, 131072
    s_sub_u32 s38, s25, 32768
    s_mov_b32 s22, 1040356334
    s_mov_b32 s24, 0
    s_waitcnt lgkmcnt(0)
    s_add_u32 s4, s28, s36
    s_addc_u32 s5, s29, 0
    s_mov_b32 s6, 126976
    s_mov_b32 s7, 0x20000
    s_add_u32 s8, s30, s37
    s_addc_u32 s9, s31, 0
    s_mov_b32 s10, 131072
    s_mov_b32 s11, 0x20000
    s_add_u32 s12, s32, s37
    s_addc_u32 s13, s33, 0
    s_mov_b32 s14, 131072
    s_mov_b32 s15, 0x20000
    s_add_u32 s16, s34, s36
    s_addc_u32 s17, s35, 0
    s_mov_b32 s18, 126976
    s_mov_b32 s19, 0x20000
    s_xor_b32 s39, s26, 0
    s_lshl_b32 s23, s39, 1
    s_add_u32 s23, s23, s27
    s_add_u32 s23, s23, 0
    s_add_u32 s39, s39, s25
    s_add_u32 m0, s39, 0
    s_nop 0
    buffer_load_dwordx4 v244, s[4:7], s23 offen offset:0 nt lds
    s_add_u32 m0, s39, 3968
    s_nop 0
    buffer_load_dwordx4 v244, s[4:7], s23 offen offset:128 nt lds
    s_xor_b32 s39, s26, 2048
    s_lshl_b32 s23, s39, 1
    s_add_u32 s23, s23, s27
    s_add_u32 s23, s23, 0
    s_add_u32 s39, s39, s25
    s_add_u32 m0, s39, 0
    s_nop 0
    buffer_load_dwordx4 v244, s[4:7], s23 offen offset:0 nt lds
    s_add_u32 m0, s39, 3968
    s_nop 0
    buffer_load_dwordx4 v244, s[4:7], s23 offen offset:128 nt lds
    s_xor_b32 s39, s26, 1024
    s_lshl_b32 s23, s39, 1
    s_add_u32 s23, s23, s27
    s_add_u32 s23, s23, 0
    s_add_u32 s39, s39, s25
    s_add_u32 m0, s39, 0
    s_nop 0
    buffer_load_dwordx4 v249, s[4:7], s23 offen offset:0 nt lds
    s_add_u32 m0, s39, 3968
    s_nop 0
    buffer_load_dwordx4 v249, s[4:7], s23 offen offset:128 nt lds
    s_xor_b32 s39, s26, 3072
    s_lshl_b32 s23, s39, 1
    s_add_u32 s23, s23, s27
    s_add_u32 s23, s23, 0
    s_add_u32 s39, s39, s25
    s_add_u32 m0, s39, 0
    s_nop 0
    buffer_load_dwordx4 v249, s[4:7], s23 offen offset:0 nt lds
    s_add_u32 m0, s39, 3968
    s_nop 0
    buffer_load_dwordx4 v249, s[4:7], s23 offen offset:128 nt lds
    s_add_u32 m0, s21, 0
    s_mov_b32 s23, 0
    buffer_load_dwordx4 v244, s[8:11], s23 offen offset:0 nt lds
    s_add_u32 m0, s21, 3968
    s_nop 0
    buffer_load_dwordx4 v244, s[8:11], s23 offen offset:128 nt lds
    s_add_u32 m0, s21, 8192
    s_nop 0
    buffer_load_dwordx4 v244, s[12:15], s23 offen offset:0 nt lds
    s_add_u32 m0, s21, 12160
    s_nop 0
    buffer_load_dwordx4 v244, s[12:15], s23 offen offset:128 nt lds
    s_xor_b32 s39, s26, 0
    s_lshl_b32 s23, s39, 1
    s_add_u32 s23, s23, s27
    s_add_u32 s23, s23, 32768
    s_add_u32 s39, s39, s38
    s_add_u32 m0, s39, 0
    s_nop 0
    buffer_load_dwordx4 v244, s[4:7], s23 offen offset:0 nt lds
    s_add_u32 m0, s39, 3968
    s_nop 0
    buffer_load_dwordx4 v244, s[4:7], s23 offen offset:128 nt lds
    s_xor_b32 s39, s26, 2048
    s_lshl_b32 s23, s39, 1
    s_add_u32 s23, s23, s27
    s_add_u32 s23, s23, 32768
    s_add_u32 s39, s39, s38
    s_add_u32 m0, s39, 0
    s_nop 0
    buffer_load_dwordx4 v244, s[4:7], s23 offen offset:0 nt lds
    s_add_u32 m0, s39, 3968
    s_nop 0
    buffer_load_dwordx4 v244, s[4:7], s23 offen offset:128 nt lds
    s_xor_b32 s39, s26, 1024
    s_lshl_b32 s23, s39, 1
    s_add_u32 s23, s23, s27
    s_add_u32 s23, s23, 32768
    s_add_u32 s39, s39, s38
    s_add_u32 m0, s39, 0
    s_nop 0
    buffer_load_dwordx4 v249, s[4:7], s23 offen offset:0 nt lds
    s_add_u32 m0, s39, 3968
    s_nop 0
    buffer_load_dwordx4 v249, s[4:7], s23 offen offset:128 nt lds
    s_xor_b32 s39, s26, 3072
    s_lshl_b32 s23, s39, 1
    s_add_u32 s23, s23, s27
    s_add_u32 s23, s23, 32768
    s_add_u32 s39, s39, s38
    s_add_u32 m0, s39, 0
    s_nop 0
    buffer_load_dwordx4 v249, s[4:7], s23 offen offset:0 nt lds
    s_add_u32 m0, s39, 3968
    s_nop 0
    buffer_load_dwordx4 v249, s[4:7], s23 offen offset:128 nt lds
    v_and_b32 v2, 15, v0
    v_lshrrev_b32 v3, 4, v0
    v_bfe_u32 v4, v2, 1, 2
    v_xor_b32 v4, v4, v3
    v_lshlrev_b32 v4, 1, v4
    v_lshrrev_b32 v5, 3, v2
    v_or_b32 v4, v4, v5
    v_lshlrev_b32 v4, 4, v4
    v_lshl_add_u32 v4, v2, 7, v4
    v_xor_b32 v250, 0, v4
    v_mov_b32 v224, v250
    v_add_u32 v250, s38, v250
    v_xor_b32 v251, 16, v4
    v_mov_b32 v225, v251
    v_add_u32 v251, s38, v251
    v_lshrrev_b32 v4, 2, v0
    v_lshlrev_b32 v5, 7, v4
    v_bfe_u32 v4, v0, 3, 2
    v_lshl_add_u32 v5, v4, 5, v5
    v_lshrrev_b32 v4, 4, v0
    v_xor_b32 v4, v4, v0
    v_and_b32 v4, 2, v4
    v_lshl_add_u32 v5, v4, 3, v5
    v_and_b32 v4, 1, v0
    v_lshl_add_u32 v5, v4, 3, v5
    v_xor_b32 v226, 0, v5
    v_xor_b32 v227, 32, v5
    v_xor_b32 v228, 64, v5
    v_xor_b32 v229, 96, v5
    v_lshrrev_b32 v246, 3, v0
    v_xor_b32 v246, v246, v0
    v_and_b32 v246, 4, v246
    v_lshlrev_b32 v246, 2, v246
    v_lshl_add_u32 v246, v2, 5, v246
    v_bfe_u32 v4, v0, 4, 1
    v_lshl_add_u32 v246, v4, 3, v246
    v_add_u32 v246, s25, v246
    v_bfe_u32 v247, v0, 1, 3
    v_lshlrev_b32 v247, 10, v247
    v_lshl_add_u32 v247, v3, 5, v247
    v_add_u32 v247, s25, v247
    v_lshlrev_b32 v248, 4, v0
    v_and_or_b32 v247, v248, 16, v247
    v_add_u32 v254, s25, v248
    v_xor_b32 v254, s26, v254
    v_xor_b32 v255, 0x400, v254
    s_lshl_b32 s47, s20, 13
    v_mov_b32 v236, 0
    v_mov_b32 v237, 0
    v_mov_b32 v238, 0
    v_mov_b32 v239, 0
    v_mov_b32 v240, 0
    v_mov_b32 v241, 0
    v_mov_b32 v242, 0
    v_mov_b32 v243, 0
    s_waitcnt vmcnt(12)
    ds_read_b128 v[64:67], v250 offset:32768
    ds_read_b128 v[80:83], v250 offset:34816
    ds_read_b128 v[68:71], v251 offset:32768
    ds_read_b128 v[84:87], v251 offset:34816
    ds_read_b128 v[72:75], v250 offset:36864
    ds_read_b128 v[88:91], v250 offset:38912
    ds_read_b128 v[76:79], v251 offset:36864
    ds_read_b128 v[92:95], v251 offset:38912
    s_waitcnt lgkmcnt(7)
    v_lshlrev_b32 v96, 16, v64
    v_and_b32 v97, 0xffff0000, v64
    v_lshlrev_b32 v98, 16, v65
    v_and_b32 v99, 0xffff0000, v65
    v_lshlrev_b32 v100, 16, v66
    v_and_b32 v101, 0xffff0000, v66
    v_lshlrev_b32 v102, 16, v67
    v_and_b32 v103, 0xffff0000, v67
    v_pk_mul_f32 v[96:97], v[96:97], s[22:23] op_sel_hi:[1,0]
    v_pk_mul_f32 v[98:99], v[98:99], s[22:23] op_sel_hi:[1,0]
    v_pk_mul_f32 v[100:101], v[100:101], s[22:23] op_sel_hi:[1,0]
    v_pk_mul_f32 v[102:103], v[102:103], s[22:23] op_sel_hi:[1,0]
    v_cvt_pk_bf16_f32 v64, v96, v97
    v_cvt_pk_bf16_f32 v65, v98, v99
    v_cvt_pk_bf16_f32 v66, v100, v101
    v_cvt_pk_bf16_f32 v67, v102, v103
    v_accvgpr_write_b32 a0, v64
    v_accvgpr_write_b32 a1, v65
    v_accvgpr_write_b32 a2, v66
    v_accvgpr_write_b32 a3, v67
    s_waitcnt lgkmcnt(0)
    v_lshlrev_b32 v96, 16, v80
    v_and_b32 v97, 0xffff0000, v80
    v_lshlrev_b32 v98, 16, v81
    v_and_b32 v99, 0xffff0000, v81
    v_lshlrev_b32 v100, 16, v82
    v_and_b32 v101, 0xffff0000, v82
    v_lshlrev_b32 v102, 16, v83
    v_and_b32 v103, 0xffff0000, v83
    v_pk_mul_f32 v[96:97], v[96:97], s[22:23] op_sel_hi:[1,0]
    v_pk_mul_f32 v[98:99], v[98:99], s[22:23] op_sel_hi:[1,0]
    v_pk_mul_f32 v[100:101], v[100:101], s[22:23] op_sel_hi:[1,0]
    v_pk_mul_f32 v[102:103], v[102:103], s[22:23] op_sel_hi:[1,0]
    v_cvt_pk_bf16_f32 v80, v96, v97
    v_cvt_pk_bf16_f32 v81, v98, v99
    v_cvt_pk_bf16_f32 v82, v100, v101
    v_cvt_pk_bf16_f32 v83, v102, v103
    v_accvgpr_write_b32 a16, v80
    v_accvgpr_write_b32 a17, v81
    v_accvgpr_write_b32 a18, v82
    v_accvgpr_write_b32 a19, v83
    s_add_u32 m0, s21, 16384
    s_mov_b32 s23, 8192
    buffer_load_dwordx4 v244, s[8:11], s23 offen offset:0 nt lds
    v_lshlrev_b32 v96, 16, v68
    v_and_b32 v97, 0xffff0000, v68
    v_lshlrev_b32 v98, 16, v69
    v_and_b32 v99, 0xffff0000, v69
    v_lshlrev_b32 v100, 16, v70
    v_and_b32 v101, 0xffff0000, v70
    v_lshlrev_b32 v102, 16, v71
    v_and_b32 v103, 0xffff0000, v71
    v_pk_mul_f32 v[96:97], v[96:97], s[22:23] op_sel_hi:[1,0]
    v_pk_mul_f32 v[98:99], v[98:99], s[22:23] op_sel_hi:[1,0]
    v_pk_mul_f32 v[100:101], v[100:101], s[22:23] op_sel_hi:[1,0]
    v_pk_mul_f32 v[102:103], v[102:103], s[22:23] op_sel_hi:[1,0]
    v_cvt_pk_bf16_f32 v68, v96, v97
    v_cvt_pk_bf16_f32 v69, v98, v99
    v_cvt_pk_bf16_f32 v70, v100, v101
    v_cvt_pk_bf16_f32 v71, v102, v103
    v_accvgpr_write_b32 a4, v68
    v_accvgpr_write_b32 a5, v69
    v_accvgpr_write_b32 a6, v70
    v_accvgpr_write_b32 a7, v71
    v_lshlrev_b32 v96, 16, v84
    v_and_b32 v97, 0xffff0000, v84
    v_lshlrev_b32 v98, 16, v85
    v_and_b32 v99, 0xffff0000, v85
    v_lshlrev_b32 v100, 16, v86
    v_and_b32 v101, 0xffff0000, v86
    v_lshlrev_b32 v102, 16, v87
    v_and_b32 v103, 0xffff0000, v87
    v_pk_mul_f32 v[96:97], v[96:97], s[22:23] op_sel_hi:[1,0]
    v_pk_mul_f32 v[98:99], v[98:99], s[22:23] op_sel_hi:[1,0]
    v_pk_mul_f32 v[100:101], v[100:101], s[22:23] op_sel_hi:[1,0]
    v_pk_mul_f32 v[102:103], v[102:103], s[22:23] op_sel_hi:[1,0]
    v_cvt_pk_bf16_f32 v84, v96, v97
    v_cvt_pk_bf16_f32 v85, v98, v99
    v_cvt_pk_bf16_f32 v86, v100, v101
    v_cvt_pk_bf16_f32 v87, v102, v103
    v_accvgpr_write_b32 a20, v84
    v_accvgpr_write_b32 a21, v85
    v_accvgpr_write_b32 a22, v86
    v_accvgpr_write_b32 a23, v87
    s_add_u32 m0, s21, 20352
    s_nop 0
    buffer_load_dwordx4 v244, s[8:11], s23 offen offset:128 nt lds
    v_lshlrev_b32 v96, 16, v72
    v_and_b32 v97, 0xffff0000, v72
    v_lshlrev_b32 v98, 16, v73
    v_and_b32 v99, 0xffff0000, v73
    v_lshlrev_b32 v100, 16, v74
    v_and_b32 v101, 0xffff0000, v74
    v_lshlrev_b32 v102, 16, v75
    v_and_b32 v103, 0xffff0000, v75
    v_pk_mul_f32 v[96:97], v[96:97], s[22:23] op_sel_hi:[1,0]
    v_pk_mul_f32 v[98:99], v[98:99], s[22:23] op_sel_hi:[1,0]
    v_pk_mul_f32 v[100:101], v[100:101], s[22:23] op_sel_hi:[1,0]
    v_pk_mul_f32 v[102:103], v[102:103], s[22:23] op_sel_hi:[1,0]
    v_cvt_pk_bf16_f32 v72, v96, v97
    v_cvt_pk_bf16_f32 v73, v98, v99
    v_cvt_pk_bf16_f32 v74, v100, v101
    v_cvt_pk_bf16_f32 v75, v102, v103
    v_accvgpr_write_b32 a8, v72
    v_accvgpr_write_b32 a9, v73
    v_accvgpr_write_b32 a10, v74
    v_accvgpr_write_b32 a11, v75
    v_lshlrev_b32 v96, 16, v88
    v_and_b32 v97, 0xffff0000, v88
    v_lshlrev_b32 v98, 16, v89
    v_and_b32 v99, 0xffff0000, v89
    v_lshlrev_b32 v100, 16, v90
    v_and_b32 v101, 0xffff0000, v90
    v_lshlrev_b32 v102, 16, v91
    v_and_b32 v103, 0xffff0000, v91
    v_pk_mul_f32 v[96:97], v[96:97], s[22:23] op_sel_hi:[1,0]
    v_pk_mul_f32 v[98:99], v[98:99], s[22:23] op_sel_hi:[1,0]
    v_pk_mul_f32 v[100:101], v[100:101], s[22:23] op_sel_hi:[1,0]
    v_pk_mul_f32 v[102:103], v[102:103], s[22:23] op_sel_hi:[1,0]
    v_cvt_pk_bf16_f32 v88, v96, v97
    v_cvt_pk_bf16_f32 v89, v98, v99
    v_cvt_pk_bf16_f32 v90, v100, v101
    v_cvt_pk_bf16_f32 v91, v102, v103
    v_accvgpr_write_b32 a24, v88
    v_accvgpr_write_b32 a25, v89
    v_accvgpr_write_b32 a26, v90
    v_accvgpr_write_b32 a27, v91
    s_add_u32 m0, s21, 24576
    s_nop 0
    buffer_load_dwordx4 v244, s[12:15], s23 offen offset:0 nt lds
    v_lshlrev_b32 v96, 16, v76
    v_and_b32 v97, 0xffff0000, v76
    v_lshlrev_b32 v98, 16, v77
    v_and_b32 v99, 0xffff0000, v77
    v_lshlrev_b32 v100, 16, v78
    v_and_b32 v101, 0xffff0000, v78
    v_lshlrev_b32 v102, 16, v79
    v_and_b32 v103, 0xffff0000, v79
    v_pk_mul_f32 v[96:97], v[96:97], s[22:23] op_sel_hi:[1,0]
    v_pk_mul_f32 v[98:99], v[98:99], s[22:23] op_sel_hi:[1,0]
    v_pk_mul_f32 v[100:101], v[100:101], s[22:23] op_sel_hi:[1,0]
    v_pk_mul_f32 v[102:103], v[102:103], s[22:23] op_sel_hi:[1,0]
    v_cvt_pk_bf16_f32 v76, v96, v97
    v_cvt_pk_bf16_f32 v77, v98, v99
    v_cvt_pk_bf16_f32 v78, v100, v101
    v_cvt_pk_bf16_f32 v79, v102, v103
    v_accvgpr_write_b32 a12, v76
    v_accvgpr_write_b32 a13, v77
    v_accvgpr_write_b32 a14, v78
    v_accvgpr_write_b32 a15, v79
    v_lshlrev_b32 v96, 16, v92
    v_and_b32 v97, 0xffff0000, v92
    v_lshlrev_b32 v98, 16, v93
    v_and_b32 v99, 0xffff0000, v93
    v_lshlrev_b32 v100, 16, v94
    v_and_b32 v101, 0xffff0000, v94
    v_lshlrev_b32 v102, 16, v95
    v_and_b32 v103, 0xffff0000, v95
    v_pk_mul_f32 v[96:97], v[96:97], s[22:23] op_sel_hi:[1,0]
    v_pk_mul_f32 v[98:99], v[98:99], s[22:23] op_sel_hi:[1,0]
    v_pk_mul_f32 v[100:101], v[100:101], s[22:23] op_sel_hi:[1,0]
    v_pk_mul_f32 v[102:103], v[102:103], s[22:23] op_sel_hi:[1,0]
    v_cvt_pk_bf16_f32 v92, v96, v97
    v_cvt_pk_bf16_f32 v93, v98, v99
    v_cvt_pk_bf16_f32 v94, v100, v101
    v_cvt_pk_bf16_f32 v95, v102, v103
    v_accvgpr_write_b32 a28, v92
    v_accvgpr_write_b32 a29, v93
    v_accvgpr_write_b32 a30, v94
    v_accvgpr_write_b32 a31, v95
    s_add_u32 m0, s21, 28544
    s_nop 0
    buffer_load_dwordx4 v244, s[12:15], s23 offen offset:128 nt lds
    s_waitcnt vmcnt(12)
    s_barrier
    ds_read_b128 a[128:131], v224 offset:0
    ds_read_b128 a[132:135], v225 offset:0
    ds_read_b128 a[136:139], v224 offset:4096
    ds_read_b128 a[140:143], v225 offset:4096
    s_waitcnt lgkmcnt(3)
    v_mfma_f32_16x16x32_bf16 v[192:195], a[128:131], a[0:3], 0
    ds_read_b128 a[144:147], v224 offset:2048
    ds_read_b64_tr_b16 a[160:161], v226 offset:8192
    s_add_u32 m0, s21, 32768
    v_mfma_f32_16x16x32_bf16 v[200:203], a[128:131], a[16:19], 0
    ds_read_b64_tr_b16 a[162:163], v226 offset:10240
    s_mov_b32 s23, 16384
    ds_read_b128 a[148:151], v225 offset:2048
    s_waitcnt lgkmcnt(6)
    v_mfma_f32_16x16x32_bf16 v[192:195], a[132:135], a[4:7], v[192:195]
    ds_read_b64_tr_b16 a[164:165], v227 offset:8192
    ds_read_b128 a[152:155], v224 offset:6144
    v_mfma_f32_16x16x32_bf16 v[200:203], a[132:135], a[20:23], v[200:203]
    buffer_load_dwordx4 v244, s[8:11], s23 offen offset:0 nt lds
    s_waitcnt lgkmcnt(6)
    v_mfma_f32_16x16x32_bf16 v[192:195], a[136:139], a[8:11], v[192:195]
    ds_read_b64_tr_b16 a[166:167], v227 offset:10240
    s_add_u32 m0, s21, 36736
    ds_read_b128 a[156:159], v225 offset:6144
    v_mfma_f32_16x16x32_bf16 v[200:203], a[136:139], a[24:27], v[200:203]
    ds_read_b64_tr_b16 a[168:169], v228 offset:8192
    ds_read_b64_tr_b16 a[170:171], v228 offset:10240
    v_mfma_f32_16x16x32_bf16 v[192:195], a[140:143], a[12:15], v[192:195]
    buffer_load_dwordx4 v244, s[8:11], s23 offen offset:128 nt lds
    v_mfma_f32_16x16x32_bf16 v[200:203], a[140:143], a[28:31], v[200:203]
    ds_read_b64_tr_b16 a[172:173], v229 offset:8192
    ds_read_b64_tr_b16 a[174:175], v229 offset:10240
    s_waitcnt lgkmcnt(6)
    v_mfma_f32_16x16x32_bf16 v[196:199], a[144:147], a[0:3], 0
    s_add_u32 m0, s21, 40960
    ds_read_b64_tr_b16 a[176:177], v226 offset:12288
    ds_read_b64_tr_b16 a[178:179], v226 offset:14336
    v_mfma_f32_16x16x32_bf16 v[204:207], a[144:147], a[16:19], 0
    buffer_load_dwordx4 v244, s[12:15], s23 offen offset:0 nt lds
    v_mfma_f32_16x16x32_bf16 v[196:199], a[148:151], a[4:7], v[196:199]
    ds_read_b64_tr_b16 a[180:181], v227 offset:12288
    ds_read_b64_tr_b16 a[182:183], v227 offset:14336
    v_mfma_f32_16x16x32_bf16 v[204:207], a[148:151], a[20:23], v[204:207]
    ds_read_b64_tr_b16 a[184:185], v228 offset:12288
    ds_read_b64_tr_b16 a[186:187], v228 offset:14336
    v_mfma_f32_16x16x32_bf16 v[196:199], a[152:155], a[8:11], v[196:199]
    s_add_u32 m0, s21, 44928
    ds_read_b64_tr_b16 a[188:189], v229 offset:12288
    ds_read_b64_tr_b16 a[190:191], v229 offset:14336
    v_mfma_f32_16x16x32_bf16 v[204:207], a[152:155], a[24:27], v[204:207]
    buffer_load_dwordx4 v244, s[12:15], s23 offen offset:128 nt lds
    s_waitcnt lgkmcnt(6)
    v_mfma_f32_16x16x32_bf16 v[196:199], a[156:159], a[12:15], v[196:199]
    v_mfma_f32_16x16x32_bf16 v[204:207], a[156:159], a[28:31], v[204:207]
    v_max3_f32 v232, v192, v193, v194
    s_nop 5
    v_max3_f32 v232, v232, v195, v196
    v_max3_f32 v232, v232, v197, v198
    v_max3_f32 v232, v232, v199, v200
    v_max3_f32 v232, v232, v201, v202
    v_max3_f32 v232, v232, v203, v204
    v_max3_f32 v232, v232, v205, v206
    v_max_f32 v232, v232, v207
    v_mov_b32 v233, v232
    s_nop 1
    v_permlane32_swap_b32 v233, v232
    v_max_f32 v232, v232, v233
    v_mov_b32 v233, v232
    s_nop 1
    v_permlane16_swap_b32 v233, v232
    v_max_f32 v232, v232, v233
    v_sub_f32 v235, 0, v232
    v_sub_f32 v234, 0, v232
    v_sub_f32 v233, 0, v232
    v_sub_f32 v232, 0, v232
    v_add_f32 v192, v192, v232
    v_add_f32 v193, v193, v232
    v_exp_f32 v192, v192
    v_add_f32 v194, v194, v232
    v_exp_f32 v193, v193
    v_add_f32 v195, v195, v232
    v_exp_f32 v194, v194
    v_add_f32 v236, v236, v192
    v_add_f32 v196, v196, v232
    v_exp_f32 v195, v195
    v_add_f32 v236, v236, v193
    v_cvt_pk_bf16_f32 v192, v192, v193
    v_add_f32 v197, v197, v232
    v_exp_f32 v196, v196
    v_add_f32 v236, v236, v194
    v_add_f32 v198, v198, v232
    v_exp_f32 v197, v197
    v_add_f32 v236, v236, v195
    v_cvt_pk_bf16_f32 v193, v194, v195
    v_add_f32 v199, v199, v232
    v_exp_f32 v198, v198
    v_add_f32 v236, v236, v196
    v_add_f32 v200, v200, v232
    v_exp_f32 v199, v199
    v_add_f32 v236, v236, v197
    v_cvt_pk_bf16_f32 v194, v196, v197
    v_add_f32 v201, v201, v232
    v_exp_f32 v200, v200
    v_add_f32 v236, v236, v198
    v_add_f32 v202, v202, v232
    v_exp_f32 v201, v201
    v_add_f32 v236, v236, v199
    v_cvt_pk_bf16_f32 v195, v198, v199
    v_add_f32 v203, v203, v232
    v_exp_f32 v202, v202
    v_add_f32 v237, v237, v200
    v_add_f32 v204, v204, v232
    v_exp_f32 v203, v203
    v_add_f32 v237, v237, v201
    v_cvt_pk_bf16_f32 v200, v200, v201
    v_add_f32 v205, v205, v232
    v_exp_f32 v204, v204
    v_add_f32 v237, v237, v202
    v_add_f32 v206, v206, v232
    v_exp_f32 v205, v205
    v_add_f32 v237, v237, v203
    v_cvt_pk_bf16_f32 v201, v202, v203
    v_add_f32 v207, v207, v232
    v_exp_f32 v206, v206
    v_add_f32 v237, v237, v204
    v_exp_f32 v207, v207
    v_add_f32 v237, v237, v205
    v_cvt_pk_bf16_f32 v202, v204, v205
    v_add_f32 v237, v237, v206
    v_add_f32 v237, v237, v207
    v_cvt_pk_bf16_f32 v203, v206, v207
    s_waitcnt vmcnt(8)
    ds_read_b128 v[64:67], v250 offset:0
    ds_read_b128 v[80:83], v250 offset:2048
    ds_read_b128 v[68:71], v251 offset:0
    ds_read_b128 v[84:87], v251 offset:2048
    ds_read_b128 v[72:75], v250 offset:4096
    ds_read_b128 v[88:91], v250 offset:6144
    ds_read_b128 v[76:79], v251 offset:4096
    ds_read_b128 v[92:95], v251 offset:6144
    s_waitcnt lgkmcnt(7)
    v_lshlrev_b32 v96, 16, v64
    v_and_b32 v97, 0xffff0000, v64
    v_lshlrev_b32 v98, 16, v65
    v_and_b32 v99, 0xffff0000, v65
    v_lshlrev_b32 v100, 16, v66
    v_and_b32 v101, 0xffff0000, v66
    v_lshlrev_b32 v102, 16, v67
    v_and_b32 v103, 0xffff0000, v67
    v_pk_mul_f32 v[96:97], v[96:97], s[22:23] op_sel_hi:[1,0]
    v_pk_mul_f32 v[98:99], v[98:99], s[22:23] op_sel_hi:[1,0]
    v_pk_mul_f32 v[100:101], v[100:101], s[22:23] op_sel_hi:[1,0]
    v_pk_mul_f32 v[102:103], v[102:103], s[22:23] op_sel_hi:[1,0]
    v_cvt_pk_bf16_f32 v64, v96, v97
    v_cvt_pk_bf16_f32 v65, v98, v99
    v_cvt_pk_bf16_f32 v66, v100, v101
    v_cvt_pk_bf16_f32 v67, v102, v103
    v_accvgpr_write_b32 a32, v64
    v_accvgpr_write_b32 a33, v65
    v_accvgpr_write_b32 a34, v66
    v_accvgpr_write_b32 a35, v67
    s_waitcnt lgkmcnt(0)
    v_lshlrev_b32 v96, 16, v80
    v_and_b32 v97, 0xffff0000, v80
    v_lshlrev_b32 v98, 16, v81
    v_and_b32 v99, 0xffff0000, v81
    v_lshlrev_b32 v100, 16, v82
    v_and_b32 v101, 0xffff0000, v82
    v_lshlrev_b32 v102, 16, v83
    v_and_b32 v103, 0xffff0000, v83
    v_pk_mul_f32 v[96:97], v[96:97], s[22:23] op_sel_hi:[1,0]
    v_pk_mul_f32 v[98:99], v[98:99], s[22:23] op_sel_hi:[1,0]
    v_pk_mul_f32 v[100:101], v[100:101], s[22:23] op_sel_hi:[1,0]
    v_pk_mul_f32 v[102:103], v[102:103], s[22:23] op_sel_hi:[1,0]
    v_cvt_pk_bf16_f32 v80, v96, v97
    v_cvt_pk_bf16_f32 v81, v98, v99
    v_cvt_pk_bf16_f32 v82, v100, v101
    v_cvt_pk_bf16_f32 v83, v102, v103
    v_accvgpr_write_b32 a48, v80
    v_accvgpr_write_b32 a49, v81
    v_accvgpr_write_b32 a50, v82
    v_accvgpr_write_b32 a51, v83
    v_mfma_f32_16x16x32_bf16 v[208:211], a[128:131], a[32:35], v[232:235]
    s_xor_b32 s39, s26, 0
    v_mfma_f32_16x16x32_bf16 v[216:219], a[128:131], a[48:51], v[232:235]
    v_lshlrev_b32 v96, 16, v68
    v_and_b32 v97, 0xffff0000, v68
    v_lshlrev_b32 v98, 16, v69
    v_and_b32 v99, 0xffff0000, v69
    v_lshlrev_b32 v100, 16, v70
    v_and_b32 v101, 0xffff0000, v70
    v_lshlrev_b32 v102, 16, v71
    v_and_b32 v103, 0xffff0000, v71
    v_pk_mul_f32 v[96:97], v[96:97], s[22:23] op_sel_hi:[1,0]
    v_pk_mul_f32 v[98:99], v[98:99], s[22:23] op_sel_hi:[1,0]
    v_pk_mul_f32 v[100:101], v[100:101], s[22:23] op_sel_hi:[1,0]
    v_pk_mul_f32 v[102:103], v[102:103], s[22:23] op_sel_hi:[1,0]
    v_cvt_pk_bf16_f32 v68, v96, v97
    v_cvt_pk_bf16_f32 v69, v98, v99
    v_cvt_pk_bf16_f32 v70, v100, v101
    v_cvt_pk_bf16_f32 v71, v102, v103
    v_accvgpr_write_b32 a36, v68
    v_accvgpr_write_b32 a37, v69
    v_accvgpr_write_b32 a38, v70
    v_accvgpr_write_b32 a39, v71
    v_lshlrev_b32 v96, 16, v84
    v_and_b32 v97, 0xffff0000, v84
    v_lshlrev_b32 v98, 16, v85
    v_and_b32 v99, 0xffff0000, v85
    v_lshlrev_b32 v100, 16, v86
    v_and_b32 v101, 0xffff0000, v86
    v_lshlrev_b32 v102, 16, v87
    v_and_b32 v103, 0xffff0000, v87
    v_pk_mul_f32 v[96:97], v[96:97], s[22:23] op_sel_hi:[1,0]
    v_pk_mul_f32 v[98:99], v[98:99], s[22:23] op_sel_hi:[1,0]
    v_pk_mul_f32 v[100:101], v[100:101], s[22:23] op_sel_hi:[1,0]
    v_pk_mul_f32 v[102:103], v[102:103], s[22:23] op_sel_hi:[1,0]
    v_cvt_pk_bf16_f32 v84, v96, v97
    v_cvt_pk_bf16_f32 v85, v98, v99
    v_cvt_pk_bf16_f32 v86, v100, v101
    v_cvt_pk_bf16_f32 v87, v102, v103
    v_accvgpr_write_b32 a52, v84
    v_accvgpr_write_b32 a53, v85
    v_accvgpr_write_b32 a54, v86
    v_accvgpr_write_b32 a55, v87
    s_lshl_b32 s23, s39, 1
    v_mfma_f32_16x16x32_bf16 v[208:211], a[132:135], a[36:39], v[208:211]
    s_add_u32 s23, s23, s27
    v_mfma_f32_16x16x32_bf16 v[216:219], a[132:135], a[52:55], v[216:219]
    v_lshlrev_b32 v96, 16, v72
    v_and_b32 v97, 0xffff0000, v72
    v_lshlrev_b32 v98, 16, v73
    v_and_b32 v99, 0xffff0000, v73
    v_lshlrev_b32 v100, 16, v74
    v_and_b32 v101, 0xffff0000, v74
    v_lshlrev_b32 v102, 16, v75
    v_and_b32 v103, 0xffff0000, v75
    v_pk_mul_f32 v[96:97], v[96:97], s[22:23] op_sel_hi:[1,0]
    v_pk_mul_f32 v[98:99], v[98:99], s[22:23] op_sel_hi:[1,0]
    v_pk_mul_f32 v[100:101], v[100:101], s[22:23] op_sel_hi:[1,0]
    v_pk_mul_f32 v[102:103], v[102:103], s[22:23] op_sel_hi:[1,0]
    v_cvt_pk_bf16_f32 v72, v96, v97
    v_cvt_pk_bf16_f32 v73, v98, v99
    v_cvt_pk_bf16_f32 v74, v100, v101
    v_cvt_pk_bf16_f32 v75, v102, v103
    v_accvgpr_write_b32 a40, v72
    v_accvgpr_write_b32 a41, v73
    v_accvgpr_write_b32 a42, v74
    v_accvgpr_write_b32 a43, v75
    v_lshlrev_b32 v96, 16, v88
    v_and_b32 v97, 0xffff0000, v88
    v_lshlrev_b32 v98, 16, v89
    v_and_b32 v99, 0xffff0000, v89
    v_lshlrev_b32 v100, 16, v90
    v_and_b32 v101, 0xffff0000, v90
    v_lshlrev_b32 v102, 16, v91
    v_and_b32 v103, 0xffff0000, v91
    v_pk_mul_f32 v[96:97], v[96:97], s[22:23] op_sel_hi:[1,0]
    v_pk_mul_f32 v[98:99], v[98:99], s[22:23] op_sel_hi:[1,0]
    v_pk_mul_f32 v[100:101], v[100:101], s[22:23] op_sel_hi:[1,0]
    v_pk_mul_f32 v[102:103], v[102:103], s[22:23] op_sel_hi:[1,0]
    v_cvt_pk_bf16_f32 v88, v96, v97
    v_cvt_pk_bf16_f32 v89, v98, v99
    v_cvt_pk_bf16_f32 v90, v100, v101
    v_cvt_pk_bf16_f32 v91, v102, v103
    v_accvgpr_write_b32 a56, v88
    v_accvgpr_write_b32 a57, v89
    v_accvgpr_write_b32 a58, v90
    v_accvgpr_write_b32 a59, v91
    s_add_u32 s23, s23, 65536
    v_mfma_f32_16x16x32_bf16 v[208:211], a[136:139], a[40:43], v[208:211]
    buffer_load_dwordx4 a[64:67], v244, s[4:7], s23 offen offset:0 nt
    v_mfma_f32_16x16x32_bf16 v[216:219], a[136:139], a[56:59], v[216:219]
    v_lshlrev_b32 v96, 16, v76
    v_and_b32 v97, 0xffff0000, v76
    v_lshlrev_b32 v98, 16, v77
    v_and_b32 v99, 0xffff0000, v77
    v_lshlrev_b32 v100, 16, v78
    v_and_b32 v101, 0xffff0000, v78
    v_lshlrev_b32 v102, 16, v79
    v_and_b32 v103, 0xffff0000, v79
    v_pk_mul_f32 v[96:97], v[96:97], s[22:23] op_sel_hi:[1,0]
    v_pk_mul_f32 v[98:99], v[98:99], s[22:23] op_sel_hi:[1,0]
    v_pk_mul_f32 v[100:101], v[100:101], s[22:23] op_sel_hi:[1,0]
    v_pk_mul_f32 v[102:103], v[102:103], s[22:23] op_sel_hi:[1,0]
    v_cvt_pk_bf16_f32 v76, v96, v97
    v_cvt_pk_bf16_f32 v77, v98, v99
    v_cvt_pk_bf16_f32 v78, v100, v101
    v_cvt_pk_bf16_f32 v79, v102, v103
    v_accvgpr_write_b32 a44, v76
    v_accvgpr_write_b32 a45, v77
    v_accvgpr_write_b32 a46, v78
    v_accvgpr_write_b32 a47, v79
    v_lshlrev_b32 v96, 16, v92
    v_and_b32 v97, 0xffff0000, v92
    v_lshlrev_b32 v98, 16, v93
    v_and_b32 v99, 0xffff0000, v93
    v_lshlrev_b32 v100, 16, v94
    v_and_b32 v101, 0xffff0000, v94
    v_lshlrev_b32 v102, 16, v95
    v_and_b32 v103, 0xffff0000, v95
    v_pk_mul_f32 v[96:97], v[96:97], s[22:23] op_sel_hi:[1,0]
    v_pk_mul_f32 v[98:99], v[98:99], s[22:23] op_sel_hi:[1,0]
    v_pk_mul_f32 v[100:101], v[100:101], s[22:23] op_sel_hi:[1,0]
    v_pk_mul_f32 v[102:103], v[102:103], s[22:23] op_sel_hi:[1,0]
    v_cvt_pk_bf16_f32 v92, v96, v97
    v_cvt_pk_bf16_f32 v93, v98, v99
    v_cvt_pk_bf16_f32 v94, v100, v101
    v_cvt_pk_bf16_f32 v95, v102, v103
    v_accvgpr_write_b32 a60, v92
    v_accvgpr_write_b32 a61, v93
    v_accvgpr_write_b32 a62, v94
    v_accvgpr_write_b32 a63, v95
    v_mfma_f32_16x16x32_bf16 v[208:211], a[140:143], a[44:47], v[208:211]
    buffer_load_dwordx4 a[68:71], v244, s[4:7], s23 offen offset:128 nt
    v_mfma_f32_16x16x32_bf16 v[216:219], a[140:143], a[60:63], v[216:219]
    v_mfma_f32_16x16x32_bf16 v[0:3], a[160:163], v[192:195], 0
    v_mfma_f32_16x16x32_bf16 v[4:7], a[164:167], v[192:195], 0
    s_xor_b32 s39, s26, 1024
    v_mfma_f32_16x16x32_bf16 v[8:11], a[168:171], v[192:195], 0
    s_lshl_b32 s23, s39, 1
    v_mfma_f32_16x16x32_bf16 v[12:15], a[172:175], v[192:195], 0
    s_add_u32 s23, s23, s27
    v_exp_f32 v208, v208
    v_mfma_f32_16x16x32_bf16 v[16:19], a[176:179], v[192:195], 0
    s_add_u32 s23, s23, 65536
    v_exp_f32 v209, v209
    v_mfma_f32_16x16x32_bf16 v[20:23], a[180:183], v[192:195], 0
    buffer_load_dwordx4 a[72:75], v249, s[4:7], s23 offen offset:0 nt
    v_mfma_f32_16x16x32_bf16 v[24:27], a[184:187], v[192:195], 0
    buffer_load_dwordx4 a[76:79], v249, s[4:7], s23 offen offset:128 nt
    v_mfma_f32_16x16x32_bf16 v[28:31], a[188:191], v[192:195], 0
    s_waitcnt vmcnt(8)
    s_barrier
    v_exp_f32 v210, v210
    v_mfma_f32_16x16x32_bf16 v[212:215], a[144:147], a[32:35], v[232:235]
    v_add_f32 v238, v238, v208
    ds_read_b128 a[128:131], v224 offset:16384
    v_mfma_f32_16x16x32_bf16 v[220:223], a[144:147], a[48:51], v[232:235]
    v_exp_f32 v211, v211
    v_mfma_f32_16x16x32_bf16 v[212:215], a[148:151], a[36:39], v[212:215]
    s_xor_b32 s39, s26, 2048
    v_add_f32 v238, v238, v209
    v_cvt_pk_bf16_f32 v208, v208, v209
    v_mfma_f32_16x16x32_bf16 v[220:223], a[148:151], a[52:55], v[220:223]
    s_lshl_b32 s23, s39, 1
    v_exp_f32 v216, v216
    v_mfma_f32_16x16x32_bf16 v[212:215], a[152:155], a[40:43], v[212:215]
    s_add_u32 s23, s23, s27
    v_add_f32 v238, v238, v210
    ds_read_b128 a[132:135], v225 offset:16384
    v_mfma_f32_16x16x32_bf16 v[220:223], a[152:155], a[56:59], v[220:223]
    s_add_u32 s23, s23, 65536
    v_exp_f32 v217, v217
    v_mfma_f32_16x16x32_bf16 v[212:215], a[156:159], a[44:47], v[212:215]
    buffer_load_dwordx4 a[80:83], v244, s[4:7], s23 offen offset:0 nt
    v_mfma_f32_16x16x32_bf16 v[220:223], a[156:159], a[60:63], v[220:223]
    v_add_f32 v238, v238, v211
    v_cvt_pk_bf16_f32 v209, v210, v211
    v_mfma_f32_16x16x32_bf16 v[32:35], a[160:163], v[200:203], 0
    v_exp_f32 v218, v218
    v_mfma_f32_16x16x32_bf16 v[36:39], a[164:167], v[200:203], 0
    v_add_f32 v239, v239, v216
    ds_read_b128 a[136:139], v224 offset:20480
    v_mfma_f32_16x16x32_bf16 v[40:43], a[168:171], v[200:203], 0
    v_exp_f32 v219, v219
    buffer_load_dwordx4 a[84:87], v244, s[4:7], s23 offen offset:128 nt
    v_mfma_f32_16x16x32_bf16 v[44:47], a[172:175], v[200:203], 0
    v_add_f32 v239, v239, v217
    v_cvt_pk_bf16_f32 v216, v216, v217
    s_xor_b32 s39, s26, 3072
    v_mfma_f32_16x16x32_bf16 v[48:51], a[176:179], v[200:203], 0
    v_exp_f32 v212, v212
    s_lshl_b32 s23, s39, 1
    v_mfma_f32_16x16x32_bf16 v[52:55], a[180:183], v[200:203], 0
    v_add_f32 v239, v239, v218
    s_add_u32 s23, s23, s27
    ds_read_b128 a[140:143], v225 offset:20480
    v_mfma_f32_16x16x32_bf16 v[56:59], a[184:187], v[200:203], 0
    v_exp_f32 v213, v213
    v_add_f32 v239, v239, v219
    s_add_u32 s23, s23, 65536
    v_mfma_f32_16x16x32_bf16 v[60:63], a[188:191], v[200:203], 0
    v_cvt_pk_bf16_f32 v217, v218, v219
    buffer_load_dwordx4 a[88:91], v249, s[4:7], s23 offen offset:0 nt
    s_waitcnt lgkmcnt(1)
    v_mfma_f32_16x16x32_bf16 v[192:195], a[128:131], a[0:3], v[232:235]
    v_exp_f32 v214, v214
    v_add_f32 v238, v238, v212
    v_mfma_f32_16x16x32_bf16 v[200:203], a[128:131], a[16:19], v[232:235]
    v_exp_f32 v215, v215
    v_mfma_f32_16x16x32_bf16 v[192:195], a[132:135], a[4:7], v[192:195]
    v_add_f32 v238, v238, v213
    v_cvt_pk_bf16_f32 v210, v212, v213
    v_mfma_f32_16x16x32_bf16 v[200:203], a[132:135], a[20:23], v[200:203]
    v_exp_f32 v220, v220
    buffer_load_dwordx4 a[92:95], v249, s[4:7], s23 offen offset:128 nt
    v_mfma_f32_16x16x32_bf16 v[192:195], a[136:139], a[8:11], v[192:195]
    v_add_f32 v238, v238, v214
    s_add_u32 m0, s21, 49152
    ds_read_b128 a[144:147], v224 offset:18432
    v_mfma_f32_16x16x32_bf16 v[200:203], a[136:139], a[24:27], v[200:203]
    v_exp_f32 v221, v221
    v_add_f32 v238, v238, v215
    s_mov_b32 s23, 24576
    s_waitcnt lgkmcnt(1)
    v_mfma_f32_16x16x32_bf16 v[192:195], a[140:143], a[12:15], v[192:195]
    v_cvt_pk_bf16_f32 v211, v214, v215
    ds_read_b128 a[148:151], v225 offset:18432
    v_mfma_f32_16x16x32_bf16 v[200:203], a[140:143], a[28:31], v[200:203]
    buffer_load_dwordx4 v244, s[8:11], s23 offen offset:0 nt lds
    v_mfma_f32_16x16x32_bf16 v[64:67], a[160:163], v[208:211], 0
    s_add_u32 m0, s21, 53120
    v_exp_f32 v222, v222
    v_mfma_f32_16x16x32_bf16 v[68:71], a[164:167], v[208:211], 0
    v_add_f32 v239, v239, v220
    ds_read_b128 a[152:155], v224 offset:22528
    v_mfma_f32_16x16x32_bf16 v[72:75], a[168:171], v[208:211], 0
    buffer_load_dwordx4 v244, s[8:11], s23 offen offset:128 nt lds
    v_mfma_f32_16x16x32_bf16 v[76:79], a[172:175], v[208:211], 0
    v_exp_f32 v223, v223
    v_mfma_f32_16x16x32_bf16 v[80:83], a[176:179], v[208:211], 0
    s_add_u32 m0, s21, 57344
    v_add_f32 v239, v239, v221
    v_cvt_pk_bf16_f32 v218, v220, v221
    v_mfma_f32_16x16x32_bf16 v[84:87], a[180:183], v[208:211], 0
    ds_read_b128 a[156:159], v225 offset:22528
    v_add_f32 v239, v239, v222
    v_mfma_f32_16x16x32_bf16 v[88:91], a[184:187], v[208:211], 0
    v_add_f32 v239, v239, v223
    v_cvt_pk_bf16_f32 v219, v222, v223
    v_mfma_f32_16x16x32_bf16 v[92:95], a[188:191], v[208:211], 0
    buffer_load_dwordx4 v244, s[12:15], s23 offen offset:0 nt lds
    s_waitcnt lgkmcnt(1)
    v_mfma_f32_16x16x32_bf16 v[196:199], a[144:147], a[0:3], v[232:235]
    s_add_u32 m0, s21, 61312
    v_exp_f32 v192, v192
    v_mfma_f32_16x16x32_bf16 v[204:207], a[144:147], a[16:19], v[232:235]
    v_exp_f32 v193, v193
    v_mfma_f32_16x16x32_bf16 v[196:199], a[148:151], a[4:7], v[196:199]
    v_exp_f32 v194, v194
    v_add_f32 v236, v236, v192
    v_mfma_f32_16x16x32_bf16 v[204:207], a[148:151], a[20:23], v[204:207]
    buffer_load_dwordx4 v244, s[12:15], s23 offen offset:128 nt lds
    v_exp_f32 v195, v195
    v_mfma_f32_16x16x32_bf16 v[196:199], a[152:155], a[8:11], v[196:199]
    s_add_u32 m0, s21, 65536
    v_add_f32 v236, v236, v193
    v_cvt_pk_bf16_f32 v192, v192, v193
    v_mfma_f32_16x16x32_bf16 v[204:207], a[152:155], a[24:27], v[204:207]
    s_waitcnt lgkmcnt(0)
    s_mov_b32 s23, 32768
    v_exp_f32 v200, v200
    v_mfma_f32_16x16x32_bf16 v[196:199], a[156:159], a[12:15], v[196:199]
    v_add_f32 v236, v236, v194
    v_exp_f32 v201, v201
    v_mfma_f32_16x16x32_bf16 v[204:207], a[156:159], a[28:31], v[204:207]
    v_add_f32 v236, v236, v195
    v_cvt_pk_bf16_f32 v193, v194, v195
    v_mfma_f32_16x16x32_bf16 v[96:99], a[160:163], v[216:219], 0
    v_exp_f32 v202, v202
    v_mfma_f32_16x16x32_bf16 v[100:103], a[164:167], v[216:219], 0
    ds_read_b64_tr_b16 a[160:161], v226 offset:24576
    ds_read_b64_tr_b16 a[162:163], v226 offset:26624
    v_add_f32 v237, v237, v200
    v_mfma_f32_16x16x32_bf16 v[104:107], a[168:171], v[216:219], 0
    ds_read_b64_tr_b16 a[164:165], v227 offset:24576
    v_exp_f32 v203, v203
    v_mfma_f32_16x16x32_bf16 v[108:111], a[172:175], v[216:219], 0
    ds_read_b64_tr_b16 a[166:167], v227 offset:26624
    v_add_f32 v237, v237, v201
    v_cvt_pk_bf16_f32 v200, v200, v201
    v_mfma_f32_16x16x32_bf16 v[112:115], a[176:179], v[216:219], 0
    ds_read_b64_tr_b16 a[168:169], v228 offset:24576
    v_exp_f32 v196, v196
    v_mfma_f32_16x16x32_bf16 v[116:119], a[180:183], v[216:219], 0
    ds_read_b64_tr_b16 a[170:171], v228 offset:26624
    v_add_f32 v237, v237, v202
    v_mfma_f32_16x16x32_bf16 v[120:123], a[184:187], v[216:219], 0
    ds_read_b64_tr_b16 a[172:173], v229 offset:24576
    v_exp_f32 v197, v197
    v_add_f32 v237, v237, v203
    v_mfma_f32_16x16x32_bf16 v[124:127], a[188:191], v[216:219], 0
    ds_read_b64_tr_b16 a[174:175], v229 offset:26624
    buffer_load_dwordx4 v244, s[8:11], s23 offen offset:0 nt lds
    v_cvt_pk_bf16_f32 v201, v202, v203
    v_mfma_f32_16x16x32_bf16 v[208:211], a[128:131], a[32:35], v[232:235]
    s_add_u32 m0, s21, 69504
    ds_read_b64_tr_b16 a[176:177], v226 offset:28672
    v_exp_f32 v198, v198
    v_add_f32 v236, v236, v196
    v_mfma_f32_16x16x32_bf16 v[216:219], a[128:131], a[48:51], v[232:235]
    ds_read_b64_tr_b16 a[178:179], v226 offset:30720
    v_exp_f32 v199, v199
    v_mfma_f32_16x16x32_bf16 v[208:211], a[132:135], a[36:39], v[208:211]
    ds_read_b64_tr_b16 a[180:181], v227 offset:28672
    v_add_f32 v236, v236, v197
    v_cvt_pk_bf16_f32 v194, v196, v197
    v_mfma_f32_16x16x32_bf16 v[216:219], a[132:135], a[52:55], v[216:219]
    ds_read_b64_tr_b16 a[182:183], v227 offset:30720
    v_exp_f32 v204, v204
    v_mfma_f32_16x16x32_bf16 v[208:211], a[136:139], a[40:43], v[208:211]
    ds_read_b64_tr_b16 a[184:185], v228 offset:28672
    v_add_f32 v236, v236, v198
    v_mfma_f32_16x16x32_bf16 v[216:219], a[136:139], a[56:59], v[216:219]
    ds_read_b64_tr_b16 a[186:187], v228 offset:30720
    v_exp_f32 v205, v205
    v_add_f32 v236, v236, v199
    v_mfma_f32_16x16x32_bf16 v[208:211], a[140:143], a[44:47], v[208:211]
    ds_read_b64_tr_b16 a[188:189], v229 offset:28672
    v_cvt_pk_bf16_f32 v195, v198, v199
    v_mfma_f32_16x16x32_bf16 v[216:219], a[140:143], a[60:63], v[216:219]
    s_waitcnt lgkmcnt(4)
    ds_read_b64_tr_b16 a[190:191], v229 offset:30720
    v_mfma_f32_16x16x32_bf16 v[0:3], a[160:163], v[192:195], v[0:3]
    v_exp_f32 v206, v206
    v_mfma_f32_16x16x32_bf16 v[4:7], a[164:167], v[192:195], v[4:7]
    v_add_f32 v237, v237, v204
    v_mfma_f32_16x16x32_bf16 v[8:11], a[168:171], v[192:195], v[8:11]
    buffer_load_dwordx4 v244, s[8:11], s23 offen offset:128 nt lds
    v_mfma_f32_16x16x32_bf16 v[12:15], a[172:175], v[192:195], v[12:15]
    v_exp_f32 v207, v207
    v_mfma_f32_16x16x32_bf16 v[16:19], a[176:179], v[192:195], v[16:19]
    s_waitcnt lgkmcnt(1)
    s_add_u32 m0, s21, 73728
    v_add_f32 v237, v237, v205
    v_cvt_pk_bf16_f32 v202, v204, v205
    v_mfma_f32_16x16x32_bf16 v[20:23], a[180:183], v[192:195], v[20:23]
    v_add_f32 v237, v237, v206
    v_add_f32 v237, v237, v207
    v_mfma_f32_16x16x32_bf16 v[24:27], a[184:187], v[192:195], v[24:27]
    s_waitcnt vmcnt(13) lgkmcnt(0)
    v_accvgpr_read_b32 v230, a64
    v_accvgpr_read_b32 v252, a65
    v_lshlrev_b32 v231, 16, v230
    v_lshlrev_b32 v253, 16, v252
    v_and_b32 v230, 0xffff0000, v230
    v_mfma_f32_16x16x32_bf16 v[28:31], a[188:191], v[192:195], v[28:31]
    s_barrier
    v_and_b32 v252, 0xffff0000, v252
    v_mul_f32 v230, s22, v230
    v_mul_f32 v231, s22, v231
    v_mul_f32 v252, s22, v252
    v_mul_f32 v253, s22, v253
    v_cvt_pk_bf16_f32 v230, v231, v230
    v_cvt_pk_bf16_f32 v203, v206, v207
    v_mfma_f32_16x16x32_bf16 v[212:215], a[144:147], a[32:35], v[232:235]
    v_cvt_pk_bf16_f32 v252, v253, v252
    v_accvgpr_write_b32 a64, v230
    v_accvgpr_write_b32 a65, v252
    v_accvgpr_read_b32 v230, a66
    v_accvgpr_read_b32 v252, a67
    v_exp_f32 v208, v208
    v_mfma_f32_16x16x32_bf16 v[220:223], a[144:147], a[48:51], v[232:235]
    v_lshlrev_b32 v231, 16, v230
    v_lshlrev_b32 v253, 16, v252
    v_and_b32 v230, 0xffff0000, v230
    v_and_b32 v252, 0xffff0000, v252
    v_mul_f32 v230, s22, v230
    v_mul_f32 v231, s22, v231
    v_exp_f32 v209, v209
    v_mfma_f32_16x16x32_bf16 v[212:215], a[148:151], a[36:39], v[212:215]
    v_mul_f32 v252, s22, v252
    v_mul_f32 v253, s22, v253
    v_cvt_pk_bf16_f32 v230, v231, v230
    v_cvt_pk_bf16_f32 v252, v253, v252
    v_accvgpr_write_b32 a66, v230
    v_exp_f32 v210, v210
    v_add_f32 v238, v238, v208
    v_mfma_f32_16x16x32_bf16 v[220:223], a[148:151], a[52:55], v[220:223]
    s_waitcnt vmcnt(12)
    v_accvgpr_write_b32 a67, v252
    v_accvgpr_read_b32 v230, a68
    v_accvgpr_read_b32 v252, a69
    v_lshlrev_b32 v231, 16, v230
    v_lshlrev_b32 v253, 16, v252
    v_and_b32 v230, 0xffff0000, v230
    v_exp_f32 v211, v211
    v_mfma_f32_16x16x32_bf16 v[212:215], a[152:155], a[40:43], v[212:215]
    v_and_b32 v252, 0xffff0000, v252
    v_mul_f32 v230, s22, v230
    v_mul_f32 v231, s22, v231
    v_mul_f32 v252, s22, v252
    v_mul_f32 v253, s22, v253
    v_cvt_pk_bf16_f32 v230, v231, v230
    v_add_f32 v238, v238, v209
    v_cvt_pk_bf16_f32 v208, v208, v209
    v_mfma_f32_16x16x32_bf16 v[220:223], a[152:155], a[56:59], v[220:223]
    v_cvt_pk_bf16_f32 v252, v253, v252
    v_accvgpr_write_b32 a68, v230
    v_accvgpr_write_b32 a69, v252
    v_accvgpr_read_b32 v230, a70
    v_accvgpr_read_b32 v252, a71
    v_exp_f32 v216, v216
    v_mfma_f32_16x16x32_bf16 v[212:215], a[156:159], a[44:47], v[212:215]
    v_lshlrev_b32 v231, 16, v230
    v_lshlrev_b32 v253, 16, v252
    v_and_b32 v230, 0xffff0000, v230
    v_and_b32 v252, 0xffff0000, v252
    v_mul_f32 v230, s22, v230
    v_mul_f32 v231, s22, v231
    v_add_f32 v238, v238, v210
    v_mfma_f32_16x16x32_bf16 v[220:223], a[156:159], a[60:63], v[220:223]
    buffer_load_dwordx4 v244, s[12:15], s23 offen offset:0 nt lds
    v_mul_f32 v252, s22, v252
    v_mul_f32 v253, s22, v253
    v_cvt_pk_bf16_f32 v230, v231, v230
    v_cvt_pk_bf16_f32 v252, v253, v252
    v_accvgpr_write_b32 a70, v230
    v_exp_f32 v217, v217
    v_add_f32 v238, v238, v211
    v_mfma_f32_16x16x32_bf16 v[32:35], a[160:163], v[200:203], v[32:35]
    s_waitcnt vmcnt(12)
    s_add_u32 m0, s21, 77696
    ds_read_b128 a[128:131], v224 offset:32768
    v_accvgpr_write_b32 a71, v252
    v_accvgpr_read_b32 v230, a72
    v_accvgpr_read_b32 v252, a73
    v_lshlrev_b32 v231, 16, v230
    v_lshlrev_b32 v253, 16, v252
    v_and_b32 v230, 0xffff0000, v230
    v_cvt_pk_bf16_f32 v209, v210, v211
    v_mfma_f32_16x16x32_bf16 v[36:39], a[164:167], v[200:203], v[36:39]
    v_and_b32 v252, 0xffff0000, v252
    v_mul_f32 v230, s22, v230
    v_mul_f32 v231, s22, v231
    v_mul_f32 v252, s22, v252
    v_mul_f32 v253, s22, v253
    v_cvt_pk_bf16_f32 v230, v231, v230
    v_exp_f32 v218, v218
    v_add_f32 v239, v239, v216
    v_mfma_f32_16x16x32_bf16 v[40:43], a[168:171], v[200:203], v[40:43]
    ds_read_b128 a[132:135], v225 offset:32768
    v_cvt_pk_bf16_f32 v252, v253, v252
    v_accvgpr_write_b32 a72, v230
    v_accvgpr_write_b32 a73, v252
    v_accvgpr_read_b32 v230, a74
    v_accvgpr_read_b32 v252, a75
    v_exp_f32 v219, v219
    v_mfma_f32_16x16x32_bf16 v[44:47], a[172:175], v[200:203], v[44:47]
    v_lshlrev_b32 v231, 16, v230
    v_lshlrev_b32 v253, 16, v252
    v_and_b32 v230, 0xffff0000, v230
    v_and_b32 v252, 0xffff0000, v252
    v_mul_f32 v230, s22, v230
    v_mul_f32 v231, s22, v231
    v_add_f32 v239, v239, v217
    v_cvt_pk_bf16_f32 v216, v216, v217
    v_mfma_f32_16x16x32_bf16 v[48:51], a[176:179], v[200:203], v[48:51]
    ds_read_b128 a[136:139], v224 offset:36864
    v_mul_f32 v252, s22, v252
    v_mul_f32 v253, s22, v253
    v_cvt_pk_bf16_f32 v230, v231, v230
    v_cvt_pk_bf16_f32 v252, v253, v252
    v_accvgpr_write_b32 a74, v230
    v_exp_f32 v212, v212
    v_mfma_f32_16x16x32_bf16 v[52:55], a[180:183], v[200:203], v[52:55]
    s_waitcnt vmcnt(11)
    v_accvgpr_write_b32 a75, v252
    v_accvgpr_read_b32 v230, a76
    v_accvgpr_read_b32 v252, a77
    v_lshlrev_b32 v231, 16, v230
    v_lshlrev_b32 v253, 16, v252
    v_and_b32 v230, 0xffff0000, v230
    v_add_f32 v239, v239, v218
    v_mfma_f32_16x16x32_bf16 v[56:59], a[184:187], v[200:203], v[56:59]
    ds_read_b128 a[140:143], v225 offset:36864
    v_and_b32 v252, 0xffff0000, v252
    v_mul_f32 v230, s22, v230
    v_mul_f32 v231, s22, v231
    v_mul_f32 v252, s22, v252
    v_mul_f32 v253, s22, v253
    v_cvt_pk_bf16_f32 v230, v231, v230
    v_exp_f32 v213, v213
    v_add_f32 v239, v239, v219
    v_mfma_f32_16x16x32_bf16 v[60:63], a[188:191], v[200:203], v[60:63]
    s_waitcnt lgkmcnt(1)
    v_cvt_pk_bf16_f32 v252, v253, v252
    v_accvgpr_write_b32 a76, v230
    v_accvgpr_write_b32 a77, v252
    v_accvgpr_read_b32 v230, a78
    v_accvgpr_read_b32 v252, a79
    v_cvt_pk_bf16_f32 v217, v218, v219
    v_mfma_f32_16x16x32_bf16 v[192:195], a[128:131], a[0:3], v[232:235]
    v_lshlrev_b32 v231, 16, v230
    v_lshlrev_b32 v253, 16, v252
    v_and_b32 v230, 0xffff0000, v230
    v_and_b32 v252, 0xffff0000, v252
    v_mul_f32 v230, s22, v230
    v_mul_f32 v231, s22, v231
    v_exp_f32 v214, v214
    v_add_f32 v238, v238, v212
    v_mfma_f32_16x16x32_bf16 v[200:203], a[128:131], a[16:19], v[232:235]
    v_mul_f32 v252, s22, v252
    v_mul_f32 v253, s22, v253
    v_cvt_pk_bf16_f32 v230, v231, v230
    v_cvt_pk_bf16_f32 v252, v253, v252
    v_accvgpr_write_b32 a78, v230
    v_exp_f32 v215, v215
    v_mfma_f32_16x16x32_bf16 v[192:195], a[132:135], a[4:7], v[192:195]
    s_waitcnt vmcnt(10)
    v_accvgpr_write_b32 a79, v252
    v_accvgpr_read_b32 v230, a80
    v_accvgpr_read_b32 v252, a81
    v_lshlrev_b32 v231, 16, v230
    v_lshlrev_b32 v253, 16, v252
    v_and_b32 v230, 0xffff0000, v230
    v_add_f32 v238, v238, v213
    v_cvt_pk_bf16_f32 v210, v212, v213
    v_mfma_f32_16x16x32_bf16 v[200:203], a[132:135], a[20:23], v[200:203]
    buffer_load_dwordx4 v244, s[12:15], s23 offen offset:128 nt lds
    v_and_b32 v252, 0xffff0000, v252
    v_mul_f32 v230, s22, v230
    v_mul_f32 v231, s22, v231
    v_mul_f32 v252, s22, v252
    v_mul_f32 v253, s22, v253
    v_cvt_pk_bf16_f32 v230, v231, v230
    v_exp_f32 v220, v220
    v_mfma_f32_16x16x32_bf16 v[192:195], a[136:139], a[8:11], v[192:195]
    s_xor_b32 s39, s26, 0
    v_cvt_pk_bf16_f32 v252, v253, v252
    v_accvgpr_write_b32 a80, v230
    v_accvgpr_write_b32 a81, v252
    v_accvgpr_read_b32 v230, a82
    v_accvgpr_read_b32 v252, a83
    v_add_f32 v238, v238, v214
    v_mfma_f32_16x16x32_bf16 v[200:203], a[136:139], a[24:27], v[200:203]
    s_waitcnt lgkmcnt(0)
    s_lshl_b32 s23, s39, 1
    v_lshlrev_b32 v231, 16, v230
    v_lshlrev_b32 v253, 16, v252
    v_and_b32 v230, 0xffff0000, v230
    v_and_b32 v252, 0xffff0000, v252
    v_mul_f32 v230, s22, v230
    v_mul_f32 v231, s22, v231
    v_exp_f32 v221, v221
    v_add_f32 v238, v238, v215
    v_mfma_f32_16x16x32_bf16 v[192:195], a[140:143], a[12:15], v[192:195]
    s_add_u32 s23, s23, s27
    v_mul_f32 v252, s22, v252
    v_mul_f32 v253, s22, v253
    v_cvt_pk_bf16_f32 v230, v231, v230
    v_cvt_pk_bf16_f32 v252, v253, v252
    v_accvgpr_write_b32 a82, v230
    v_cvt_pk_bf16_f32 v211, v214, v215
    v_mfma_f32_16x16x32_bf16 v[200:203], a[140:143], a[28:31], v[200:203]
    s_waitcnt vmcnt(10)
    s_add_u32 s23, s23, 98304
    v_accvgpr_write_b32 a83, v252
    v_accvgpr_read_b32 v230, a84
    v_accvgpr_read_b32 v252, a85
    v_lshlrev_b32 v231, 16, v230
    v_lshlrev_b32 v253, 16, v252
    v_and_b32 v230, 0xffff0000, v230
    v_mfma_f32_16x16x32_bf16 v[64:67], a[160:163], v[208:211], v[64:67]
    ds_read_b128 a[144:147], v224 offset:34816
    v_and_b32 v252, 0xffff0000, v252
    v_mul_f32 v230, s22, v230
    v_mul_f32 v231, s22, v231
    v_mul_f32 v252, s22, v252
    v_mul_f32 v253, s22, v253
    v_cvt_pk_bf16_f32 v230, v231, v230
    v_mfma_f32_16x16x32_bf16 v[68:71], a[164:167], v[208:211], v[68:71]
    v_cvt_pk_bf16_f32 v252, v253, v252
    v_accvgpr_write_b32 a84, v230
    v_accvgpr_write_b32 a85, v252
    v_accvgpr_read_b32 v230, a86
    v_accvgpr_read_b32 v252, a87
    v_mfma_f32_16x16x32_bf16 v[72:75], a[168:171], v[208:211], v[72:75]
    ds_read_b128 a[148:151], v225 offset:34816
    v_lshlrev_b32 v231, 16, v230
    v_lshlrev_b32 v253, 16, v252
    v_and_b32 v230, 0xffff0000, v230
    v_and_b32 v252, 0xffff0000, v252
    v_mul_f32 v230, s22, v230
    v_mul_f32 v231, s22, v231
    v_mfma_f32_16x16x32_bf16 v[76:79], a[172:175], v[208:211], v[76:79]
    v_mul_f32 v252, s22, v252
    v_mul_f32 v253, s22, v253
    v_cvt_pk_bf16_f32 v230, v231, v230
    v_cvt_pk_bf16_f32 v252, v253, v252
    v_accvgpr_write_b32 a86, v230
    v_exp_f32 v222, v222
    v_add_f32 v239, v239, v220
    v_mfma_f32_16x16x32_bf16 v[80:83], a[176:179], v[208:211], v[80:83]
    s_waitcnt vmcnt(9)
    ds_read_b128 a[152:155], v224 offset:38912
    v_accvgpr_write_b32 a87, v252
    v_accvgpr_read_b32 v230, a88
    v_accvgpr_read_b32 v252, a89
    v_lshlrev_b32 v231, 16, v230
    v_lshlrev_b32 v253, 16, v252
    v_and_b32 v230, 0xffff0000, v230
    v_exp_f32 v223, v223
    v_mfma_f32_16x16x32_bf16 v[84:87], a[180:183], v[208:211], v[84:87]
    v_and_b32 v252, 0xffff0000, v252
    v_mul_f32 v230, s22, v230
    v_mul_f32 v231, s22, v231
    v_mul_f32 v252, s22, v252
    v_mul_f32 v253, s22, v253
    v_cvt_pk_bf16_f32 v230, v231, v230
    v_add_f32 v239, v239, v221
    v_cvt_pk_bf16_f32 v218, v220, v221
    v_mfma_f32_16x16x32_bf16 v[88:91], a[184:187], v[208:211], v[88:91]
    ds_read_b128 a[156:159], v225 offset:38912
    v_cvt_pk_bf16_f32 v252, v253, v252
    v_accvgpr_write_b32 a88, v230
    v_accvgpr_write_b32 a89, v252
    v_accvgpr_read_b32 v230, a90
    v_accvgpr_read_b32 v252, a91
    v_add_f32 v239, v239, v222
    v_add_f32 v239, v239, v223
    v_mfma_f32_16x16x32_bf16 v[92:95], a[188:191], v[208:211], v[92:95]
    s_waitcnt lgkmcnt(1)
    buffer_load_dwordx4 a[96:99], v244, s[4:7], s23 offen offset:0 nt
    v_lshlrev_b32 v231, 16, v230
    v_lshlrev_b32 v253, 16, v252
    v_and_b32 v230, 0xffff0000, v230
    v_and_b32 v252, 0xffff0000, v252
    v_mul_f32 v230, s22, v230
    v_mul_f32 v231, s22, v231
    v_cvt_pk_bf16_f32 v219, v222, v223
    v_mfma_f32_16x16x32_bf16 v[196:199], a[144:147], a[0:3], v[232:235]
    v_mul_f32 v252, s22, v252
    v_mul_f32 v253, s22, v253
    v_cvt_pk_bf16_f32 v230, v231, v230
    v_cvt_pk_bf16_f32 v252, v253, v252
    v_accvgpr_write_b32 a90, v230
    v_exp_f32 v192, v192
    v_mfma_f32_16x16x32_bf16 v[204:207], a[144:147], a[16:19], v[232:235]
    s_waitcnt vmcnt(9)
    v_accvgpr_write_b32 a91, v252
    v_accvgpr_read_b32 v230, a92
    v_accvgpr_read_b32 v252, a93
    v_lshlrev_b32 v231, 16, v230
    v_lshlrev_b32 v253, 16, v252
    v_and_b32 v230, 0xffff0000, v230
    v_exp_f32 v193, v193
    v_mfma_f32_16x16x32_bf16 v[196:199], a[148:151], a[4:7], v[196:199]
    v_and_b32 v252, 0xffff0000, v252
    v_mul_f32 v230, s22, v230
    v_mul_f32 v231, s22, v231
    v_mul_f32 v252, s22, v252
    v_mul_f32 v253, s22, v253
    v_cvt_pk_bf16_f32 v230, v231, v230
    v_exp_f32 v194, v194
    v_add_f32 v236, v236, v192
    v_mfma_f32_16x16x32_bf16 v[204:207], a[148:151], a[20:23], v[204:207]
    v_cvt_pk_bf16_f32 v252, v253, v252
    v_accvgpr_write_b32 a92, v230
    v_accvgpr_write_b32 a93, v252
    v_accvgpr_read_b32 v230, a94
    v_accvgpr_read_b32 v252, a95
    v_exp_f32 v195, v195
    v_mfma_f32_16x16x32_bf16 v[196:199], a[152:155], a[8:11], v[196:199]
    v_lshlrev_b32 v231, 16, v230
    v_lshlrev_b32 v253, 16, v252
    v_and_b32 v230, 0xffff0000, v230
    v_and_b32 v252, 0xffff0000, v252
    v_mul_f32 v230, s22, v230
    v_mul_f32 v231, s22, v231
    v_add_f32 v236, v236, v193
    v_cvt_pk_bf16_f32 v192, v192, v193
    v_mfma_f32_16x16x32_bf16 v[204:207], a[152:155], a[24:27], v[204:207]
    s_waitcnt lgkmcnt(0)
    v_mul_f32 v252, s22, v252
    v_mul_f32 v253, s22, v253
    v_cvt_pk_bf16_f32 v230, v231, v230
    v_cvt_pk_bf16_f32 v252, v253, v252
    v_accvgpr_write_b32 a94, v230
    v_exp_f32 v200, v200
    v_mfma_f32_16x16x32_bf16 v[196:199], a[156:159], a[12:15], v[196:199]
    v_accvgpr_write_b32 a95, v252
    v_add_f32 v236, v236, v194
    v_mfma_f32_16x16x32_bf16 v[204:207], a[156:159], a[28:31], v[204:207]
    v_exp_f32 v201, v201
    v_add_f32 v236, v236, v195
    v_mfma_f32_16x16x32_bf16 v[96:99], a[160:163], v[216:219], v[96:99]
    ds_write_b128 v254, a[64:67] offset:0
    v_cvt_pk_bf16_f32 v193, v194, v195
    v_mfma_f32_16x16x32_bf16 v[100:103], a[164:167], v[216:219], v[100:103]
    ds_read_b64_tr_b16 a[160:161], v226 offset:40960
    ds_read_b64_tr_b16 a[162:163], v226 offset:43008
    v_exp_f32 v202, v202
    v_add_f32 v237, v237, v200
    v_mfma_f32_16x16x32_bf16 v[104:107], a[168:171], v[216:219], v[104:107]
    ds_write_b128 v254, a[68:71] offset:4096
    ds_read_b64_tr_b16 a[164:165], v227 offset:40960
    v_exp_f32 v203, v203
    v_mfma_f32_16x16x32_bf16 v[108:111], a[172:175], v[216:219], v[108:111]
    ds_read_b64_tr_b16 a[166:167], v227 offset:43008
    buffer_load_dwordx4 a[100:103], v244, s[4:7], s23 offen offset:128 nt
    v_add_f32 v237, v237, v201
    v_cvt_pk_bf16_f32 v200, v200, v201
    v_mfma_f32_16x16x32_bf16 v[112:115], a[176:179], v[216:219], v[112:115]
    s_xor_b32 s39, s26, 1024
    ds_write_b128 v255, a[72:75] offset:0
    ds_read_b64_tr_b16 a[168:169], v228 offset:40960
    v_exp_f32 v196, v196
    v_mfma_f32_16x16x32_bf16 v[116:119], a[180:183], v[216:219], v[116:119]
    s_lshl_b32 s23, s39, 1
    ds_read_b64_tr_b16 a[170:171], v228 offset:43008
    v_add_f32 v237, v237, v202
    v_mfma_f32_16x16x32_bf16 v[120:123], a[184:187], v[216:219], v[120:123]
    s_add_u32 s23, s23, s27
    ds_write_b128 v255, a[76:79] offset:4096
    ds_read_b64_tr_b16 a[172:173], v229 offset:40960
    v_exp_f32 v197, v197
    v_add_f32 v237, v237, v203
    v_mfma_f32_16x16x32_bf16 v[124:127], a[188:191], v[216:219], v[124:127]
    s_add_u32 s23, s23, 98304
    ds_read_b64_tr_b16 a[174:175], v229 offset:43008
    v_cvt_pk_bf16_f32 v201, v202, v203
    v_mfma_f32_16x16x32_bf16 v[208:211], a[128:131], a[32:35], v[232:235]
    ds_write_b128 v254, a[80:83] offset:2048
    ds_read_b64_tr_b16 a[176:177], v226 offset:45056
    v_exp_f32 v198, v198
    v_add_f32 v236, v236, v196
    v_mfma_f32_16x16x32_bf16 v[216:219], a[128:131], a[48:51], v[232:235]
    ds_read_b64_tr_b16 a[178:179], v226 offset:47104
    v_exp_f32 v199, v199
    v_mfma_f32_16x16x32_bf16 v[208:211], a[132:135], a[36:39], v[208:211]
    s_waitcnt lgkmcnt(4)
    ds_write_b128 v254, a[84:87] offset:6144
    ds_read_b64_tr_b16 a[180:181], v227 offset:45056
    v_add_f32 v236, v236, v197
    v_cvt_pk_bf16_f32 v194, v196, v197
    v_mfma_f32_16x16x32_bf16 v[216:219], a[132:135], a[52:55], v[216:219]
    ds_read_b64_tr_b16 a[182:183], v227 offset:47104
    v_exp_f32 v204, v204
    v_mfma_f32_16x16x32_bf16 v[208:211], a[136:139], a[40:43], v[208:211]
    ds_write_b128 v255, a[88:91] offset:2048
    ds_read_b64_tr_b16 a[184:185], v228 offset:45056
    v_add_f32 v236, v236, v198
    v_mfma_f32_16x16x32_bf16 v[216:219], a[136:139], a[56:59], v[216:219]
    ds_read_b64_tr_b16 a[186:187], v228 offset:47104
    v_exp_f32 v205, v205
    v_add_f32 v236, v236, v199
    v_mfma_f32_16x16x32_bf16 v[208:211], a[140:143], a[44:47], v[208:211]
    ds_write_b128 v255, a[92:95] offset:6144
    ds_read_b64_tr_b16 a[188:189], v229 offset:45056
    v_cvt_pk_bf16_f32 v195, v198, v199
    v_mfma_f32_16x16x32_bf16 v[216:219], a[140:143], a[60:63], v[216:219]
    ds_read_b64_tr_b16 a[190:191], v229 offset:47104
    buffer_load_dwordx4 a[104:107], v249, s[4:7], s23 offen offset:0 nt
    v_mfma_f32_16x16x32_bf16 v[0:3], a[160:163], v[192:195], v[0:3]
    ds_read_b128 a[64:67], v250 offset:32768
    ds_read_b128 a[80:83], v250 offset:34816
    v_mfma_f32_16x16x32_bf16 v[4:7], a[164:167], v[192:195], v[4:7]
    v_exp_f32 v206, v206
    v_mfma_f32_16x16x32_bf16 v[8:11], a[168:171], v[192:195], v[8:11]
    s_waitcnt lgkmcnt(5)
    ds_read_b128 a[68:71], v251 offset:32768
    v_add_f32 v237, v237, v204
    v_mfma_f32_16x16x32_bf16 v[12:15], a[172:175], v[192:195], v[12:15]
    v_exp_f32 v207, v207
    v_mfma_f32_16x16x32_bf16 v[16:19], a[176:179], v[192:195], v[16:19]
    v_add_f32 v237, v237, v205
    v_cvt_pk_bf16_f32 v202, v204, v205
    v_mfma_f32_16x16x32_bf16 v[20:23], a[180:183], v[192:195], v[20:23]
    ds_read_b128 a[84:87], v251 offset:34816
    v_add_f32 v237, v237, v206
    v_mfma_f32_16x16x32_bf16 v[24:27], a[184:187], v[192:195], v[24:27]
    s_waitcnt lgkmcnt(2)
    v_add_f32 v237, v237, v207
    v_cvt_pk_bf16_f32 v203, v206, v207
    v_mfma_f32_16x16x32_bf16 v[28:31], a[188:191], v[192:195], v[28:31]
    ds_read_b128 a[72:75], v250 offset:36864
    v_exp_f32 v208, v208
    v_mfma_f32_16x16x32_bf16 v[212:215], a[144:147], a[32:35], v[232:235]
    v_exp_f32 v209, v209
    v_mfma_f32_16x16x32_bf16 v[220:223], a[144:147], a[48:51], v[232:235]
    ds_read_b128 a[88:91], v250 offset:38912
    v_exp_f32 v210, v210
    v_mfma_f32_16x16x32_bf16 v[212:215], a[148:151], a[36:39], v[212:215]
    ds_read_b128 a[76:79], v251 offset:36864
    v_add_f32 v238, v238, v208
    v_mfma_f32_16x16x32_bf16 v[220:223], a[148:151], a[52:55], v[220:223]
    buffer_load_dwordx4 a[108:111], v249, s[4:7], s23 offen offset:128 nt
    v_exp_f32 v211, v211
    v_mfma_f32_16x16x32_bf16 v[212:215], a[152:155], a[40:43], v[212:215]
    s_xor_b32 s39, s26, 2048
    v_add_f32 v238, v238, v209
    v_cvt_pk_bf16_f32 v208, v208, v209
    v_mfma_f32_16x16x32_bf16 v[220:223], a[152:155], a[56:59], v[220:223]
    s_lshl_b32 s23, s39, 1
    v_exp_f32 v216, v216
    v_mfma_f32_16x16x32_bf16 v[212:215], a[156:159], a[44:47], v[212:215]
    s_add_u32 s23, s23, s27
    ds_read_b128 a[92:95], v251 offset:38912
    v_add_f32 v238, v238, v210
    v_mfma_f32_16x16x32_bf16 v[220:223], a[156:159], a[60:63], v[220:223]
    s_add_u32 s23, s23, 98304
    v_exp_f32 v217, v217
    v_add_f32 v238, v238, v211
    v_mfma_f32_16x16x32_bf16 v[32:35], a[160:163], v[200:203], v[32:35]
    v_cvt_pk_bf16_f32 v209, v210, v211
    v_exp_f32 v218, v218
    v_mfma_f32_16x16x32_bf16 v[36:39], a[164:167], v[200:203], v[36:39]
    v_add_f32 v239, v239, v216
    v_exp_f32 v219, v219
    v_mfma_f32_16x16x32_bf16 v[40:43], a[168:171], v[200:203], v[40:43]
    v_add_f32 v239, v239, v217
    v_cvt_pk_bf16_f32 v216, v216, v217
    v_mfma_f32_16x16x32_bf16 v[44:47], a[172:175], v[200:203], v[44:47]
    v_exp_f32 v212, v212
    v_mfma_f32_16x16x32_bf16 v[48:51], a[176:179], v[200:203], v[48:51]
    v_add_f32 v239, v239, v218
    v_mfma_f32_16x16x32_bf16 v[52:55], a[180:183], v[200:203], v[52:55]
    v_exp_f32 v213, v213
    v_mfma_f32_16x16x32_bf16 v[56:59], a[184:187], v[200:203], v[56:59]
    v_add_f32 v239, v239, v219
    v_cvt_pk_bf16_f32 v217, v218, v219
    v_mfma_f32_16x16x32_bf16 v[60:63], a[188:191], v[200:203], v[60:63]
    buffer_load_dwordx4 a[112:115], v244, s[4:7], s23 offen offset:0 nt
    v_mfma_f32_16x16x32_bf16 v[192:195], a[128:131], a[64:67], v[232:235]
    v_exp_f32 v214, v214
    v_add_f32 v238, v238, v212
    v_mfma_f32_16x16x32_bf16 v[200:203], a[128:131], a[80:83], v[232:235]
    s_waitcnt lgkmcnt(0)
    v_exp_f32 v215, v215
    v_mfma_f32_16x16x32_bf16 v[192:195], a[132:135], a[68:71], v[192:195]
    v_add_f32 v238, v238, v213
    v_cvt_pk_bf16_f32 v210, v212, v213
    v_mfma_f32_16x16x32_bf16 v[200:203], a[132:135], a[84:87], v[200:203]
    v_exp_f32 v220, v220
    v_mfma_f32_16x16x32_bf16 v[192:195], a[136:139], a[72:75], v[192:195]
    v_add_f32 v238, v238, v214
    v_exp_f32 v221, v221
    v_mfma_f32_16x16x32_bf16 v[200:203], a[136:139], a[88:91], v[200:203]
    v_add_f32 v238, v238, v215
    v_cvt_pk_bf16_f32 v211, v214, v215
    v_mfma_f32_16x16x32_bf16 v[192:195], a[140:143], a[76:79], v[192:195]
    v_exp_f32 v222, v222
    v_mfma_f32_16x16x32_bf16 v[200:203], a[140:143], a[92:95], v[200:203]
    v_add_f32 v239, v239, v220
    v_mfma_f32_16x16x32_bf16 v[64:67], a[160:163], v[208:211], v[64:67]
    buffer_load_dwordx4 a[116:119], v244, s[4:7], s23 offen offset:128 nt
    v_mfma_f32_16x16x32_bf16 v[68:71], a[164:167], v[208:211], v[68:71]
    v_exp_f32 v223, v223
    v_mfma_f32_16x16x32_bf16 v[72:75], a[168:171], v[208:211], v[72:75]
    v_add_f32 v239, v239, v221
    v_cvt_pk_bf16_f32 v218, v220, v221
    v_mfma_f32_16x16x32_bf16 v[76:79], a[172:175], v[208:211], v[76:79]
    v_add_f32 v239, v239, v222
    v_add_f32 v239, v239, v223
    v_mfma_f32_16x16x32_bf16 v[80:83], a[176:179], v[208:211], v[80:83]
    s_xor_b32 s39, s26, 3072
    v_cvt_pk_bf16_f32 v219, v222, v223
    v_mfma_f32_16x16x32_bf16 v[84:87], a[180:183], v[208:211], v[84:87]
    s_lshl_b32 s23, s39, 1
    v_exp_f32 v192, v192
    v_mfma_f32_16x16x32_bf16 v[88:91], a[184:187], v[208:211], v[88:91]
    s_add_u32 s23, s23, s27
    v_exp_f32 v193, v193
    v_mfma_f32_16x16x32_bf16 v[92:95], a[188:191], v[208:211], v[92:95]
    s_waitcnt vmcnt(10)
    s_add_u32 s23, s23, 98304
    s_barrier
    v_mfma_f32_16x16x32_bf16 v[196:199], a[144:147], a[64:67], v[232:235]
    v_exp_f32 v194, v194
    v_mfma_f32_16x16x32_bf16 v[204:207], a[144:147], a[80:83], v[232:235]
    ds_read_b128 a[128:131], v224 offset:49152
    v_add_f32 v240, v240, v192
    v_mfma_f32_16x16x32_bf16 v[196:199], a[148:151], a[68:71], v[196:199]
    v_exp_f32 v195, v195
    v_mfma_f32_16x16x32_bf16 v[204:207], a[148:151], a[84:87], v[204:207]
    v_add_f32 v240, v240, v193
    v_cvt_pk_bf16_f32 v192, v192, v193
    v_mfma_f32_16x16x32_bf16 v[196:199], a[152:155], a[72:75], v[196:199]
    v_exp_f32 v200, v200
    v_mfma_f32_16x16x32_bf16 v[204:207], a[152:155], a[88:91], v[204:207]
    ds_read_b128 a[132:135], v225 offset:49152
    v_add_f32 v240, v240, v194
    v_mfma_f32_16x16x32_bf16 v[196:199], a[156:159], a[76:79], v[196:199]
    v_exp_f32 v201, v201
    v_mfma_f32_16x16x32_bf16 v[204:207], a[156:159], a[92:95], v[204:207]
    buffer_load_dwordx4 a[120:123], v249, s[4:7], s23 offen offset:0 nt
    v_add_f32 v240, v240, v195
    v_mfma_f32_16x16x32_bf16 v[96:99], a[160:163], v[216:219], v[96:99]
    ds_read_b128 a[136:139], v224 offset:53248
    v_cvt_pk_bf16_f32 v193, v194, v195
    v_mfma_f32_16x16x32_bf16 v[100:103], a[164:167], v[216:219], v[100:103]
    v_exp_f32 v202, v202
    v_add_f32 v241, v241, v200
    v_mfma_f32_16x16x32_bf16 v[104:107], a[168:171], v[216:219], v[104:107]
    v_exp_f32 v203, v203
    v_mfma_f32_16x16x32_bf16 v[108:111], a[172:175], v[216:219], v[108:111]
    v_add_f32 v241, v241, v201
    v_cvt_pk_bf16_f32 v200, v200, v201
    v_mfma_f32_16x16x32_bf16 v[112:115], a[176:179], v[216:219], v[112:115]
    v_exp_f32 v196, v196
    v_mfma_f32_16x16x32_bf16 v[116:119], a[180:183], v[216:219], v[116:119]
    ds_read_b128 a[140:143], v225 offset:53248
    v_add_f32 v241, v241, v202
    v_mfma_f32_16x16x32_bf16 v[120:123], a[184:187], v[216:219], v[120:123]
    v_exp_f32 v197, v197
    v_add_f32 v241, v241, v203
    v_mfma_f32_16x16x32_bf16 v[124:127], a[188:191], v[216:219], v[124:127]
    s_waitcnt lgkmcnt(1)
    ds_read_b128 a[144:147], v224 offset:51200
    v_cvt_pk_bf16_f32 v201, v202, v203
    v_mfma_f32_16x16x32_bf16 v[208:211], a[128:131], a[0:3], v[232:235]
    v_exp_f32 v198, v198
    v_add_f32 v240, v240, v196
    v_mfma_f32_16x16x32_bf16 v[216:219], a[128:131], a[16:19], v[232:235]
    v_exp_f32 v199, v199
    v_mfma_f32_16x16x32_bf16 v[208:211], a[132:135], a[4:7], v[208:211]
    v_add_f32 v240, v240, v197
    v_cvt_pk_bf16_f32 v194, v196, v197
    v_mfma_f32_16x16x32_bf16 v[216:219], a[132:135], a[20:23], v[216:219]
    buffer_load_dwordx4 a[124:127], v249, s[4:7], s23 offen offset:128 nt
    v_exp_f32 v204, v204
    v_mfma_f32_16x16x32_bf16 v[208:211], a[136:139], a[8:11], v[208:211]
    s_add_u32 m0, s21, 81920
    ds_read_b128 a[148:151], v225 offset:51200
    v_add_f32 v240, v240, v198
    v_mfma_f32_16x16x32_bf16 v[216:219], a[136:139], a[24:27], v[216:219]
    s_waitcnt lgkmcnt(1)
    s_mov_b32 s23, 40960
    v_exp_f32 v205, v205
    v_add_f32 v240, v240, v199
    v_mfma_f32_16x16x32_bf16 v[208:211], a[140:143], a[12:15], v[208:211]
    ds_read_b128 a[152:155], v224 offset:55296
    v_cvt_pk_bf16_f32 v195, v198, v199
    v_mfma_f32_16x16x32_bf16 v[216:219], a[140:143], a[28:31], v[216:219]
    v_exp_f32 v206, v206
    v_mfma_f32_16x16x32_bf16 v[128:131], a[160:163], v[192:195], 0
    ds_read_b128 a[156:159], v225 offset:55296
    v_add_f32 v241, v241, v204
    v_mfma_f32_16x16x32_bf16 v[132:135], a[164:167], v[192:195], 0
    v_exp_f32 v207, v207
    v_mfma_f32_16x16x32_bf16 v[136:139], a[168:171], v[192:195], 0
    v_add_f32 v241, v241, v205
    v_cvt_pk_bf16_f32 v202, v204, v205
    v_mfma_f32_16x16x32_bf16 v[140:143], a[172:175], v[192:195], 0
    v_add_f32 v241, v241, v206
    v_add_f32 v241, v241, v207
    v_mfma_f32_16x16x32_bf16 v[144:147], a[176:179], v[192:195], 0
    v_cvt_pk_bf16_f32 v203, v206, v207
    v_mfma_f32_16x16x32_bf16 v[148:151], a[180:183], v[192:195], 0
    buffer_load_dwordx4 v244, s[8:11], s23 offen offset:0 nt lds
    v_mfma_f32_16x16x32_bf16 v[152:155], a[184:187], v[192:195], 0
    v_exp_f32 v208, v208
    v_mfma_f32_16x16x32_bf16 v[156:159], a[188:191], v[192:195], 0
    v_exp_f32 v209, v209
    v_mfma_f32_16x16x32_bf16 v[212:215], a[144:147], a[0:3], v[232:235]
    s_add_u32 m0, s21, 85888
    v_exp_f32 v210, v210
    v_mfma_f32_16x16x32_bf16 v[220:223], a[144:147], a[16:19], v[232:235]
    s_waitcnt lgkmcnt(0)
    v_add_f32 v236, v236, v208
    v_mfma_f32_16x16x32_bf16 v[212:215], a[148:151], a[4:7], v[212:215]
    v_exp_f32 v211, v211
    v_mfma_f32_16x16x32_bf16 v[220:223], a[148:151], a[20:23], v[220:223]
    v_add_f32 v236, v236, v209
    v_cvt_pk_bf16_f32 v208, v208, v209
    v_mfma_f32_16x16x32_bf16 v[212:215], a[152:155], a[8:11], v[212:215]
    v_exp_f32 v216, v216
    v_mfma_f32_16x16x32_bf16 v[220:223], a[152:155], a[24:27], v[220:223]
    v_add_f32 v236, v236, v210
    v_mfma_f32_16x16x32_bf16 v[212:215], a[156:159], a[12:15], v[212:215]
    v_exp_f32 v217, v217
    v_mfma_f32_16x16x32_bf16 v[220:223], a[156:159], a[28:31], v[220:223]
    v_add_f32 v236, v236, v211
    v_cvt_pk_bf16_f32 v209, v210, v211
    v_mfma_f32_16x16x32_bf16 v[160:163], a[160:163], v[200:203], 0
    v_exp_f32 v218, v218
    v_mfma_f32_16x16x32_bf16 v[164:167], a[164:167], v[200:203], 0
    ds_read_b64_tr_b16 a[160:161], v226 offset:57344
    ds_read_b64_tr_b16 a[162:163], v226 offset:59392
    v_add_f32 v237, v237, v216
    v_mfma_f32_16x16x32_bf16 v[168:171], a[168:171], v[200:203], 0
    ds_read_b64_tr_b16 a[164:165], v227 offset:57344
    v_exp_f32 v219, v219
    v_mfma_f32_16x16x32_bf16 v[172:175], a[172:175], v[200:203], 0
    ds_read_b64_tr_b16 a[166:167], v227 offset:59392
    buffer_load_dwordx4 v244, s[8:11], s23 offen offset:128 nt lds
    v_add_f32 v237, v237, v217
    v_cvt_pk_bf16_f32 v216, v216, v217
    v_mfma_f32_16x16x32_bf16 v[176:179], a[176:179], v[200:203], 0
    s_add_u32 m0, s21, 90112
    ds_read_b64_tr_b16 a[168:169], v228 offset:57344
    v_exp_f32 v212, v212
    v_mfma_f32_16x16x32_bf16 v[180:183], a[180:183], v[200:203], 0
    ds_read_b64_tr_b16 a[170:171], v228 offset:59392
    v_add_f32 v237, v237, v218
    v_mfma_f32_16x16x32_bf16 v[184:187], a[184:187], v[200:203], 0
    ds_read_b64_tr_b16 a[172:173], v229 offset:57344
    v_exp_f32 v213, v213
    v_add_f32 v237, v237, v219
    v_mfma_f32_16x16x32_bf16 v[188:191], a[188:191], v[200:203], 0
    ds_read_b64_tr_b16 a[174:175], v229 offset:59392
    v_cvt_pk_bf16_f32 v217, v218, v219
    v_mfma_f32_16x16x32_bf16 v[192:195], a[128:131], a[32:35], v[232:235]
    ds_read_b64_tr_b16 a[176:177], v226 offset:61440
    v_exp_f32 v214, v214
    v_add_f32 v236, v236, v212
    v_mfma_f32_16x16x32_bf16 v[200:203], a[128:131], a[48:51], v[232:235]
    ds_read_b64_tr_b16 a[178:179], v226 offset:63488
    v_exp_f32 v215, v215
    v_mfma_f32_16x16x32_bf16 v[192:195], a[132:135], a[36:39], v[192:195]
    ds_read_b64_tr_b16 a[180:181], v227 offset:61440
    v_add_f32 v236, v236, v213
    v_cvt_pk_bf16_f32 v210, v212, v213
    v_mfma_f32_16x16x32_bf16 v[200:203], a[132:135], a[52:55], v[200:203]
    ds_read_b64_tr_b16 a[182:183], v227 offset:63488
    v_exp_f32 v220, v220
    v_mfma_f32_16x16x32_bf16 v[192:195], a[136:139], a[40:43], v[192:195]
    ds_read_b64_tr_b16 a[184:185], v228 offset:61440
    v_add_f32 v236, v236, v214
    v_mfma_f32_16x16x32_bf16 v[200:203], a[136:139], a[56:59], v[200:203]
    ds_read_b64_tr_b16 a[186:187], v228 offset:63488
    v_exp_f32 v221, v221
    v_add_f32 v236, v236, v215
    v_mfma_f32_16x16x32_bf16 v[192:195], a[140:143], a[44:47], v[192:195]
    ds_read_b64_tr_b16 a[188:189], v229 offset:61440
    v_cvt_pk_bf16_f32 v211, v214, v215
    v_mfma_f32_16x16x32_bf16 v[200:203], a[140:143], a[60:63], v[200:203]
    s_waitcnt lgkmcnt(4)
    ds_read_b64_tr_b16 a[190:191], v229 offset:63488
    buffer_load_dwordx4 v244, s[12:15], s23 offen offset:0 nt lds
    v_mfma_f32_16x16x32_bf16 v[0:3], a[160:163], v[208:211], v[0:3]
    s_add_u32 m0, s21, 94080
    v_exp_f32 v222, v222
    v_mfma_f32_16x16x32_bf16 v[4:7], a[164:167], v[208:211], v[4:7]
    v_add_f32 v237, v237, v220
    v_mfma_f32_16x16x32_bf16 v[8:11], a[168:171], v[208:211], v[8:11]
    v_exp_f32 v223, v223
    v_mfma_f32_16x16x32_bf16 v[12:15], a[172:175], v[208:211], v[12:15]
    v_add_f32 v237, v237, v221
    v_cvt_pk_bf16_f32 v218, v220, v221
    v_mfma_f32_16x16x32_bf16 v[16:19], a[176:179], v[208:211], v[16:19]
    s_waitcnt lgkmcnt(1)
    v_add_f32 v237, v237, v222
    v_add_f32 v237, v237, v223
    v_mfma_f32_16x16x32_bf16 v[20:23], a[180:183], v[208:211], v[20:23]
    v_cvt_pk_bf16_f32 v219, v222, v223
    v_mfma_f32_16x16x32_bf16 v[24:27], a[184:187], v[208:211], v[24:27]
    s_waitcnt lgkmcnt(0)
    v_exp_f32 v192, v192
    v_mfma_f32_16x16x32_bf16 v[28:31], a[188:191], v[208:211], v[28:31]
    v_exp_f32 v193, v193
    v_mfma_f32_16x16x32_bf16 v[196:199], a[144:147], a[32:35], v[232:235]
    v_exp_f32 v194, v194
    v_mfma_f32_16x16x32_bf16 v[204:207], a[144:147], a[48:51], v[232:235]
    v_add_f32 v238, v238, v192
    v_mfma_f32_16x16x32_bf16 v[196:199], a[148:151], a[36:39], v[196:199]
    v_exp_f32 v195, v195
    v_mfma_f32_16x16x32_bf16 v[204:207], a[148:151], a[52:55], v[204:207]
    buffer_load_dwordx4 v244, s[12:15], s23 offen offset:128 nt lds
    v_mfma_f32_16x16x32_bf16 v[196:199], a[152:155], a[40:43], v[196:199]
    s_add_u32 m0, s21, 98304
    v_add_f32 v238, v238, v193
    v_cvt_pk_bf16_f32 v192, v192, v193
    v_mfma_f32_16x16x32_bf16 v[204:207], a[152:155], a[56:59], v[204:207]
    s_mov_b32 s23, 49152
    v_exp_f32 v200, v200
    v_mfma_f32_16x16x32_bf16 v[196:199], a[156:159], a[44:47], v[196:199]
    v_add_f32 v238, v238, v194
    v_exp_f32 v201, v201
    v_mfma_f32_16x16x32_bf16 v[204:207], a[156:159], a[60:63], v[204:207]
    v_add_f32 v238, v238, v195
    v_cvt_pk_bf16_f32 v193, v194, v195
    v_mfma_f32_16x16x32_bf16 v[32:35], a[160:163], v[216:219], v[32:35]
    v_exp_f32 v202, v202
    v_mfma_f32_16x16x32_bf16 v[36:39], a[164:167], v[216:219], v[36:39]
    v_add_f32 v239, v239, v200
    v_add_u32 v224, 65536, v224
    v_mfma_f32_16x16x32_bf16 v[40:43], a[168:171], v[216:219], v[40:43]
    v_exp_f32 v203, v203
    v_mfma_f32_16x16x32_bf16 v[44:47], a[172:175], v[216:219], v[44:47]
    v_add_f32 v239, v239, v201
    v_cvt_pk_bf16_f32 v200, v200, v201
    v_mfma_f32_16x16x32_bf16 v[48:51], a[176:179], v[216:219], v[48:51]
    v_exp_f32 v196, v196
    v_mfma_f32_16x16x32_bf16 v[52:55], a[180:183], v[216:219], v[52:55]
    v_add_f32 v239, v239, v202
    v_add_u32 v225, 65536, v225
    v_mfma_f32_16x16x32_bf16 v[56:59], a[184:187], v[216:219], v[56:59]
    v_exp_f32 v197, v197
    v_add_f32 v239, v239, v203
    v_mfma_f32_16x16x32_bf16 v[60:63], a[188:191], v[216:219], v[60:63]
    buffer_load_dwordx4 v244, s[8:11], s23 offen offset:0 nt lds
    v_cvt_pk_bf16_f32 v201, v202, v203
    v_mfma_f32_16x16x32_bf16 v[208:211], a[128:131], a[64:67], v[232:235]
    s_add_u32 m0, s21, 102272
    v_exp_f32 v198, v198
    v_add_f32 v238, v238, v196
    v_mfma_f32_16x16x32_bf16 v[216:219], a[128:131], a[80:83], v[232:235]
    v_exp_f32 v199, v199
    v_mfma_f32_16x16x32_bf16 v[208:211], a[132:135], a[68:71], v[208:211]
    v_add_f32 v238, v238, v197
    v_cvt_pk_bf16_f32 v194, v196, v197
    v_mfma_f32_16x16x32_bf16 v[216:219], a[132:135], a[84:87], v[216:219]
    v_exp_f32 v204, v204
    v_mfma_f32_16x16x32_bf16 v[208:211], a[136:139], a[72:75], v[208:211]
    v_add_f32 v238, v238, v198
    v_exp_f32 v205, v205
    v_mfma_f32_16x16x32_bf16 v[216:219], a[136:139], a[88:91], v[216:219]
    v_add_f32 v238, v238, v199
    v_cvt_pk_bf16_f32 v195, v198, v199
    v_mfma_f32_16x16x32_bf16 v[208:211], a[140:143], a[76:79], v[208:211]
    v_exp_f32 v206, v206
    v_mfma_f32_16x16x32_bf16 v[216:219], a[140:143], a[92:95], v[216:219]
    v_add_f32 v239, v239, v204
    v_mfma_f32_16x16x32_bf16 v[64:67], a[160:163], v[192:195], v[64:67]
    buffer_load_dwordx4 v244, s[8:11], s23 offen offset:128 nt lds
    v_mfma_f32_16x16x32_bf16 v[68:71], a[164:167], v[192:195], v[68:71]
    v_exp_f32 v207, v207
    v_mfma_f32_16x16x32_bf16 v[72:75], a[168:171], v[192:195], v[72:75]
    v_add_f32 v239, v239, v205
    v_cvt_pk_bf16_f32 v202, v204, v205
    v_mfma_f32_16x16x32_bf16 v[76:79], a[172:175], v[192:195], v[76:79]
    v_add_f32 v239, v239, v206
    v_add_f32 v239, v239, v207
    v_mfma_f32_16x16x32_bf16 v[80:83], a[176:179], v[192:195], v[80:83]
    s_add_u32 m0, s21, 106496
    v_cvt_pk_bf16_f32 v203, v206, v207
    v_mfma_f32_16x16x32_bf16 v[84:87], a[180:183], v[192:195], v[84:87]
    v_exp_f32 v208, v208
    v_mfma_f32_16x16x32_bf16 v[88:91], a[184:187], v[192:195], v[88:91]
    v_exp_f32 v209, v209
    v_mfma_f32_16x16x32_bf16 v[92:95], a[188:191], v[192:195], v[92:95]
    s_waitcnt vmcnt(14)
    s_barrier
    v_exp_f32 v210, v210
    v_mfma_f32_16x16x32_bf16 v[212:215], a[144:147], a[64:67], v[232:235]
    s_waitcnt vmcnt(13)
    v_accvgpr_read_b32 v230, a96
    v_accvgpr_read_b32 v252, a97
    v_lshlrev_b32 v231, 16, v230
    v_mfma_f32_16x16x32_bf16 v[220:223], a[144:147], a[80:83], v[232:235]
    v_lshlrev_b32 v253, 16, v252
    v_and_b32 v230, 0xffff0000, v230
    v_and_b32 v252, 0xffff0000, v252
    v_mfma_f32_16x16x32_bf16 v[212:215], a[148:151], a[68:71], v[212:215]
    v_mul_f32 v230, s22, v230
    v_mul_f32 v231, s22, v231
    v_mul_f32 v252, s22, v252
    v_add_f32 v240, v240, v208
    v_mfma_f32_16x16x32_bf16 v[220:223], a[148:151], a[84:87], v[220:223]
    v_mul_f32 v253, s22, v253
    v_cvt_pk_bf16_f32 v230, v231, v230
    v_cvt_pk_bf16_f32 v252, v253, v252
    v_exp_f32 v211, v211
    v_mfma_f32_16x16x32_bf16 v[212:215], a[152:155], a[72:75], v[212:215]
    v_accvgpr_write_b32 a96, v230
    v_accvgpr_write_b32 a97, v252
    v_accvgpr_read_b32 v230, a98
    v_add_f32 v240, v240, v209
    v_cvt_pk_bf16_f32 v208, v208, v209
    v_mfma_f32_16x16x32_bf16 v[220:223], a[152:155], a[88:91], v[220:223]
    v_accvgpr_read_b32 v252, a99
    v_lshlrev_b32 v231, 16, v230
    v_lshlrev_b32 v253, 16, v252
    v_and_b32 v230, 0xffff0000, v230
    v_exp_f32 v216, v216
    v_mfma_f32_16x16x32_bf16 v[212:215], a[156:159], a[76:79], v[212:215]
    v_and_b32 v252, 0xffff0000, v252
    v_mul_f32 v230, s22, v230
    v_mul_f32 v231, s22, v231
    v_add_f32 v240, v240, v210
    v_mfma_f32_16x16x32_bf16 v[220:223], a[156:159], a[92:95], v[220:223]
    buffer_load_dwordx4 v244, s[12:15], s23 offen offset:0 nt lds
    v_mul_f32 v252, s22, v252
    v_mul_f32 v253, s22, v253
    v_cvt_pk_bf16_f32 v230, v231, v230
    v_exp_f32 v217, v217
    v_add_f32 v240, v240, v211
    v_mfma_f32_16x16x32_bf16 v[96:99], a[160:163], v[200:203], v[96:99]
    s_add_u32 m0, s21, 110464
    ds_read_b128 a[128:131], v224 offset:0
    v_cvt_pk_bf16_f32 v252, v253, v252
    v_accvgpr_write_b32 a98, v230
    v_accvgpr_write_b32 a99, v252
    v_cvt_pk_bf16_f32 v209, v210, v211
    v_mfma_f32_16x16x32_bf16 v[100:103], a[164:167], v[200:203], v[100:103]
    s_waitcnt vmcnt(13)
    v_accvgpr_read_b32 v230, a100
    v_accvgpr_read_b32 v252, a101
    v_lshlrev_b32 v231, 16, v230
    v_exp_f32 v218, v218
    v_add_f32 v241, v241, v216
    v_mfma_f32_16x16x32_bf16 v[104:107], a[168:171], v[200:203], v[104:107]
    ds_read_b128 a[132:135], v225 offset:0
    v_lshlrev_b32 v253, 16, v252
    v_and_b32 v230, 0xffff0000, v230
    v_and_b32 v252, 0xffff0000, v252
    v_mul_f32 v230, s22, v230
    v_exp_f32 v219, v219
    v_mfma_f32_16x16x32_bf16 v[108:111], a[172:175], v[200:203], v[108:111]
    v_mul_f32 v231, s22, v231
    v_mul_f32 v252, s22, v252
    v_mul_f32 v253, s22, v253
    v_add_f32 v241, v241, v217
    v_cvt_pk_bf16_f32 v216, v216, v217
    v_mfma_f32_16x16x32_bf16 v[112:115], a[176:179], v[200:203], v[112:115]
    ds_read_b128 a[136:139], v224 offset:4096
    v_cvt_pk_bf16_f32 v230, v231, v230
    v_cvt_pk_bf16_f32 v252, v253, v252
    v_accvgpr_write_b32 a100, v230
    v_exp_f32 v212, v212
    v_mfma_f32_16x16x32_bf16 v[116:119], a[180:183], v[200:203], v[116:119]
    v_accvgpr_write_b32 a101, v252
    v_accvgpr_read_b32 v230, a102
    v_accvgpr_read_b32 v252, a103
    v_add_f32 v241, v241, v218
    v_mfma_f32_16x16x32_bf16 v[120:123], a[184:187], v[200:203], v[120:123]
    ds_read_b128 a[140:143], v225 offset:4096
    v_lshlrev_b32 v231, 16, v230
    v_lshlrev_b32 v253, 16, v252
    v_and_b32 v230, 0xffff0000, v230
    v_exp_f32 v213, v213
    v_add_f32 v241, v241, v219
    v_mfma_f32_16x16x32_bf16 v[124:127], a[188:191], v[200:203], v[124:127]
    s_waitcnt lgkmcnt(1)
    v_and_b32 v252, 0xffff0000, v252
    v_mul_f32 v230, s22, v230
    v_mul_f32 v231, s22, v231
    v_mul_f32 v252, s22, v252
    v_cvt_pk_bf16_f32 v217, v218, v219
    v_mfma_f32_16x16x32_bf16 v[192:195], a[128:131], a[0:3], v[232:235]
    v_mul_f32 v253, s22, v253
    v_cvt_pk_bf16_f32 v230, v231, v230
    v_cvt_pk_bf16_f32 v252, v253, v252
    v_exp_f32 v214, v214
    v_add_f32 v240, v240, v212
    v_mfma_f32_16x16x32_bf16 v[200:203], a[128:131], a[16:19], v[232:235]
    s_waitcnt vmcnt(12)
    v_accvgpr_write_b32 a102, v230
    v_accvgpr_write_b32 a103, v252
    v_accvgpr_read_b32 v230, a104
    v_exp_f32 v215, v215
    v_mfma_f32_16x16x32_bf16 v[192:195], a[132:135], a[4:7], v[192:195]
    v_accvgpr_read_b32 v252, a105
    v_lshlrev_b32 v231, 16, v230
    v_lshlrev_b32 v253, 16, v252
    v_add_f32 v240, v240, v213
    v_cvt_pk_bf16_f32 v210, v212, v213
    v_mfma_f32_16x16x32_bf16 v[200:203], a[132:135], a[20:23], v[200:203]
    buffer_load_dwordx4 v244, s[12:15], s23 offen offset:128 nt lds
    v_and_b32 v230, 0xffff0000, v230
    v_and_b32 v252, 0xffff0000, v252
    v_mul_f32 v230, s22, v230
    v_exp_f32 v220, v220
    v_mfma_f32_16x16x32_bf16 v[192:195], a[136:139], a[8:11], v[192:195]
    s_add_u32 m0, s21, 114688
    v_mul_f32 v231, s22, v231
    v_mul_f32 v252, s22, v252
    v_mul_f32 v253, s22, v253
    v_cvt_pk_bf16_f32 v230, v231, v230
    v_add_f32 v240, v240, v214
    v_mfma_f32_16x16x32_bf16 v[200:203], a[136:139], a[24:27], v[200:203]
    s_waitcnt lgkmcnt(0)
    s_mov_b32 s23, 57344
    v_cvt_pk_bf16_f32 v252, v253, v252
    v_accvgpr_write_b32 a104, v230
    v_accvgpr_write_b32 a105, v252
    v_exp_f32 v221, v221
    v_add_f32 v240, v240, v215
    v_mfma_f32_16x16x32_bf16 v[192:195], a[140:143], a[12:15], v[192:195]
    v_accvgpr_read_b32 v230, a106
    v_accvgpr_read_b32 v252, a107
    v_lshlrev_b32 v231, 16, v230
    v_cvt_pk_bf16_f32 v211, v214, v215
    v_mfma_f32_16x16x32_bf16 v[200:203], a[140:143], a[28:31], v[200:203]
    v_lshlrev_b32 v253, 16, v252
    v_and_b32 v230, 0xffff0000, v230
    v_and_b32 v252, 0xffff0000, v252
    v_mfma_f32_16x16x32_bf16 v[128:131], a[160:163], v[208:211], v[128:131]
    ds_read_b128 a[144:147], v224 offset:2048
    v_mul_f32 v230, s22, v230
    v_mul_f32 v231, s22, v231
    v_mul_f32 v252, s22, v252
    v_mfma_f32_16x16x32_bf16 v[132:135], a[164:167], v[208:211], v[132:135]
    v_mul_f32 v253, s22, v253
    v_cvt_pk_bf16_f32 v230, v231, v230
    v_cvt_pk_bf16_f32 v252, v253, v252
    v_accvgpr_write_b32 a106, v230
    v_mfma_f32_16x16x32_bf16 v[136:139], a[168:171], v[208:211], v[136:139]
    s_waitcnt vmcnt(12)
    ds_read_b128 a[148:151], v225 offset:2048
    v_accvgpr_write_b32 a107, v252
    v_accvgpr_read_b32 v230, a108
    v_accvgpr_read_b32 v252, a109
    v_mfma_f32_16x16x32_bf16 v[140:143], a[172:175], v[208:211], v[140:143]
    v_lshlrev_b32 v231, 16, v230
    v_lshlrev_b32 v253, 16, v252
    v_and_b32 v230, 0xffff0000, v230
    v_exp_f32 v222, v222
    v_add_f32 v241, v241, v220
    v_mfma_f32_16x16x32_bf16 v[144:147], a[176:179], v[208:211], v[144:147]
    ds_read_b128 a[152:155], v224 offset:6144
    v_and_b32 v252, 0xffff0000, v252
    v_mul_f32 v230, s22, v230
    v_mul_f32 v231, s22, v231
    v_exp_f32 v223, v223
    v_mfma_f32_16x16x32_bf16 v[148:151], a[180:183], v[208:211], v[148:151]
    v_mul_f32 v252, s22, v252
    v_mul_f32 v253, s22, v253
    v_cvt_pk_bf16_f32 v230, v231, v230
    v_add_f32 v241, v241, v221
    v_cvt_pk_bf16_f32 v218, v220, v221
    v_mfma_f32_16x16x32_bf16 v[152:155], a[184:187], v[208:211], v[152:155]
    ds_read_b128 a[156:159], v225 offset:6144
    v_cvt_pk_bf16_f32 v252, v253, v252
    v_accvgpr_write_b32 a108, v230
    v_accvgpr_write_b32 a109, v252
    v_accvgpr_read_b32 v230, a110
    v_add_f32 v241, v241, v222
    v_add_f32 v241, v241, v223
    v_mfma_f32_16x16x32_bf16 v[156:159], a[188:191], v[208:211], v[156:159]
    s_waitcnt lgkmcnt(1)
    buffer_load_dwordx4 v244, s[8:11], s23 offen offset:0 nt lds
    v_accvgpr_read_b32 v252, a111
    v_lshlrev_b32 v231, 16, v230
    v_lshlrev_b32 v253, 16, v252
    v_cvt_pk_bf16_f32 v219, v222, v223
    v_mfma_f32_16x16x32_bf16 v[196:199], a[144:147], a[0:3], v[232:235]
    s_add_u32 m0, s21, 118656
    v_and_b32 v230, 0xffff0000, v230
    v_and_b32 v252, 0xffff0000, v252
    v_mul_f32 v230, s22, v230
    v_exp_f32 v192, v192
    v_mfma_f32_16x16x32_bf16 v[204:207], a[144:147], a[16:19], v[232:235]
    v_mul_f32 v231, s22, v231
    v_mul_f32 v252, s22, v252
    v_mul_f32 v253, s22, v253
    v_exp_f32 v193, v193
    v_mfma_f32_16x16x32_bf16 v[196:199], a[148:151], a[4:7], v[196:199]
    v_cvt_pk_bf16_f32 v230, v231, v230
    v_cvt_pk_bf16_f32 v252, v253, v252
    v_accvgpr_write_b32 a110, v230
    v_exp_f32 v194, v194
    v_add_f32 v236, v236, v192
    v_mfma_f32_16x16x32_bf16 v[204:207], a[148:151], a[20:23], v[204:207]
    s_waitcnt vmcnt(12)
    v_accvgpr_write_b32 a111, v252
    v_accvgpr_read_b32 v230, a112
    v_accvgpr_read_b32 v252, a113
    v_lshlrev_b32 v231, 16, v230
    v_exp_f32 v195, v195
    v_mfma_f32_16x16x32_bf16 v[196:199], a[152:155], a[8:11], v[196:199]
    v_lshlrev_b32 v253, 16, v252
    v_and_b32 v230, 0xffff0000, v230
    v_and_b32 v252, 0xffff0000, v252
    v_add_f32 v236, v236, v193
    v_cvt_pk_bf16_f32 v192, v192, v193
    v_mfma_f32_16x16x32_bf16 v[204:207], a[152:155], a[24:27], v[204:207]
    s_waitcnt lgkmcnt(0)
    v_mul_f32 v230, s22, v230
    v_mul_f32 v231, s22, v231
    v_mul_f32 v252, s22, v252
    v_exp_f32 v200, v200
    v_mfma_f32_16x16x32_bf16 v[196:199], a[156:159], a[12:15], v[196:199]
    v_mul_f32 v253, s22, v253
    v_cvt_pk_bf16_f32 v230, v231, v230
    v_cvt_pk_bf16_f32 v252, v253, v252
    v_add_f32 v236, v236, v194
    v_mfma_f32_16x16x32_bf16 v[204:207], a[156:159], a[28:31], v[204:207]
    v_accvgpr_write_b32 a112, v230
    v_accvgpr_write_b32 a113, v252
    v_accvgpr_read_b32 v230, a114
    v_exp_f32 v201, v201
    v_add_f32 v236, v236, v195
    v_add_u32 v226, 65536, v226
    v_add_u32 v227, 65536, v227
    v_add_u32 v228, 65536, v228
    v_add_u32 v229, 65536, v229
    v_mfma_f32_16x16x32_bf16 v[160:163], a[160:163], v[216:219], v[160:163]
    v_accvgpr_read_b32 v252, a115
    v_lshlrev_b32 v231, 16, v230
    v_lshlrev_b32 v253, 16, v252
    v_and_b32 v230, 0xffff0000, v230
    v_cvt_pk_bf16_f32 v193, v194, v195
    v_mfma_f32_16x16x32_bf16 v[164:167], a[164:167], v[216:219], v[164:167]
    ds_read_b64_tr_b16 a[160:161], v226 offset:8192
    ds_read_b64_tr_b16 a[162:163], v226 offset:10240
    v_and_b32 v252, 0xffff0000, v252
    v_mul_f32 v230, s22, v230
    v_mul_f32 v231, s22, v231
    v_exp_f32 v202, v202
    v_add_f32 v237, v237, v200
    v_mfma_f32_16x16x32_bf16 v[168:171], a[168:171], v[216:219], v[168:171]
    ds_read_b64_tr_b16 a[164:165], v227 offset:8192
    v_mul_f32 v252, s22, v252
    v_mul_f32 v253, s22, v253
    v_cvt_pk_bf16_f32 v230, v231, v230
    v_exp_f32 v203, v203
    v_mfma_f32_16x16x32_bf16 v[172:175], a[172:175], v[216:219], v[172:175]
    ds_read_b64_tr_b16 a[166:167], v227 offset:10240
    buffer_load_dwordx4 v244, s[8:11], s23 offen offset:128 nt lds
    v_cvt_pk_bf16_f32 v252, v253, v252
    v_accvgpr_write_b32 a114, v230
    v_accvgpr_write_b32 a115, v252
    v_add_f32 v237, v237, v201
    v_cvt_pk_bf16_f32 v200, v200, v201
    v_mfma_f32_16x16x32_bf16 v[176:179], a[176:179], v[216:219], v[176:179]
    s_waitcnt vmcnt(12)
    s_add_u32 m0, s21, 122880
    ds_read_b64_tr_b16 a[168:169], v228 offset:8192
    v_accvgpr_read_b32 v230, a116
    v_accvgpr_read_b32 v252, a117
    v_lshlrev_b32 v231, 16, v230
    v_exp_f32 v196, v196
    v_mfma_f32_16x16x32_bf16 v[180:183], a[180:183], v[216:219], v[180:183]
    ds_read_b64_tr_b16 a[170:171], v228 offset:10240
    v_lshlrev_b32 v253, 16, v252
    v_and_b32 v230, 0xffff0000, v230
    v_and_b32 v252, 0xffff0000, v252
    v_mul_f32 v230, s22, v230
    v_add_f32 v237, v237, v202
    v_mfma_f32_16x16x32_bf16 v[184:187], a[184:187], v[216:219], v[184:187]
    ds_read_b64_tr_b16 a[172:173], v229 offset:8192
    v_mul_f32 v231, s22, v231
    v_mul_f32 v252, s22, v252
    v_mul_f32 v253, s22, v253
    v_exp_f32 v197, v197
    v_add_f32 v237, v237, v203
    v_mfma_f32_16x16x32_bf16 v[188:191], a[188:191], v[216:219], v[188:191]
    ds_read_b64_tr_b16 a[174:175], v229 offset:10240
    v_cvt_pk_bf16_f32 v230, v231, v230
    v_cvt_pk_bf16_f32 v252, v253, v252
    v_accvgpr_write_b32 a116, v230
    v_cvt_pk_bf16_f32 v201, v202, v203
    v_mfma_f32_16x16x32_bf16 v[208:211], a[128:131], a[32:35], v[232:235]
    ds_read_b64_tr_b16 a[176:177], v226 offset:12288
    v_accvgpr_write_b32 a117, v252
    v_accvgpr_read_b32 v230, a118
    v_accvgpr_read_b32 v252, a119
    v_exp_f32 v198, v198
    v_add_f32 v236, v236, v196
    v_mfma_f32_16x16x32_bf16 v[216:219], a[128:131], a[48:51], v[232:235]
    ds_read_b64_tr_b16 a[178:179], v226 offset:14336
    v_lshlrev_b32 v231, 16, v230
    v_lshlrev_b32 v253, 16, v252
    v_and_b32 v230, 0xffff0000, v230
    v_exp_f32 v199, v199
    v_mfma_f32_16x16x32_bf16 v[208:211], a[132:135], a[36:39], v[208:211]
    ds_read_b64_tr_b16 a[180:181], v227 offset:12288
    v_and_b32 v252, 0xffff0000, v252
    v_mul_f32 v230, s22, v230
    v_mul_f32 v231, s22, v231
    v_mul_f32 v252, s22, v252
    v_add_f32 v236, v236, v197
    v_cvt_pk_bf16_f32 v194, v196, v197
    v_mfma_f32_16x16x32_bf16 v[216:219], a[132:135], a[52:55], v[216:219]
    ds_read_b64_tr_b16 a[182:183], v227 offset:14336
    v_mul_f32 v253, s22, v253
    v_cvt_pk_bf16_f32 v230, v231, v230
    v_cvt_pk_bf16_f32 v252, v253, v252
    v_exp_f32 v204, v204
    v_mfma_f32_16x16x32_bf16 v[208:211], a[136:139], a[40:43], v[208:211]
    s_waitcnt vmcnt(11)
    ds_read_b64_tr_b16 a[184:185], v228 offset:12288
    v_accvgpr_write_b32 a118, v230
    v_accvgpr_write_b32 a119, v252
    v_accvgpr_read_b32 v230, a120
    v_add_f32 v236, v236, v198
    v_mfma_f32_16x16x32_bf16 v[216:219], a[136:139], a[56:59], v[216:219]
    ds_read_b64_tr_b16 a[186:187], v228 offset:14336
    v_accvgpr_read_b32 v252, a121
    v_lshlrev_b32 v231, 16, v230
    v_lshlrev_b32 v253, 16, v252
    v_exp_f32 v205, v205
    v_add_f32 v236, v236, v199
    v_mfma_f32_16x16x32_bf16 v[208:211], a[140:143], a[44:47], v[208:211]
    ds_read_b64_tr_b16 a[188:189], v229 offset:12288
    v_and_b32 v230, 0xffff0000, v230
    v_and_b32 v252, 0xffff0000, v252
    v_mul_f32 v230, s22, v230
    v_cvt_pk_bf16_f32 v195, v198, v199
    v_mfma_f32_16x16x32_bf16 v[216:219], a[140:143], a[60:63], v[216:219]
    s_waitcnt lgkmcnt(2)
    ds_read_b64_tr_b16 a[190:191], v229 offset:14336
    buffer_load_dwordx4 v244, s[12:15], s23 offen offset:0 nt lds
    v_mul_f32 v231, s22, v231
    v_mul_f32 v252, s22, v252
    v_mul_f32 v253, s22, v253
    v_cvt_pk_bf16_f32 v230, v231, v230
    v_mfma_f32_16x16x32_bf16 v[0:3], a[160:163], v[192:195], v[0:3]
    s_add_u32 m0, s21, 126848
    v_cvt_pk_bf16_f32 v252, v253, v252
    v_accvgpr_write_b32 a120, v230
    v_accvgpr_write_b32 a121, v252
    v_mfma_f32_16x16x32_bf16 v[4:7], a[164:167], v[192:195], v[4:7]
    v_accvgpr_read_b32 v230, a122
    v_accvgpr_read_b32 v252, a123
    v_lshlrev_b32 v231, 16, v230
    v_mfma_f32_16x16x32_bf16 v[8:11], a[168:171], v[192:195], v[8:11]
    v_lshlrev_b32 v253, 16, v252
    v_and_b32 v230, 0xffff0000, v230
    v_and_b32 v252, 0xffff0000, v252
    v_mfma_f32_16x16x32_bf16 v[12:15], a[172:175], v[192:195], v[12:15]
    v_mul_f32 v230, s22, v230
    v_mul_f32 v231, s22, v231
    v_mul_f32 v252, s22, v252
    v_exp_f32 v206, v206
    v_add_f32 v237, v237, v204
    v_mfma_f32_16x16x32_bf16 v[16:19], a[176:179], v[192:195], v[16:19]
    v_mul_f32 v253, s22, v253
    v_cvt_pk_bf16_f32 v230, v231, v230
    v_cvt_pk_bf16_f32 v252, v253, v252
    v_accvgpr_write_b32 a122, v230
    v_exp_f32 v207, v207
    v_mfma_f32_16x16x32_bf16 v[20:23], a[180:183], v[192:195], v[20:23]
    s_waitcnt vmcnt(11) lgkmcnt(0)
    v_accvgpr_write_b32 a123, v252
    v_accvgpr_read_b32 v230, a124
    v_accvgpr_read_b32 v252, a125
    v_add_f32 v237, v237, v205
    v_cvt_pk_bf16_f32 v202, v204, v205
    v_mfma_f32_16x16x32_bf16 v[24:27], a[184:187], v[192:195], v[24:27]
    v_lshlrev_b32 v231, 16, v230
    v_lshlrev_b32 v253, 16, v252
    v_and_b32 v230, 0xffff0000, v230
    v_add_f32 v237, v237, v206
    v_add_f32 v237, v237, v207
    v_mfma_f32_16x16x32_bf16 v[28:31], a[188:191], v[192:195], v[28:31]
    v_and_b32 v252, 0xffff0000, v252
    v_mul_f32 v230, s22, v230
    v_mul_f32 v231, s22, v231
    v_cvt_pk_bf16_f32 v203, v206, v207
    v_mfma_f32_16x16x32_bf16 v[212:215], a[144:147], a[32:35], v[232:235]
    v_mul_f32 v252, s22, v252
    v_mul_f32 v253, s22, v253
    v_cvt_pk_bf16_f32 v230, v231, v230
    v_exp_f32 v208, v208
    v_mfma_f32_16x16x32_bf16 v[220:223], a[144:147], a[48:51], v[232:235]
    v_cvt_pk_bf16_f32 v252, v253, v252
    v_accvgpr_write_b32 a124, v230
    v_accvgpr_write_b32 a125, v252
    v_accvgpr_read_b32 v230, a126
    v_exp_f32 v209, v209
    v_mfma_f32_16x16x32_bf16 v[212:215], a[148:151], a[36:39], v[212:215]
    v_accvgpr_read_b32 v252, a127
    v_lshlrev_b32 v231, 16, v230
    v_lshlrev_b32 v253, 16, v252
    v_exp_f32 v210, v210
    v_add_f32 v238, v238, v208
    v_mfma_f32_16x16x32_bf16 v[220:223], a[148:151], a[52:55], v[220:223]
    buffer_load_dwordx4 v244, s[12:15], s23 offen offset:128 nt lds
    v_and_b32 v230, 0xffff0000, v230
    v_and_b32 v252, 0xffff0000, v252
    v_mul_f32 v230, s22, v230
    v_exp_f32 v211, v211
    v_mfma_f32_16x16x32_bf16 v[212:215], a[152:155], a[40:43], v[212:215]
    v_mul_f32 v231, s22, v231
    v_mul_f32 v252, s22, v252
    v_mul_f32 v253, s22, v253
    v_add_f32 v238, v238, v209
    v_cvt_pk_bf16_f32 v208, v208, v209
    v_mfma_f32_16x16x32_bf16 v[220:223], a[152:155], a[56:59], v[220:223]
    v_cvt_pk_bf16_f32 v230, v231, v230
    v_cvt_pk_bf16_f32 v252, v253, v252
    v_accvgpr_write_b32 a126, v230
    v_exp_f32 v216, v216
    v_mfma_f32_16x16x32_bf16 v[212:215], a[156:159], a[44:47], v[212:215]
    v_accvgpr_write_b32 a127, v252
    v_add_f32 v238, v238, v210
    v_mfma_f32_16x16x32_bf16 v[220:223], a[156:159], a[60:63], v[220:223]
    v_exp_f32 v217, v217
    v_add_f32 v238, v238, v211
    v_mfma_f32_16x16x32_bf16 v[32:35], a[160:163], v[200:203], v[32:35]
    ds_write_b128 v254, a[96:99] offset:0
    v_cvt_pk_bf16_f32 v209, v210, v211
    v_mfma_f32_16x16x32_bf16 v[36:39], a[164:167], v[200:203], v[36:39]
    v_exp_f32 v218, v218
    v_add_f32 v239, v239, v216
    v_mfma_f32_16x16x32_bf16 v[40:43], a[168:171], v[200:203], v[40:43]
    ds_write_b128 v254, a[100:103] offset:4096
    v_exp_f32 v219, v219
    v_mfma_f32_16x16x32_bf16 v[44:47], a[172:175], v[200:203], v[44:47]
    v_add_f32 v239, v239, v217
    v_cvt_pk_bf16_f32 v216, v216, v217
    v_mfma_f32_16x16x32_bf16 v[48:51], a[176:179], v[200:203], v[48:51]
    ds_write_b128 v255, a[104:107] offset:0
    v_exp_f32 v212, v212
    v_mfma_f32_16x16x32_bf16 v[52:55], a[180:183], v[200:203], v[52:55]
    ds_write_b128 v255, a[108:111] offset:4096
    v_add_f32 v239, v239, v218
    v_mfma_f32_16x16x32_bf16 v[56:59], a[184:187], v[200:203], v[56:59]
    v_exp_f32 v213, v213
    v_add_f32 v239, v239, v219
    v_mfma_f32_16x16x32_bf16 v[60:63], a[188:191], v[200:203], v[60:63]
    ds_write_b128 v254, a[112:115] offset:2048
    v_cvt_pk_bf16_f32 v217, v218, v219
    v_mfma_f32_16x16x32_bf16 v[192:195], a[128:131], a[64:67], v[232:235]
    v_exp_f32 v214, v214
    v_add_f32 v238, v238, v212
    v_mfma_f32_16x16x32_bf16 v[200:203], a[128:131], a[80:83], v[232:235]
    v_exp_f32 v215, v215
    v_mfma_f32_16x16x32_bf16 v[192:195], a[132:135], a[68:71], v[192:195]
    ds_write_b128 v254, a[116:119] offset:6144
    v_add_f32 v238, v238, v213
    v_cvt_pk_bf16_f32 v210, v212, v213
    v_mfma_f32_16x16x32_bf16 v[200:203], a[132:135], a[84:87], v[200:203]
    v_exp_f32 v220, v220
    v_mfma_f32_16x16x32_bf16 v[192:195], a[136:139], a[72:75], v[192:195]
    ds_write_b128 v255, a[120:123] offset:2048
    v_add_f32 v238, v238, v214
    v_mfma_f32_16x16x32_bf16 v[200:203], a[136:139], a[88:91], v[200:203]
    v_exp_f32 v221, v221
    v_add_f32 v238, v238, v215
    v_mfma_f32_16x16x32_bf16 v[192:195], a[140:143], a[76:79], v[192:195]
    ds_write_b128 v255, a[124:127] offset:6144
    v_cvt_pk_bf16_f32 v211, v214, v215
    v_mfma_f32_16x16x32_bf16 v[200:203], a[140:143], a[92:95], v[200:203]
    ds_read_b128 a[96:99], v250 offset:32768
    v_mfma_f32_16x16x32_bf16 v[64:67], a[160:163], v[208:211], v[64:67]
    ds_read_b128 a[112:115], v250 offset:34816
    v_mfma_f32_16x16x32_bf16 v[68:71], a[164:167], v[208:211], v[68:71]
    v_exp_f32 v222, v222
    v_mfma_f32_16x16x32_bf16 v[72:75], a[168:171], v[208:211], v[72:75]
    ds_read_b128 a[100:103], v251 offset:32768
    v_add_f32 v239, v239, v220
    v_mfma_f32_16x16x32_bf16 v[76:79], a[172:175], v[208:211], v[76:79]
    v_exp_f32 v223, v223
    v_mfma_f32_16x16x32_bf16 v[80:83], a[176:179], v[208:211], v[80:83]
    v_add_f32 v239, v239, v221
    v_cvt_pk_bf16_f32 v218, v220, v221
    v_mfma_f32_16x16x32_bf16 v[84:87], a[180:183], v[208:211], v[84:87]
    ds_read_b128 a[116:119], v251 offset:34816
    v_add_f32 v239, v239, v222
    v_mfma_f32_16x16x32_bf16 v[88:91], a[184:187], v[208:211], v[88:91]
    v_add_f32 v239, v239, v223
    v_cvt_pk_bf16_f32 v219, v222, v223
    v_mfma_f32_16x16x32_bf16 v[92:95], a[188:191], v[208:211], v[92:95]
    ds_read_b128 a[104:107], v250 offset:36864
    v_exp_f32 v192, v192
    v_mfma_f32_16x16x32_bf16 v[196:199], a[144:147], a[64:67], v[232:235]
    v_exp_f32 v193, v193
    v_mfma_f32_16x16x32_bf16 v[204:207], a[144:147], a[80:83], v[232:235]
    ds_read_b128 a[120:123], v250 offset:38912
    v_exp_f32 v194, v194
    v_mfma_f32_16x16x32_bf16 v[196:199], a[148:151], a[68:71], v[196:199]
    ds_read_b128 a[108:111], v251 offset:36864
    v_add_f32 v240, v240, v192
    v_mfma_f32_16x16x32_bf16 v[204:207], a[148:151], a[84:87], v[204:207]
    v_exp_f32 v195, v195
    v_mfma_f32_16x16x32_bf16 v[196:199], a[152:155], a[72:75], v[196:199]
    v_add_f32 v240, v240, v193
    v_cvt_pk_bf16_f32 v192, v192, v193
    v_mfma_f32_16x16x32_bf16 v[204:207], a[152:155], a[88:91], v[204:207]
    v_exp_f32 v200, v200
    v_mfma_f32_16x16x32_bf16 v[196:199], a[156:159], a[76:79], v[196:199]
    s_waitcnt lgkmcnt(2)
    ds_read_b128 a[124:127], v251 offset:38912
    v_add_f32 v240, v240, v194
    v_mfma_f32_16x16x32_bf16 v[204:207], a[156:159], a[92:95], v[204:207]
    v_exp_f32 v201, v201
    v_add_f32 v240, v240, v195
    v_mfma_f32_16x16x32_bf16 v[96:99], a[160:163], v[216:219], v[96:99]
    v_cvt_pk_bf16_f32 v193, v194, v195
    v_exp_f32 v202, v202
    v_mfma_f32_16x16x32_bf16 v[100:103], a[164:167], v[216:219], v[100:103]
    v_add_f32 v241, v241, v200
    v_exp_f32 v203, v203
    v_mfma_f32_16x16x32_bf16 v[104:107], a[168:171], v[216:219], v[104:107]
    v_add_f32 v241, v241, v201
    v_cvt_pk_bf16_f32 v200, v200, v201
    v_mfma_f32_16x16x32_bf16 v[108:111], a[172:175], v[216:219], v[108:111]
    v_exp_f32 v196, v196
    v_mfma_f32_16x16x32_bf16 v[112:115], a[176:179], v[216:219], v[112:115]
    v_add_f32 v241, v241, v202
    v_mfma_f32_16x16x32_bf16 v[116:119], a[180:183], v[216:219], v[116:119]
    v_exp_f32 v197, v197
    v_mfma_f32_16x16x32_bf16 v[120:123], a[184:187], v[216:219], v[120:123]
    v_add_f32 v241, v241, v203
    v_cvt_pk_bf16_f32 v201, v202, v203
    v_mfma_f32_16x16x32_bf16 v[124:127], a[188:191], v[216:219], v[124:127]
    v_exp_f32 v198, v198
    v_mfma_f32_16x16x32_bf16 v[208:211], a[128:131], a[96:99], v[232:235]
    v_add_f32 v240, v240, v196
    v_exp_f32 v199, v199
    v_mfma_f32_16x16x32_bf16 v[216:219], a[128:131], a[112:115], v[232:235]
    v_add_f32 v240, v240, v197
    v_cvt_pk_bf16_f32 v194, v196, v197
    v_mfma_f32_16x16x32_bf16 v[208:211], a[132:135], a[100:103], v[208:211]
    v_exp_f32 v204, v204
    v_mfma_f32_16x16x32_bf16 v[216:219], a[132:135], a[116:119], v[216:219]
    v_add_f32 v240, v240, v198
    v_mfma_f32_16x16x32_bf16 v[208:211], a[136:139], a[104:107], v[208:211]
    s_waitcnt lgkmcnt(0)
    v_exp_f32 v205, v205
    v_mfma_f32_16x16x32_bf16 v[216:219], a[136:139], a[120:123], v[216:219]
    v_add_f32 v240, v240, v199
    v_cvt_pk_bf16_f32 v195, v198, v199
    v_mfma_f32_16x16x32_bf16 v[208:211], a[140:143], a[108:111], v[208:211]
    v_exp_f32 v206, v206
    v_mfma_f32_16x16x32_bf16 v[216:219], a[140:143], a[124:127], v[216:219]
    v_add_f32 v241, v241, v204
    v_mfma_f32_16x16x32_bf16 v[128:131], a[160:163], v[192:195], v[128:131]
    v_exp_f32 v207, v207
    v_mfma_f32_16x16x32_bf16 v[132:135], a[164:167], v[192:195], v[132:135]
    v_add_f32 v241, v241, v205
    v_cvt_pk_bf16_f32 v202, v204, v205
    v_mfma_f32_16x16x32_bf16 v[136:139], a[168:171], v[192:195], v[136:139]
    v_add_f32 v241, v241, v206
    v_add_f32 v241, v241, v207
    v_mfma_f32_16x16x32_bf16 v[140:143], a[172:175], v[192:195], v[140:143]
    v_cvt_pk_bf16_f32 v203, v206, v207
    v_mfma_f32_16x16x32_bf16 v[144:147], a[176:179], v[192:195], v[144:147]
    v_exp_f32 v208, v208
    v_mfma_f32_16x16x32_bf16 v[148:151], a[180:183], v[192:195], v[148:151]
    v_exp_f32 v209, v209
    v_mfma_f32_16x16x32_bf16 v[152:155], a[184:187], v[192:195], v[152:155]
    v_exp_f32 v210, v210
    v_mfma_f32_16x16x32_bf16 v[156:159], a[188:191], v[192:195], v[156:159]
    s_waitcnt vmcnt(8)
    s_barrier
    v_add_f32 v242, v242, v208
    v_mfma_f32_16x16x32_bf16 v[212:215], a[144:147], a[96:99], v[232:235]
    s_add_u32 m0, s21, 65536
    v_exp_f32 v211, v211
    v_mfma_f32_16x16x32_bf16 v[220:223], a[144:147], a[112:115], v[232:235]
    s_mov_b32 s23, 65536
    v_add_f32 v242, v242, v209
    v_cvt_pk_bf16_f32 v208, v208, v209
    v_mfma_f32_16x16x32_bf16 v[212:215], a[148:151], a[100:103], v[212:215]
    v_exp_f32 v216, v216
    v_mfma_f32_16x16x32_bf16 v[220:223], a[148:151], a[116:119], v[220:223]
    ds_read_b128 a[128:131], v224 offset:16384
    v_add_f32 v242, v242, v210
    v_mfma_f32_16x16x32_bf16 v[212:215], a[152:155], a[104:107], v[212:215]
    v_exp_f32 v217, v217
    v_mfma_f32_16x16x32_bf16 v[220:223], a[152:155], a[120:123], v[220:223]
    v_add_f32 v242, v242, v211
    v_cvt_pk_bf16_f32 v209, v210, v211
    v_mfma_f32_16x16x32_bf16 v[212:215], a[156:159], a[108:111], v[212:215]
    v_exp_f32 v218, v218
    v_mfma_f32_16x16x32_bf16 v[220:223], a[156:159], a[124:127], v[220:223]
    ds_read_b128 a[132:135], v225 offset:16384
    v_add_f32 v243, v243, v216
    v_mfma_f32_16x16x32_bf16 v[160:163], a[160:163], v[200:203], v[160:163]
    v_exp_f32 v219, v219
    v_mfma_f32_16x16x32_bf16 v[164:167], a[164:167], v[200:203], v[164:167]
    v_add_f32 v243, v243, v217
    v_cvt_pk_bf16_f32 v216, v216, v217
    v_mfma_f32_16x16x32_bf16 v[168:171], a[168:171], v[200:203], v[168:171]
    buffer_load_dwordx4 v244, s[8:11], s23 offen offset:0 nt lds
    v_mfma_f32_16x16x32_bf16 v[172:175], a[172:175], v[200:203], v[172:175]
    ds_read_b128 a[136:139], v224 offset:20480
    ds_read_b128 a[140:143], v225 offset:20480
    v_mfma_f32_16x16x32_bf16 v[176:179], a[176:179], v[200:203], v[176:179]
    s_add_u32 m0, s21, 69504
    v_exp_f32 v212, v212
    v_mfma_f32_16x16x32_bf16 v[180:183], a[180:183], v[200:203], v[180:183]
    ds_read_b128 a[144:147], v224 offset:18432
    v_add_f32 v243, v243, v218
    v_mfma_f32_16x16x32_bf16 v[184:187], a[184:187], v[200:203], v[184:187]
    v_exp_f32 v213, v213
    v_add_f32 v243, v243, v219
    v_mfma_f32_16x16x32_bf16 v[188:191], a[188:191], v[200:203], v[188:191]
    s_waitcnt lgkmcnt(3)
    ds_read_b128 a[148:151], v225 offset:18432
    v_cvt_pk_bf16_f32 v217, v218, v219
    v_mfma_f32_16x16x32_bf16 v[192:195], a[128:131], a[0:3], v[232:235]
    v_exp_f32 v214, v214
    v_add_f32 v242, v242, v212
    v_mfma_f32_16x16x32_bf16 v[200:203], a[128:131], a[16:19], v[232:235]
    v_exp_f32 v215, v215
    v_mfma_f32_16x16x32_bf16 v[192:195], a[132:135], a[4:7], v[192:195]
    v_add_f32 v242, v242, v213
    v_cvt_pk_bf16_f32 v210, v212, v213
    v_mfma_f32_16x16x32_bf16 v[200:203], a[132:135], a[20:23], v[200:203]
    s_waitcnt lgkmcnt(1)
    v_exp_f32 v220, v220
    v_mfma_f32_16x16x32_bf16 v[192:195], a[136:139], a[8:11], v[192:195]
    ds_read_b128 a[152:155], v224 offset:22528
    v_add_f32 v242, v242, v214
    v_mfma_f32_16x16x32_bf16 v[200:203], a[136:139], a[24:27], v[200:203]
    v_exp_f32 v221, v221
    v_add_f32 v242, v242, v215
    v_mfma_f32_16x16x32_bf16 v[192:195], a[140:143], a[12:15], v[192:195]
    ds_read_b128 a[156:159], v225 offset:22528
    v_cvt_pk_bf16_f32 v211, v214, v215
    v_mfma_f32_16x16x32_bf16 v[200:203], a[140:143], a[28:31], v[200:203]
    buffer_load_dwordx4 v244, s[8:11], s23 offen offset:128 nt lds
    v_mfma_f32_16x16x32_bf16 a[192:195], a[160:163], v[208:211], 0
    s_add_u32 m0, s21, 73728
    v_exp_f32 v222, v222
    v_mfma_f32_16x16x32_bf16 a[196:199], a[164:167], v[208:211], 0
    v_add_f32 v243, v243, v220
    v_mfma_f32_16x16x32_bf16 a[200:203], a[168:171], v[208:211], 0
    v_exp_f32 v223, v223
    v_mfma_f32_16x16x32_bf16 a[204:207], a[172:175], v[208:211], 0
    v_add_f32 v243, v243, v221
    v_cvt_pk_bf16_f32 v218, v220, v221
    v_mfma_f32_16x16x32_bf16 a[208:211], a[176:179], v[208:211], 0
    v_add_f32 v243, v243, v222
    v_add_f32 v243, v243, v223
    v_mfma_f32_16x16x32_bf16 a[212:215], a[180:183], v[208:211], 0
    v_cvt_pk_bf16_f32 v219, v222, v223
    v_mfma_f32_16x16x32_bf16 a[216:219], a[184:187], v[208:211], 0
    v_exp_f32 v192, v192
    v_mfma_f32_16x16x32_bf16 a[220:223], a[188:191], v[208:211], 0
    v_exp_f32 v193, v193
    v_mfma_f32_16x16x32_bf16 v[196:199], a[144:147], a[0:3], v[232:235]
    v_exp_f32 v194, v194
    v_mfma_f32_16x16x32_bf16 v[204:207], a[144:147], a[16:19], v[232:235]
    s_waitcnt lgkmcnt(0)
    v_add_f32 v236, v236, v192
    v_mfma_f32_16x16x32_bf16 v[196:199], a[148:151], a[4:7], v[196:199]
    v_exp_f32 v195, v195
    v_mfma_f32_16x16x32_bf16 v[204:207], a[148:151], a[20:23], v[204:207]
    buffer_load_dwordx4 v244, s[12:15], s23 offen offset:0 nt lds
    v_mfma_f32_16x16x32_bf16 v[196:199], a[152:155], a[8:11], v[196:199]
    s_add_u32 m0, s21, 77696
    v_add_f32 v236, v236, v193
    v_cvt_pk_bf16_f32 v192, v192, v193
    v_mfma_f32_16x16x32_bf16 v[204:207], a[152:155], a[24:27], v[204:207]
    v_exp_f32 v200, v200
    v_mfma_f32_16x16x32_bf16 v[196:199], a[156:159], a[12:15], v[196:199]
    v_add_f32 v236, v236, v194
    v_exp_f32 v201, v201
    v_mfma_f32_16x16x32_bf16 v[204:207], a[156:159], a[28:31], v[204:207]
    v_add_f32 v236, v236, v195
    v_cvt_pk_bf16_f32 v193, v194, v195
    v_mfma_f32_16x16x32_bf16 a[224:227], a[160:163], v[216:219], 0
    v_exp_f32 v202, v202
    v_mfma_f32_16x16x32_bf16 a[228:231], a[164:167], v[216:219], 0
    ds_read_b64_tr_b16 a[160:161], v226 offset:24576
    ds_read_b64_tr_b16 a[162:163], v226 offset:26624
    v_add_f32 v237, v237, v200
    v_mfma_f32_16x16x32_bf16 a[232:235], a[168:171], v[216:219], 0
    ds_read_b64_tr_b16 a[164:165], v227 offset:24576
    v_exp_f32 v203, v203
    v_mfma_f32_16x16x32_bf16 a[236:239], a[172:175], v[216:219], 0
    ds_read_b64_tr_b16 a[166:167], v227 offset:26624
    v_add_f32 v237, v237, v201
    v_cvt_pk_bf16_f32 v200, v200, v201
    v_mfma_f32_16x16x32_bf16 a[240:243], a[176:179], v[216:219], 0
    ds_read_b64_tr_b16 a[168:169], v228 offset:24576
    v_exp_f32 v196, v196
    v_mfma_f32_16x16x32_bf16 a[244:247], a[180:183], v[216:219], 0
    ds_read_b64_tr_b16 a[170:171], v228 offset:26624
    v_add_f32 v237, v237, v202
    v_mfma_f32_16x16x32_bf16 a[248:251], a[184:187], v[216:219], 0
    ds_read_b64_tr_b16 a[172:173], v229 offset:24576
    v_exp_f32 v197, v197
    v_add_f32 v237, v237, v203
    v_mfma_f32_16x16x32_bf16 a[252:255], a[188:191], v[216:219], 0
    ds_read_b64_tr_b16 a[174:175], v229 offset:26624
    buffer_load_dwordx4 v244, s[12:15], s23 offen offset:128 nt lds
    v_cvt_pk_bf16_f32 v201, v202, v203
    v_mfma_f32_16x16x32_bf16 v[208:211], a[128:131], a[32:35], v[232:235]
    ds_read_b64_tr_b16 a[176:177], v226 offset:28672
    v_exp_f32 v198, v198
    v_add_f32 v236, v236, v196
    v_mfma_f32_16x16x32_bf16 v[216:219], a[128:131], a[48:51], v[232:235]
    ds_read_b64_tr_b16 a[178:179], v226 offset:30720
    v_exp_f32 v199, v199
    v_mfma_f32_16x16x32_bf16 v[208:211], a[132:135], a[36:39], v[208:211]
    ds_read_b64_tr_b16 a[180:181], v227 offset:28672
    v_add_f32 v236, v236, v197
    v_cvt_pk_bf16_f32 v194, v196, v197
    v_mfma_f32_16x16x32_bf16 v[216:219], a[132:135], a[52:55], v[216:219]
    ds_read_b64_tr_b16 a[182:183], v227 offset:30720
    v_exp_f32 v204, v204
    v_mfma_f32_16x16x32_bf16 v[208:211], a[136:139], a[40:43], v[208:211]
    ds_read_b64_tr_b16 a[184:185], v228 offset:28672
    v_add_f32 v236, v236, v198
    v_mfma_f32_16x16x32_bf16 v[216:219], a[136:139], a[56:59], v[216:219]
    ds_read_b64_tr_b16 a[186:187], v228 offset:30720
    v_exp_f32 v205, v205
    v_add_f32 v236, v236, v199
    v_mfma_f32_16x16x32_bf16 v[208:211], a[140:143], a[44:47], v[208:211]
    ds_read_b64_tr_b16 a[188:189], v229 offset:28672
    v_cvt_pk_bf16_f32 v195, v198, v199
    v_mfma_f32_16x16x32_bf16 v[216:219], a[140:143], a[60:63], v[216:219]
    s_waitcnt lgkmcnt(4)
    ds_read_b64_tr_b16 a[190:191], v229 offset:30720
    v_mfma_f32_16x16x32_bf16 v[0:3], a[160:163], v[192:195], v[0:3]
    v_exp_f32 v206, v206
    v_mfma_f32_16x16x32_bf16 v[4:7], a[164:167], v[192:195], v[4:7]
    v_add_f32 v237, v237, v204
    v_mfma_f32_16x16x32_bf16 v[8:11], a[168:171], v[192:195], v[8:11]
    v_exp_f32 v207, v207
    v_mfma_f32_16x16x32_bf16 v[12:15], a[172:175], v[192:195], v[12:15]
    v_add_f32 v237, v237, v205
    v_cvt_pk_bf16_f32 v202, v204, v205
    v_mfma_f32_16x16x32_bf16 v[16:19], a[176:179], v[192:195], v[16:19]
    s_waitcnt lgkmcnt(1)
    v_add_f32 v237, v237, v206
    v_add_f32 v237, v237, v207
    v_mfma_f32_16x16x32_bf16 v[20:23], a[180:183], v[192:195], v[20:23]
    v_cvt_pk_bf16_f32 v203, v206, v207
    v_mfma_f32_16x16x32_bf16 v[24:27], a[184:187], v[192:195], v[24:27]
    s_waitcnt lgkmcnt(0)
    v_exp_f32 v208, v208
    v_mfma_f32_16x16x32_bf16 v[28:31], a[188:191], v[192:195], v[28:31]
    v_exp_f32 v209, v209
    v_mfma_f32_16x16x32_bf16 v[212:215], a[144:147], a[32:35], v[232:235]
    v_exp_f32 v210, v210
    v_mfma_f32_16x16x32_bf16 v[220:223], a[144:147], a[48:51], v[232:235]
    v_add_f32 v238, v238, v208
    v_mfma_f32_16x16x32_bf16 v[212:215], a[148:151], a[36:39], v[212:215]
    v_exp_f32 v211, v211
    v_mfma_f32_16x16x32_bf16 v[220:223], a[148:151], a[52:55], v[220:223]
    v_add_f32 v238, v238, v209
    v_cvt_pk_bf16_f32 v208, v208, v209
    v_mfma_f32_16x16x32_bf16 v[212:215], a[152:155], a[40:43], v[212:215]
    v_exp_f32 v216, v216
    v_mfma_f32_16x16x32_bf16 v[220:223], a[152:155], a[56:59], v[220:223]
    v_add_f32 v238, v238, v210
    v_mfma_f32_16x16x32_bf16 v[212:215], a[156:159], a[44:47], v[212:215]
    v_exp_f32 v217, v217
    v_mfma_f32_16x16x32_bf16 v[220:223], a[156:159], a[60:63], v[220:223]
    v_add_f32 v238, v238, v211
    v_cvt_pk_bf16_f32 v209, v210, v211
    v_mfma_f32_16x16x32_bf16 v[32:35], a[160:163], v[200:203], v[32:35]
    v_exp_f32 v218, v218
    v_mfma_f32_16x16x32_bf16 v[36:39], a[164:167], v[200:203], v[36:39]
    v_add_f32 v239, v239, v216
    v_exp_f32 v219, v219
    v_mfma_f32_16x16x32_bf16 v[40:43], a[168:171], v[200:203], v[40:43]
    v_add_f32 v239, v239, v217
    v_cvt_pk_bf16_f32 v216, v216, v217
    v_mfma_f32_16x16x32_bf16 v[44:47], a[172:175], v[200:203], v[44:47]
    v_exp_f32 v212, v212
    v_mfma_f32_16x16x32_bf16 v[48:51], a[176:179], v[200:203], v[48:51]
    v_add_f32 v239, v239, v218
    v_mfma_f32_16x16x32_bf16 v[52:55], a[180:183], v[200:203], v[52:55]
    v_exp_f32 v213, v213
    v_mfma_f32_16x16x32_bf16 v[56:59], a[184:187], v[200:203], v[56:59]
    v_add_f32 v239, v239, v219
    v_cvt_pk_bf16_f32 v217, v218, v219
    v_mfma_f32_16x16x32_bf16 v[60:63], a[188:191], v[200:203], v[60:63]
    v_exp_f32 v214, v214
    v_mfma_f32_16x16x32_bf16 v[192:195], a[128:131], a[64:67], v[232:235]
    v_add_f32 v238, v238, v212
    v_exp_f32 v215, v215
    v_mfma_f32_16x16x32_bf16 v[200:203], a[128:131], a[80:83], v[232:235]
    v_add_f32 v238, v238, v213
    v_cvt_pk_bf16_f32 v210, v212, v213
    v_mfma_f32_16x16x32_bf16 v[192:195], a[132:135], a[68:71], v[192:195]
    v_exp_f32 v220, v220
    v_mfma_f32_16x16x32_bf16 v[200:203], a[132:135], a[84:87], v[200:203]
    v_add_f32 v238, v238, v214
    v_mfma_f32_16x16x32_bf16 v[192:195], a[136:139], a[72:75], v[192:195]
    v_exp_f32 v221, v221
    v_mfma_f32_16x16x32_bf16 v[200:203], a[136:139], a[88:91], v[200:203]
    v_add_f32 v238, v238, v215
    v_cvt_pk_bf16_f32 v211, v214, v215
    v_mfma_f32_16x16x32_bf16 v[192:195], a[140:143], a[76:79], v[192:195]
    v_exp_f32 v222, v222
    v_mfma_f32_16x16x32_bf16 v[200:203], a[140:143], a[92:95], v[200:203]
    v_add_f32 v239, v239, v220
    v_mfma_f32_16x16x32_bf16 v[64:67], a[160:163], v[208:211], v[64:67]
    v_exp_f32 v223, v223
    v_mfma_f32_16x16x32_bf16 v[68:71], a[164:167], v[208:211], v[68:71]
    v_add_f32 v239, v239, v221
    v_cvt_pk_bf16_f32 v218, v220, v221
    v_mfma_f32_16x16x32_bf16 v[72:75], a[168:171], v[208:211], v[72:75]
    v_add_f32 v239, v239, v222
    v_add_f32 v239, v239, v223
    v_mfma_f32_16x16x32_bf16 v[76:79], a[172:175], v[208:211], v[76:79]
    v_cvt_pk_bf16_f32 v219, v222, v223
    v_mfma_f32_16x16x32_bf16 v[80:83], a[176:179], v[208:211], v[80:83]
    v_exp_f32 v192, v192
    v_mfma_f32_16x16x32_bf16 v[84:87], a[180:183], v[208:211], v[84:87]
    v_exp_f32 v193, v193
    v_mfma_f32_16x16x32_bf16 v[88:91], a[184:187], v[208:211], v[88:91]
    v_exp_f32 v194, v194
    v_mfma_f32_16x16x32_bf16 v[92:95], a[188:191], v[208:211], v[92:95]
    v_add_f32 v240, v240, v192
    v_mfma_f32_16x16x32_bf16 v[196:199], a[144:147], a[64:67], v[232:235]
    v_exp_f32 v195, v195
    v_mfma_f32_16x16x32_bf16 v[204:207], a[144:147], a[80:83], v[232:235]
    v_add_f32 v240, v240, v193
    v_cvt_pk_bf16_f32 v192, v192, v193
    v_mfma_f32_16x16x32_bf16 v[196:199], a[148:151], a[68:71], v[196:199]
    v_exp_f32 v200, v200
    v_mfma_f32_16x16x32_bf16 v[204:207], a[148:151], a[84:87], v[204:207]
    v_add_f32 v240, v240, v194
    v_mfma_f32_16x16x32_bf16 v[196:199], a[152:155], a[72:75], v[196:199]
    v_exp_f32 v201, v201
    v_mfma_f32_16x16x32_bf16 v[204:207], a[152:155], a[88:91], v[204:207]
    v_add_f32 v240, v240, v195
    v_cvt_pk_bf16_f32 v193, v194, v195
    v_mfma_f32_16x16x32_bf16 v[196:199], a[156:159], a[76:79], v[196:199]
    v_exp_f32 v202, v202
    v_mfma_f32_16x16x32_bf16 v[204:207], a[156:159], a[92:95], v[204:207]
    v_add_f32 v241, v241, v200
    v_mfma_f32_16x16x32_bf16 v[96:99], a[160:163], v[216:219], v[96:99]
    v_exp_f32 v203, v203
    v_mfma_f32_16x16x32_bf16 v[100:103], a[164:167], v[216:219], v[100:103]
    v_add_f32 v241, v241, v201
    v_cvt_pk_bf16_f32 v200, v200, v201
    v_mfma_f32_16x16x32_bf16 v[104:107], a[168:171], v[216:219], v[104:107]
    v_mfma_f32_16x16x32_bf16 v[108:111], a[172:175], v[216:219], v[108:111]
    v_exp_f32 v196, v196
    v_mfma_f32_16x16x32_bf16 v[112:115], a[176:179], v[216:219], v[112:115]
    v_add_f32 v241, v241, v202
    v_mfma_f32_16x16x32_bf16 v[116:119], a[180:183], v[216:219], v[116:119]
    v_exp_f32 v197, v197
    v_mfma_f32_16x16x32_bf16 v[120:123], a[184:187], v[216:219], v[120:123]
    v_add_f32 v241, v241, v203
    v_cvt_pk_bf16_f32 v201, v202, v203
    v_mfma_f32_16x16x32_bf16 v[124:127], a[188:191], v[216:219], v[124:127]
    v_exp_f32 v198, v198
    v_mfma_f32_16x16x32_bf16 v[208:211], a[128:131], a[96:99], v[232:235]
    v_add_f32 v240, v240, v196
    v_exp_f32 v199, v199
    v_mfma_f32_16x16x32_bf16 v[216:219], a[128:131], a[112:115], v[232:235]
    v_add_f32 v240, v240, v197
    v_cvt_pk_bf16_f32 v194, v196, v197
    v_mfma_f32_16x16x32_bf16 v[208:211], a[132:135], a[100:103], v[208:211]
    v_exp_f32 v204, v204
    v_mfma_f32_16x16x32_bf16 v[216:219], a[132:135], a[116:119], v[216:219]
    v_add_f32 v240, v240, v198
    v_mfma_f32_16x16x32_bf16 v[208:211], a[136:139], a[104:107], v[208:211]
    v_exp_f32 v205, v205
    v_mfma_f32_16x16x32_bf16 v[216:219], a[136:139], a[120:123], v[216:219]
    v_add_f32 v240, v240, v199
    v_cvt_pk_bf16_f32 v195, v198, v199
    v_mfma_f32_16x16x32_bf16 v[208:211], a[140:143], a[108:111], v[208:211]
    v_exp_f32 v206, v206
    v_mfma_f32_16x16x32_bf16 v[216:219], a[140:143], a[124:127], v[216:219]
    v_add_f32 v241, v241, v204
    v_mfma_f32_16x16x32_bf16 v[128:131], a[160:163], v[192:195], v[128:131]
    v_exp_f32 v207, v207
    v_mfma_f32_16x16x32_bf16 v[132:135], a[164:167], v[192:195], v[132:135]
    v_add_f32 v241, v241, v205
    v_cvt_pk_bf16_f32 v202, v204, v205
    v_mfma_f32_16x16x32_bf16 v[136:139], a[168:171], v[192:195], v[136:139]
    v_add_f32 v241, v241, v206
    v_add_f32 v241, v241, v207
    v_mfma_f32_16x16x32_bf16 v[140:143], a[172:175], v[192:195], v[140:143]
    v_cvt_pk_bf16_f32 v203, v206, v207
    v_mfma_f32_16x16x32_bf16 v[144:147], a[176:179], v[192:195], v[144:147]
    v_exp_f32 v208, v208
    v_mfma_f32_16x16x32_bf16 v[148:151], a[180:183], v[192:195], v[148:151]
    v_exp_f32 v209, v209
    v_mfma_f32_16x16x32_bf16 v[152:155], a[184:187], v[192:195], v[152:155]
    v_exp_f32 v210, v210
    v_mfma_f32_16x16x32_bf16 v[156:159], a[188:191], v[192:195], v[156:159]
    s_waitcnt vmcnt(8)
    s_barrier
    v_add_f32 v242, v242, v208
    v_mfma_f32_16x16x32_bf16 v[212:215], a[144:147], a[96:99], v[232:235]
    s_add_u32 m0, s21, 81920
    v_exp_f32 v211, v211
    v_mfma_f32_16x16x32_bf16 v[220:223], a[144:147], a[112:115], v[232:235]
    s_mov_b32 s23, 73728
    v_add_f32 v242, v242, v209
    v_cvt_pk_bf16_f32 v208, v208, v209
    v_mfma_f32_16x16x32_bf16 v[212:215], a[148:151], a[100:103], v[212:215]
    v_exp_f32 v216, v216
    v_mfma_f32_16x16x32_bf16 v[220:223], a[148:151], a[116:119], v[220:223]
    ds_read_b128 a[128:131], v224 offset:32768
    v_add_f32 v242, v242, v210
    v_mfma_f32_16x16x32_bf16 v[212:215], a[152:155], a[104:107], v[212:215]
    v_exp_f32 v217, v217
    v_mfma_f32_16x16x32_bf16 v[220:223], a[152:155], a[120:123], v[220:223]
    v_add_f32 v242, v242, v211
    v_cvt_pk_bf16_f32 v209, v210, v211
    v_mfma_f32_16x16x32_bf16 v[212:215], a[156:159], a[108:111], v[212:215]
    v_exp_f32 v218, v218
    v_mfma_f32_16x16x32_bf16 v[220:223], a[156:159], a[124:127], v[220:223]
    ds_read_b128 a[132:135], v225 offset:32768
    v_add_f32 v243, v243, v216
    v_mfma_f32_16x16x32_bf16 v[160:163], a[160:163], v[200:203], v[160:163]
    v_exp_f32 v219, v219
    v_mfma_f32_16x16x32_bf16 v[164:167], a[164:167], v[200:203], v[164:167]
    v_add_f32 v243, v243, v217
    v_cvt_pk_bf16_f32 v216, v216, v217
    v_mfma_f32_16x16x32_bf16 v[168:171], a[168:171], v[200:203], v[168:171]
    buffer_load_dwordx4 v244, s[8:11], s23 offen offset:0 nt lds
    v_mfma_f32_16x16x32_bf16 v[172:175], a[172:175], v[200:203], v[172:175]
    ds_read_b128 a[136:139], v224 offset:36864
    ds_read_b128 a[140:143], v225 offset:36864
    v_mfma_f32_16x16x32_bf16 v[176:179], a[176:179], v[200:203], v[176:179]
    s_add_u32 m0, s21, 85888
    v_exp_f32 v212, v212
    v_mfma_f32_16x16x32_bf16 v[180:183], a[180:183], v[200:203], v[180:183]
    ds_read_b128 a[144:147], v224 offset:34816
    v_add_f32 v243, v243, v218
    v_mfma_f32_16x16x32_bf16 v[184:187], a[184:187], v[200:203], v[184:187]
    v_exp_f32 v213, v213
    v_add_f32 v243, v243, v219
    v_mfma_f32_16x16x32_bf16 v[188:191], a[188:191], v[200:203], v[188:191]
    s_waitcnt lgkmcnt(3)
    ds_read_b128 a[148:151], v225 offset:34816
    v_cvt_pk_bf16_f32 v217, v218, v219
    v_mfma_f32_16x16x32_bf16 v[192:195], a[128:131], a[0:3], v[232:235]
    v_exp_f32 v214, v214
    v_add_f32 v242, v242, v212
    v_mfma_f32_16x16x32_bf16 v[200:203], a[128:131], a[16:19], v[232:235]
    v_exp_f32 v215, v215
    v_mfma_f32_16x16x32_bf16 v[192:195], a[132:135], a[4:7], v[192:195]
    v_add_f32 v242, v242, v213
    v_cvt_pk_bf16_f32 v210, v212, v213
    v_mfma_f32_16x16x32_bf16 v[200:203], a[132:135], a[20:23], v[200:203]
    s_waitcnt lgkmcnt(1)
    v_exp_f32 v220, v220
    v_mfma_f32_16x16x32_bf16 v[192:195], a[136:139], a[8:11], v[192:195]
    ds_read_b128 a[152:155], v224 offset:38912
    v_add_f32 v242, v242, v214
    v_mfma_f32_16x16x32_bf16 v[200:203], a[136:139], a[24:27], v[200:203]
    v_exp_f32 v221, v221
    v_add_f32 v242, v242, v215
    v_mfma_f32_16x16x32_bf16 v[192:195], a[140:143], a[12:15], v[192:195]
    ds_read_b128 a[156:159], v225 offset:38912
    v_cvt_pk_bf16_f32 v211, v214, v215
    v_mfma_f32_16x16x32_bf16 v[200:203], a[140:143], a[28:31], v[200:203]
    buffer_load_dwordx4 v244, s[8:11], s23 offen offset:128 nt lds
    v_mfma_f32_16x16x32_bf16 a[192:195], a[160:163], v[208:211], a[192:195]
    s_add_u32 m0, s21, 90112
    v_exp_f32 v222, v222
    v_mfma_f32_16x16x32_bf16 a[196:199], a[164:167], v[208:211], a[196:199]
    v_add_f32 v243, v243, v220
    v_mfma_f32_16x16x32_bf16 a[200:203], a[168:171], v[208:211], a[200:203]
    v_exp_f32 v223, v223
    v_mfma_f32_16x16x32_bf16 a[204:207], a[172:175], v[208:211], a[204:207]
    v_add_f32 v243, v243, v221
    v_cvt_pk_bf16_f32 v218, v220, v221
    v_mfma_f32_16x16x32_bf16 a[208:211], a[176:179], v[208:211], a[208:211]
    v_add_f32 v243, v243, v222
    v_add_f32 v243, v243, v223
    v_mfma_f32_16x16x32_bf16 a[212:215], a[180:183], v[208:211], a[212:215]
    v_cvt_pk_bf16_f32 v219, v222, v223
    v_mfma_f32_16x16x32_bf16 a[216:219], a[184:187], v[208:211], a[216:219]
    v_exp_f32 v192, v192
    v_mfma_f32_16x16x32_bf16 a[220:223], a[188:191], v[208:211], a[220:223]
    v_exp_f32 v193, v193
    v_mfma_f32_16x16x32_bf16 v[196:199], a[144:147], a[0:3], v[232:235]
    v_exp_f32 v194, v194
    v_mfma_f32_16x16x32_bf16 v[204:207], a[144:147], a[16:19], v[232:235]
    s_waitcnt lgkmcnt(0)
    v_add_f32 v236, v236, v192
    v_mfma_f32_16x16x32_bf16 v[196:199], a[148:151], a[4:7], v[196:199]
    v_exp_f32 v195, v195
    v_mfma_f32_16x16x32_bf16 v[204:207], a[148:151], a[20:23], v[204:207]
    buffer_load_dwordx4 v244, s[12:15], s23 offen offset:0 nt lds
    v_mfma_f32_16x16x32_bf16 v[196:199], a[152:155], a[8:11], v[196:199]
    s_add_u32 m0, s21, 94080
    v_add_f32 v236, v236, v193
    v_cvt_pk_bf16_f32 v192, v192, v193
    v_mfma_f32_16x16x32_bf16 v[204:207], a[152:155], a[24:27], v[204:207]
    v_exp_f32 v200, v200
    v_mfma_f32_16x16x32_bf16 v[196:199], a[156:159], a[12:15], v[196:199]
    v_add_f32 v236, v236, v194
    v_exp_f32 v201, v201
    v_mfma_f32_16x16x32_bf16 v[204:207], a[156:159], a[28:31], v[204:207]
    v_add_f32 v236, v236, v195
    v_cvt_pk_bf16_f32 v193, v194, v195
    v_mfma_f32_16x16x32_bf16 a[224:227], a[160:163], v[216:219], a[224:227]
    v_exp_f32 v202, v202
    v_mfma_f32_16x16x32_bf16 a[228:231], a[164:167], v[216:219], a[228:231]
    ds_read_b64_tr_b16 a[160:161], v226 offset:40960
    ds_read_b64_tr_b16 a[162:163], v226 offset:43008
    v_add_f32 v237, v237, v200
    v_mfma_f32_16x16x32_bf16 a[232:235], a[168:171], v[216:219], a[232:235]
    ds_read_b64_tr_b16 a[164:165], v227 offset:40960
    v_exp_f32 v203, v203
    v_mfma_f32_16x16x32_bf16 a[236:239], a[172:175], v[216:219], a[236:239]
    ds_read_b64_tr_b16 a[166:167], v227 offset:43008
    v_add_f32 v237, v237, v201
    v_cvt_pk_bf16_f32 v200, v200, v201
    v_mfma_f32_16x16x32_bf16 a[240:243], a[176:179], v[216:219], a[240:243]
    ds_read_b64_tr_b16 a[168:169], v228 offset:40960
    v_exp_f32 v196, v196
    v_mfma_f32_16x16x32_bf16 a[244:247], a[180:183], v[216:219], a[244:247]
    ds_read_b64_tr_b16 a[170:171], v228 offset:43008
    v_add_f32 v237, v237, v202
    v_mfma_f32_16x16x32_bf16 a[248:251], a[184:187], v[216:219], a[248:251]
    ds_read_b64_tr_b16 a[172:173], v229 offset:40960
    v_exp_f32 v197, v197
    v_add_f32 v237, v237, v203
    v_mfma_f32_16x16x32_bf16 a[252:255], a[188:191], v[216:219], a[252:255]
    ds_read_b64_tr_b16 a[174:175], v229 offset:43008
    buffer_load_dwordx4 v244, s[12:15], s23 offen offset:128 nt lds
    v_cvt_pk_bf16_f32 v201, v202, v203
    v_mfma_f32_16x16x32_bf16 v[208:211], a[128:131], a[32:35], v[232:235]
    ds_read_b64_tr_b16 a[176:177], v226 offset:45056
    v_exp_f32 v198, v198
    v_add_f32 v236, v236, v196
    v_mfma_f32_16x16x32_bf16 v[216:219], a[128:131], a[48:51], v[232:235]
    ds_read_b64_tr_b16 a[178:179], v226 offset:47104
    v_exp_f32 v199, v199
    v_mfma_f32_16x16x32_bf16 v[208:211], a[132:135], a[36:39], v[208:211]
    ds_read_b64_tr_b16 a[180:181], v227 offset:45056
    v_add_f32 v236, v236, v197
    v_cvt_pk_bf16_f32 v194, v196, v197
    v_mfma_f32_16x16x32_bf16 v[216:219], a[132:135], a[52:55], v[216:219]
    ds_read_b64_tr_b16 a[182:183], v227 offset:47104
    v_exp_f32 v204, v204
    v_mfma_f32_16x16x32_bf16 v[208:211], a[136:139], a[40:43], v[208:211]
    ds_read_b64_tr_b16 a[184:185], v228 offset:45056
    v_add_f32 v236, v236, v198
    v_mfma_f32_16x16x32_bf16 v[216:219], a[136:139], a[56:59], v[216:219]
    ds_read_b64_tr_b16 a[186:187], v228 offset:47104
    v_exp_f32 v205, v205
    v_add_f32 v236, v236, v199
    v_mfma_f32_16x16x32_bf16 v[208:211], a[140:143], a[44:47], v[208:211]
    ds_read_b64_tr_b16 a[188:189], v229 offset:45056
    v_cvt_pk_bf16_f32 v195, v198, v199
    v_mfma_f32_16x16x32_bf16 v[216:219], a[140:143], a[60:63], v[216:219]
    s_waitcnt lgkmcnt(4)
    ds_read_b64_tr_b16 a[190:191], v229 offset:47104
    v_mfma_f32_16x16x32_bf16 v[0:3], a[160:163], v[192:195], v[0:3]
    v_exp_f32 v206, v206
    v_mfma_f32_16x16x32_bf16 v[4:7], a[164:167], v[192:195], v[4:7]
    v_add_f32 v237, v237, v204
    v_mfma_f32_16x16x32_bf16 v[8:11], a[168:171], v[192:195], v[8:11]
    v_exp_f32 v207, v207
    v_mfma_f32_16x16x32_bf16 v[12:15], a[172:175], v[192:195], v[12:15]
    v_add_f32 v237, v237, v205
    v_cvt_pk_bf16_f32 v202, v204, v205
    v_mfma_f32_16x16x32_bf16 v[16:19], a[176:179], v[192:195], v[16:19]
    s_waitcnt lgkmcnt(1)
    v_add_f32 v237, v237, v206
    v_add_f32 v237, v237, v207
    v_mfma_f32_16x16x32_bf16 v[20:23], a[180:183], v[192:195], v[20:23]
    v_cvt_pk_bf16_f32 v203, v206, v207
    v_mfma_f32_16x16x32_bf16 v[24:27], a[184:187], v[192:195], v[24:27]
    s_waitcnt lgkmcnt(0)
    v_exp_f32 v208, v208
    v_mfma_f32_16x16x32_bf16 v[28:31], a[188:191], v[192:195], v[28:31]
    v_exp_f32 v209, v209
    v_mfma_f32_16x16x32_bf16 v[212:215], a[144:147], a[32:35], v[232:235]
    v_exp_f32 v210, v210
    v_mfma_f32_16x16x32_bf16 v[220:223], a[144:147], a[48:51], v[232:235]
    v_add_f32 v238, v238, v208
    v_mfma_f32_16x16x32_bf16 v[212:215], a[148:151], a[36:39], v[212:215]
    v_exp_f32 v211, v211
    v_mfma_f32_16x16x32_bf16 v[220:223], a[148:151], a[52:55], v[220:223]
    v_add_f32 v238, v238, v209
    v_cvt_pk_bf16_f32 v208, v208, v209
    v_mfma_f32_16x16x32_bf16 v[212:215], a[152:155], a[40:43], v[212:215]
    v_exp_f32 v216, v216
    v_mfma_f32_16x16x32_bf16 v[220:223], a[152:155], a[56:59], v[220:223]
    v_add_f32 v238, v238, v210
    v_mfma_f32_16x16x32_bf16 v[212:215], a[156:159], a[44:47], v[212:215]
    v_exp_f32 v217, v217
    v_mfma_f32_16x16x32_bf16 v[220:223], a[156:159], a[60:63], v[220:223]
    v_add_f32 v238, v238, v211
    v_cvt_pk_bf16_f32 v209, v210, v211
    v_mfma_f32_16x16x32_bf16 v[32:35], a[160:163], v[200:203], v[32:35]
    v_exp_f32 v218, v218
    v_mfma_f32_16x16x32_bf16 v[36:39], a[164:167], v[200:203], v[36:39]
    v_add_f32 v239, v239, v216
    v_exp_f32 v219, v219
    v_mfma_f32_16x16x32_bf16 v[40:43], a[168:171], v[200:203], v[40:43]
    v_add_f32 v239, v239, v217
    v_cvt_pk_bf16_f32 v216, v216, v217
    v_mfma_f32_16x16x32_bf16 v[44:47], a[172:175], v[200:203], v[44:47]
    v_exp_f32 v212, v212
    v_mfma_f32_16x16x32_bf16 v[48:51], a[176:179], v[200:203], v[48:51]
    v_add_f32 v239, v239, v218
    v_mfma_f32_16x16x32_bf16 v[52:55], a[180:183], v[200:203], v[52:55]
    v_exp_f32 v213, v213
    v_mfma_f32_16x16x32_bf16 v[56:59], a[184:187], v[200:203], v[56:59]
    v_add_f32 v239, v239, v219
    v_cvt_pk_bf16_f32 v217, v218, v219
    v_mfma_f32_16x16x32_bf16 v[60:63], a[188:191], v[200:203], v[60:63]
    v_exp_f32 v214, v214
    v_mfma_f32_16x16x32_bf16 v[192:195], a[128:131], a[64:67], v[232:235]
    v_add_f32 v238, v238, v212
    v_exp_f32 v215, v215
    v_mfma_f32_16x16x32_bf16 v[200:203], a[128:131], a[80:83], v[232:235]
    v_add_f32 v238, v238, v213
    v_cvt_pk_bf16_f32 v210, v212, v213
    v_mfma_f32_16x16x32_bf16 v[192:195], a[132:135], a[68:71], v[192:195]
    v_exp_f32 v220, v220
    v_mfma_f32_16x16x32_bf16 v[200:203], a[132:135], a[84:87], v[200:203]
    v_add_f32 v238, v238, v214
    v_mfma_f32_16x16x32_bf16 v[192:195], a[136:139], a[72:75], v[192:195]
    v_exp_f32 v221, v221
    v_mfma_f32_16x16x32_bf16 v[200:203], a[136:139], a[88:91], v[200:203]
    v_add_f32 v238, v238, v215
    v_cvt_pk_bf16_f32 v211, v214, v215
    v_mfma_f32_16x16x32_bf16 v[192:195], a[140:143], a[76:79], v[192:195]
    v_exp_f32 v222, v222
    v_mfma_f32_16x16x32_bf16 v[200:203], a[140:143], a[92:95], v[200:203]
    v_add_f32 v239, v239, v220
    v_mfma_f32_16x16x32_bf16 v[64:67], a[160:163], v[208:211], v[64:67]
    v_exp_f32 v223, v223
    v_mfma_f32_16x16x32_bf16 v[68:71], a[164:167], v[208:211], v[68:71]
    v_add_f32 v239, v239, v221
    v_cvt_pk_bf16_f32 v218, v220, v221
    v_mfma_f32_16x16x32_bf16 v[72:75], a[168:171], v[208:211], v[72:75]
    v_add_f32 v239, v239, v222
    v_add_f32 v239, v239, v223
    v_mfma_f32_16x16x32_bf16 v[76:79], a[172:175], v[208:211], v[76:79]
    v_cvt_pk_bf16_f32 v219, v222, v223
    v_mfma_f32_16x16x32_bf16 v[80:83], a[176:179], v[208:211], v[80:83]
    v_exp_f32 v192, v192
    v_mfma_f32_16x16x32_bf16 v[84:87], a[180:183], v[208:211], v[84:87]
    v_exp_f32 v193, v193
    v_mfma_f32_16x16x32_bf16 v[88:91], a[184:187], v[208:211], v[88:91]
    v_exp_f32 v194, v194
    v_mfma_f32_16x16x32_bf16 v[92:95], a[188:191], v[208:211], v[92:95]
    s_waitcnt vmcnt(8)
    s_barrier
    v_add_f32 v240, v240, v192
    v_mfma_f32_16x16x32_bf16 v[196:199], a[144:147], a[64:67], v[232:235]
    s_add_u32 m0, s21, 98304
    v_exp_f32 v195, v195
    v_mfma_f32_16x16x32_bf16 v[204:207], a[144:147], a[80:83], v[232:235]
    s_mov_b32 s23, 81920
    v_add_f32 v240, v240, v193
    v_cvt_pk_bf16_f32 v192, v192, v193
    v_mfma_f32_16x16x32_bf16 v[196:199], a[148:151], a[68:71], v[196:199]
    v_exp_f32 v200, v200
    v_mfma_f32_16x16x32_bf16 v[204:207], a[148:151], a[84:87], v[204:207]
    v_add_f32 v240, v240, v194
    v_mfma_f32_16x16x32_bf16 v[196:199], a[152:155], a[72:75], v[196:199]
    v_exp_f32 v201, v201
    v_mfma_f32_16x16x32_bf16 v[204:207], a[152:155], a[88:91], v[204:207]
    v_add_f32 v240, v240, v195
    v_cvt_pk_bf16_f32 v193, v194, v195
    v_mfma_f32_16x16x32_bf16 v[196:199], a[156:159], a[76:79], v[196:199]
    v_exp_f32 v202, v202
    v_mfma_f32_16x16x32_bf16 v[204:207], a[156:159], a[92:95], v[204:207]
    v_add_f32 v241, v241, v200
    v_mfma_f32_16x16x32_bf16 v[96:99], a[160:163], v[216:219], v[96:99]
    v_exp_f32 v203, v203
    v_mfma_f32_16x16x32_bf16 v[100:103], a[164:167], v[216:219], v[100:103]
    v_add_f32 v241, v241, v201
    v_cvt_pk_bf16_f32 v200, v200, v201
    v_mfma_f32_16x16x32_bf16 v[104:107], a[168:171], v[216:219], v[104:107]
    buffer_load_dwordx4 v244, s[8:11], s23 offen offset:0 nt lds
    v_mfma_f32_16x16x32_bf16 v[108:111], a[172:175], v[216:219], v[108:111]
    v_exp_f32 v196, v196
    v_mfma_f32_16x16x32_bf16 v[112:115], a[176:179], v[216:219], v[112:115]
    s_add_u32 m0, s21, 102272
    v_add_f32 v241, v241, v202
    v_mfma_f32_16x16x32_bf16 v[116:119], a[180:183], v[216:219], v[116:119]
    v_exp_f32 v197, v197
    v_mfma_f32_16x16x32_bf16 v[120:123], a[184:187], v[216:219], v[120:123]
    v_add_f32 v241, v241, v203
    v_cvt_pk_bf16_f32 v201, v202, v203
    v_mfma_f32_16x16x32_bf16 v[124:127], a[188:191], v[216:219], v[124:127]
    v_exp_f32 v198, v198
    v_mfma_f32_16x16x32_bf16 v[208:211], a[128:131], a[96:99], v[232:235]
    v_add_f32 v240, v240, v196
    v_exp_f32 v199, v199
    v_mfma_f32_16x16x32_bf16 v[216:219], a[128:131], a[112:115], v[232:235]
    v_add_f32 v240, v240, v197
    v_cvt_pk_bf16_f32 v194, v196, v197
    v_mfma_f32_16x16x32_bf16 v[208:211], a[132:135], a[100:103], v[208:211]
    v_exp_f32 v204, v204
    v_mfma_f32_16x16x32_bf16 v[216:219], a[132:135], a[116:119], v[216:219]
    ds_read_b128 a[128:131], v224 offset:49152
    v_add_f32 v240, v240, v198
    v_mfma_f32_16x16x32_bf16 v[208:211], a[136:139], a[104:107], v[208:211]
    v_exp_f32 v205, v205
    v_mfma_f32_16x16x32_bf16 v[216:219], a[136:139], a[120:123], v[216:219]
    v_add_f32 v240, v240, v199
    v_cvt_pk_bf16_f32 v195, v198, v199
    v_mfma_f32_16x16x32_bf16 v[208:211], a[140:143], a[108:111], v[208:211]
    buffer_load_dwordx4 v244, s[8:11], s23 offen offset:128 nt lds
    v_mfma_f32_16x16x32_bf16 v[216:219], a[140:143], a[124:127], v[216:219]
    v_exp_f32 v206, v206
    v_mfma_f32_16x16x32_bf16 v[128:131], a[160:163], v[192:195], v[128:131]
    s_add_u32 m0, s21, 106496
    ds_read_b128 a[132:135], v225 offset:49152
    v_add_f32 v241, v241, v204
    v_mfma_f32_16x16x32_bf16 v[132:135], a[164:167], v[192:195], v[132:135]
    v_exp_f32 v207, v207
    v_mfma_f32_16x16x32_bf16 v[136:139], a[168:171], v[192:195], v[136:139]
    v_add_f32 v241, v241, v205
    v_cvt_pk_bf16_f32 v202, v204, v205
    v_mfma_f32_16x16x32_bf16 v[140:143], a[172:175], v[192:195], v[140:143]
    v_add_f32 v241, v241, v206
    v_add_f32 v241, v241, v207
    v_mfma_f32_16x16x32_bf16 v[144:147], a[176:179], v[192:195], v[144:147]
    ds_read_b128 a[136:139], v224 offset:53248
    v_cvt_pk_bf16_f32 v203, v206, v207
    v_mfma_f32_16x16x32_bf16 v[148:151], a[180:183], v[192:195], v[148:151]
    v_exp_f32 v208, v208
    v_mfma_f32_16x16x32_bf16 v[152:155], a[184:187], v[192:195], v[152:155]
    v_exp_f32 v209, v209
    v_mfma_f32_16x16x32_bf16 v[156:159], a[188:191], v[192:195], v[156:159]
    v_exp_f32 v210, v210
    v_mfma_f32_16x16x32_bf16 v[212:215], a[144:147], a[96:99], v[232:235]
    ds_read_b128 a[140:143], v225 offset:53248
    v_add_f32 v242, v242, v208
    v_mfma_f32_16x16x32_bf16 v[220:223], a[144:147], a[112:115], v[232:235]
    v_exp_f32 v211, v211
    v_mfma_f32_16x16x32_bf16 v[212:215], a[148:151], a[100:103], v[212:215]
    buffer_load_dwordx4 v244, s[12:15], s23 offen offset:0 nt lds
    v_mfma_f32_16x16x32_bf16 v[220:223], a[148:151], a[116:119], v[220:223]
    v_add_f32 v242, v242, v209
    v_cvt_pk_bf16_f32 v208, v208, v209
    v_mfma_f32_16x16x32_bf16 v[212:215], a[152:155], a[104:107], v[212:215]
    s_add_u32 m0, s21, 110464
    v_exp_f32 v216, v216
    v_mfma_f32_16x16x32_bf16 v[220:223], a[152:155], a[120:123], v[220:223]
    ds_read_b128 a[144:147], v224 offset:51200
    v_add_f32 v242, v242, v210
    v_mfma_f32_16x16x32_bf16 v[212:215], a[156:159], a[108:111], v[212:215]
    v_exp_f32 v217, v217
    v_mfma_f32_16x16x32_bf16 v[220:223], a[156:159], a[124:127], v[220:223]
    v_add_f32 v242, v242, v211
    v_cvt_pk_bf16_f32 v209, v210, v211
    v_mfma_f32_16x16x32_bf16 v[160:163], a[160:163], v[200:203], v[160:163]
    v_exp_f32 v218, v218
    v_mfma_f32_16x16x32_bf16 v[164:167], a[164:167], v[200:203], v[164:167]
    ds_read_b128 a[148:151], v225 offset:51200
    v_add_f32 v243, v243, v216
    v_mfma_f32_16x16x32_bf16 v[168:171], a[168:171], v[200:203], v[168:171]
    v_exp_f32 v219, v219
    v_mfma_f32_16x16x32_bf16 v[172:175], a[172:175], v[200:203], v[172:175]
    v_add_f32 v243, v243, v217
    v_cvt_pk_bf16_f32 v216, v216, v217
    v_mfma_f32_16x16x32_bf16 v[176:179], a[176:179], v[200:203], v[176:179]
    v_exp_f32 v212, v212
    v_mfma_f32_16x16x32_bf16 v[180:183], a[180:183], v[200:203], v[180:183]
    ds_read_b128 a[152:155], v224 offset:55296
    v_add_f32 v243, v243, v218
    v_mfma_f32_16x16x32_bf16 v[184:187], a[184:187], v[200:203], v[184:187]
    v_exp_f32 v213, v213
    v_add_f32 v243, v243, v219
    v_mfma_f32_16x16x32_bf16 v[188:191], a[188:191], v[200:203], v[188:191]
    s_waitcnt lgkmcnt(1)
    buffer_load_dwordx4 v244, s[12:15], s23 offen offset:128 nt lds
    v_cvt_pk_bf16_f32 v217, v218, v219
    v_mfma_f32_16x16x32_bf16 v[192:195], a[128:131], a[0:3], v[232:235]
    v_exp_f32 v214, v214
    v_add_f32 v242, v242, v212
    v_mfma_f32_16x16x32_bf16 v[200:203], a[128:131], a[16:19], v[232:235]
    v_exp_f32 v215, v215
    v_mfma_f32_16x16x32_bf16 v[192:195], a[132:135], a[4:7], v[192:195]
    v_add_f32 v242, v242, v213
    v_cvt_pk_bf16_f32 v210, v212, v213
    v_mfma_f32_16x16x32_bf16 v[200:203], a[132:135], a[20:23], v[200:203]
    v_exp_f32 v220, v220
    v_mfma_f32_16x16x32_bf16 v[192:195], a[136:139], a[8:11], v[192:195]
    ds_read_b128 a[156:159], v225 offset:55296
    v_add_f32 v242, v242, v214
    v_mfma_f32_16x16x32_bf16 v[200:203], a[136:139], a[24:27], v[200:203]
    v_exp_f32 v221, v221
    v_add_f32 v242, v242, v215
    v_mfma_f32_16x16x32_bf16 v[192:195], a[140:143], a[12:15], v[192:195]
    v_cvt_pk_bf16_f32 v211, v214, v215
    v_mfma_f32_16x16x32_bf16 v[200:203], a[140:143], a[28:31], v[200:203]
    v_exp_f32 v222, v222
    v_mfma_f32_16x16x32_bf16 a[192:195], a[160:163], v[208:211], a[192:195]
    v_add_f32 v243, v243, v220
    v_mfma_f32_16x16x32_bf16 a[196:199], a[164:167], v[208:211], a[196:199]
    v_exp_f32 v223, v223
    v_mfma_f32_16x16x32_bf16 a[200:203], a[168:171], v[208:211], a[200:203]
    v_add_f32 v243, v243, v221
    v_cvt_pk_bf16_f32 v218, v220, v221
    v_mfma_f32_16x16x32_bf16 a[204:207], a[172:175], v[208:211], a[204:207]
    v_add_f32 v243, v243, v222
    v_add_f32 v243, v243, v223
    v_mfma_f32_16x16x32_bf16 a[208:211], a[176:179], v[208:211], a[208:211]
    v_cvt_pk_bf16_f32 v219, v222, v223
    v_mfma_f32_16x16x32_bf16 a[212:215], a[180:183], v[208:211], a[212:215]
    v_exp_f32 v192, v192
    v_mfma_f32_16x16x32_bf16 a[216:219], a[184:187], v[208:211], a[216:219]
    v_exp_f32 v193, v193
    v_mfma_f32_16x16x32_bf16 a[220:223], a[188:191], v[208:211], a[220:223]
    v_exp_f32 v194, v194
    v_mfma_f32_16x16x32_bf16 v[196:199], a[144:147], a[0:3], v[232:235]
    v_add_f32 v236, v236, v192
    v_mfma_f32_16x16x32_bf16 v[204:207], a[144:147], a[16:19], v[232:235]
    v_exp_f32 v195, v195
    v_mfma_f32_16x16x32_bf16 v[196:199], a[148:151], a[4:7], v[196:199]
    v_add_f32 v236, v236, v193
    v_cvt_pk_bf16_f32 v192, v192, v193
    v_mfma_f32_16x16x32_bf16 v[204:207], a[148:151], a[20:23], v[204:207]
    s_waitcnt lgkmcnt(0)
    v_exp_f32 v200, v200
    v_mfma_f32_16x16x32_bf16 v[196:199], a[152:155], a[8:11], v[196:199]
    v_add_f32 v236, v236, v194
    v_mfma_f32_16x16x32_bf16 v[204:207], a[152:155], a[24:27], v[204:207]
    v_exp_f32 v201, v201
    v_mfma_f32_16x16x32_bf16 v[196:199], a[156:159], a[12:15], v[196:199]
    v_add_f32 v236, v236, v195
    v_cvt_pk_bf16_f32 v193, v194, v195
    v_mfma_f32_16x16x32_bf16 v[204:207], a[156:159], a[28:31], v[204:207]
    v_exp_f32 v202, v202
    v_mfma_f32_16x16x32_bf16 a[224:227], a[160:163], v[216:219], a[224:227]
    ds_read_b64_tr_b16 a[160:161], v226 offset:57344
    v_add_f32 v237, v237, v200
    v_mfma_f32_16x16x32_bf16 a[228:231], a[164:167], v[216:219], a[228:231]
    ds_read_b64_tr_b16 a[162:163], v226 offset:59392
    ds_read_b64_tr_b16 a[164:165], v227 offset:57344
    v_mfma_f32_16x16x32_bf16 a[232:235], a[168:171], v[216:219], a[232:235]
    v_exp_f32 v203, v203
    v_mfma_f32_16x16x32_bf16 a[236:239], a[172:175], v[216:219], a[236:239]
    ds_read_b64_tr_b16 a[166:167], v227 offset:59392
    v_add_f32 v237, v237, v201
    v_cvt_pk_bf16_f32 v200, v200, v201
    v_mfma_f32_16x16x32_bf16 a[240:243], a[176:179], v[216:219], a[240:243]
    ds_read_b64_tr_b16 a[168:169], v228 offset:57344
    v_exp_f32 v196, v196
    v_mfma_f32_16x16x32_bf16 a[244:247], a[180:183], v[216:219], a[244:247]
    ds_read_b64_tr_b16 a[170:171], v228 offset:59392
    v_add_f32 v237, v237, v202
    v_mfma_f32_16x16x32_bf16 a[248:251], a[184:187], v[216:219], a[248:251]
    ds_read_b64_tr_b16 a[172:173], v229 offset:57344
    v_exp_f32 v197, v197
    v_add_f32 v237, v237, v203
    v_mfma_f32_16x16x32_bf16 a[252:255], a[188:191], v[216:219], a[252:255]
    ds_read_b64_tr_b16 a[174:175], v229 offset:59392
    v_cvt_pk_bf16_f32 v201, v202, v203
    v_mfma_f32_16x16x32_bf16 v[208:211], a[128:131], a[32:35], v[232:235]
    ds_read_b64_tr_b16 a[176:177], v226 offset:61440
    v_exp_f32 v198, v198
    v_add_f32 v236, v236, v196
    v_mfma_f32_16x16x32_bf16 v[216:219], a[128:131], a[48:51], v[232:235]
    ds_read_b64_tr_b16 a[178:179], v226 offset:63488
    v_exp_f32 v199, v199
    v_mfma_f32_16x16x32_bf16 v[208:211], a[132:135], a[36:39], v[208:211]
    ds_read_b64_tr_b16 a[180:181], v227 offset:61440
    v_add_f32 v236, v236, v197
    v_cvt_pk_bf16_f32 v194, v196, v197
    v_mfma_f32_16x16x32_bf16 v[216:219], a[132:135], a[52:55], v[216:219]
    ds_read_b64_tr_b16 a[182:183], v227 offset:63488
    v_exp_f32 v204, v204
    v_mfma_f32_16x16x32_bf16 v[208:211], a[136:139], a[40:43], v[208:211]
    ds_read_b64_tr_b16 a[184:185], v228 offset:61440
    v_add_f32 v236, v236, v198
    v_mfma_f32_16x16x32_bf16 v[216:219], a[136:139], a[56:59], v[216:219]
    ds_read_b64_tr_b16 a[186:187], v228 offset:63488
    v_exp_f32 v205, v205
    v_add_f32 v236, v236, v199
    v_mfma_f32_16x16x32_bf16 v[208:211], a[140:143], a[44:47], v[208:211]
    ds_read_b64_tr_b16 a[188:189], v229 offset:61440
    v_cvt_pk_bf16_f32 v195, v198, v199
    v_mfma_f32_16x16x32_bf16 v[216:219], a[140:143], a[60:63], v[216:219]
    s_waitcnt lgkmcnt(4)
    ds_read_b64_tr_b16 a[190:191], v229 offset:63488
    v_mfma_f32_16x16x32_bf16 v[0:3], a[160:163], v[192:195], v[0:3]
    v_exp_f32 v206, v206
    v_mfma_f32_16x16x32_bf16 v[4:7], a[164:167], v[192:195], v[4:7]
    v_add_f32 v237, v237, v204
    v_mfma_f32_16x16x32_bf16 v[8:11], a[168:171], v[192:195], v[8:11]
    v_exp_f32 v207, v207
    v_mfma_f32_16x16x32_bf16 v[12:15], a[172:175], v[192:195], v[12:15]
    v_add_f32 v237, v237, v205
    v_cvt_pk_bf16_f32 v202, v204, v205
    v_mfma_f32_16x16x32_bf16 v[16:19], a[176:179], v[192:195], v[16:19]
    s_waitcnt lgkmcnt(1)
    v_add_f32 v237, v237, v206
    v_add_f32 v237, v237, v207
    v_mfma_f32_16x16x32_bf16 v[20:23], a[180:183], v[192:195], v[20:23]
    v_cvt_pk_bf16_f32 v203, v206, v207
    v_mfma_f32_16x16x32_bf16 v[24:27], a[184:187], v[192:195], v[24:27]
    s_waitcnt lgkmcnt(0)
    v_exp_f32 v208, v208
    v_mfma_f32_16x16x32_bf16 v[28:31], a[188:191], v[192:195], v[28:31]
    v_exp_f32 v209, v209
    v_mfma_f32_16x16x32_bf16 v[212:215], a[144:147], a[32:35], v[232:235]
    v_exp_f32 v210, v210
    v_mfma_f32_16x16x32_bf16 v[220:223], a[144:147], a[48:51], v[232:235]
    v_add_f32 v238, v238, v208
    v_mfma_f32_16x16x32_bf16 v[212:215], a[148:151], a[36:39], v[212:215]
    v_exp_f32 v211, v211
    v_mfma_f32_16x16x32_bf16 v[220:223], a[148:151], a[52:55], v[220:223]
    v_add_f32 v238, v238, v209
    v_cvt_pk_bf16_f32 v208, v208, v209
    v_mfma_f32_16x16x32_bf16 v[212:215], a[152:155], a[40:43], v[212:215]
    v_exp_f32 v216, v216
    v_mfma_f32_16x16x32_bf16 v[220:223], a[152:155], a[56:59], v[220:223]
    v_add_f32 v238, v238, v210
    v_mfma_f32_16x16x32_bf16 v[212:215], a[156:159], a[44:47], v[212:215]
    v_exp_f32 v217, v217
    v_mfma_f32_16x16x32_bf16 v[220:223], a[156:159], a[60:63], v[220:223]
    v_add_f32 v238, v238, v211
    v_cvt_pk_bf16_f32 v209, v210, v211
    v_mfma_f32_16x16x32_bf16 v[32:35], a[160:163], v[200:203], v[32:35]
    v_exp_f32 v218, v218
    v_mfma_f32_16x16x32_bf16 v[36:39], a[164:167], v[200:203], v[36:39]
    v_add_f32 v239, v239, v216
    v_exp_f32 v219, v219
    v_mfma_f32_16x16x32_bf16 v[40:43], a[168:171], v[200:203], v[40:43]
    v_add_f32 v239, v239, v217
    v_cvt_pk_bf16_f32 v216, v216, v217
    v_mfma_f32_16x16x32_bf16 v[44:47], a[172:175], v[200:203], v[44:47]
    v_exp_f32 v212, v212
    v_mfma_f32_16x16x32_bf16 v[48:51], a[176:179], v[200:203], v[48:51]
    v_add_f32 v239, v239, v218
    v_mfma_f32_16x16x32_bf16 v[52:55], a[180:183], v[200:203], v[52:55]
    v_exp_f32 v213, v213
    v_mfma_f32_16x16x32_bf16 v[56:59], a[184:187], v[200:203], v[56:59]
    v_add_f32 v239, v239, v219
    v_cvt_pk_bf16_f32 v217, v218, v219
    v_mfma_f32_16x16x32_bf16 v[60:63], a[188:191], v[200:203], v[60:63]
    v_exp_f32 v214, v214
    v_mfma_f32_16x16x32_bf16 v[192:195], a[128:131], a[64:67], v[232:235]
    v_add_f32 v238, v238, v212
    v_exp_f32 v215, v215
    v_mfma_f32_16x16x32_bf16 v[200:203], a[128:131], a[80:83], v[232:235]
    v_add_f32 v238, v238, v213
    v_cvt_pk_bf16_f32 v210, v212, v213
    v_mfma_f32_16x16x32_bf16 v[192:195], a[132:135], a[68:71], v[192:195]
    v_exp_f32 v220, v220
    v_mfma_f32_16x16x32_bf16 v[200:203], a[132:135], a[84:87], v[200:203]
    v_add_f32 v238, v238, v214
    v_mfma_f32_16x16x32_bf16 v[192:195], a[136:139], a[72:75], v[192:195]
    v_exp_f32 v221, v221
    v_mfma_f32_16x16x32_bf16 v[200:203], a[136:139], a[88:91], v[200:203]
    v_add_f32 v238, v238, v215
    v_cvt_pk_bf16_f32 v211, v214, v215
    v_mfma_f32_16x16x32_bf16 v[192:195], a[140:143], a[76:79], v[192:195]
    v_exp_f32 v222, v222
    v_mfma_f32_16x16x32_bf16 v[200:203], a[140:143], a[92:95], v[200:203]
    v_add_f32 v239, v239, v220
    v_mfma_f32_16x16x32_bf16 v[64:67], a[160:163], v[208:211], v[64:67]
    v_exp_f32 v223, v223
    v_mfma_f32_16x16x32_bf16 v[68:71], a[164:167], v[208:211], v[68:71]
    v_add_f32 v239, v239, v221
    v_cvt_pk_bf16_f32 v218, v220, v221
    v_mfma_f32_16x16x32_bf16 v[72:75], a[168:171], v[208:211], v[72:75]
    v_add_f32 v239, v239, v222
    v_add_f32 v239, v239, v223
    v_mfma_f32_16x16x32_bf16 v[76:79], a[172:175], v[208:211], v[76:79]
    v_cvt_pk_bf16_f32 v219, v222, v223
    v_mfma_f32_16x16x32_bf16 v[80:83], a[176:179], v[208:211], v[80:83]
    v_exp_f32 v192, v192
    v_mfma_f32_16x16x32_bf16 v[84:87], a[180:183], v[208:211], v[84:87]
    v_exp_f32 v193, v193
    v_mfma_f32_16x16x32_bf16 v[88:91], a[184:187], v[208:211], v[88:91]
    v_exp_f32 v194, v194
    v_mfma_f32_16x16x32_bf16 v[92:95], a[188:191], v[208:211], v[92:95]
    s_waitcnt vmcnt(8)
    s_barrier
    v_add_f32 v240, v240, v192
    v_mfma_f32_16x16x32_bf16 v[196:199], a[144:147], a[64:67], v[232:235]
    s_add_u32 m0, s21, 114688
    v_exp_f32 v195, v195
    v_mfma_f32_16x16x32_bf16 v[204:207], a[144:147], a[80:83], v[232:235]
    s_mov_b32 s23, 90112
    v_add_f32 v240, v240, v193
    v_cvt_pk_bf16_f32 v192, v192, v193
    v_mfma_f32_16x16x32_bf16 v[196:199], a[148:151], a[68:71], v[196:199]
    v_exp_f32 v200, v200
    v_mfma_f32_16x16x32_bf16 v[204:207], a[148:151], a[84:87], v[204:207]
    v_add_f32 v240, v240, v194
    v_mfma_f32_16x16x32_bf16 v[196:199], a[152:155], a[72:75], v[196:199]
    v_exp_f32 v201, v201
    v_mfma_f32_16x16x32_bf16 v[204:207], a[152:155], a[88:91], v[204:207]
    v_add_f32 v240, v240, v195
    v_cvt_pk_bf16_f32 v193, v194, v195
    v_mfma_f32_16x16x32_bf16 v[196:199], a[156:159], a[76:79], v[196:199]
    v_exp_f32 v202, v202
    v_mfma_f32_16x16x32_bf16 v[204:207], a[156:159], a[92:95], v[204:207]
    v_add_f32 v241, v241, v200
    v_mfma_f32_16x16x32_bf16 v[96:99], a[160:163], v[216:219], v[96:99]
    v_exp_f32 v203, v203
    v_mfma_f32_16x16x32_bf16 v[100:103], a[164:167], v[216:219], v[100:103]
    v_add_f32 v241, v241, v201
    v_cvt_pk_bf16_f32 v200, v200, v201
    v_mfma_f32_16x16x32_bf16 v[104:107], a[168:171], v[216:219], v[104:107]
    buffer_load_dwordx4 v244, s[8:11], s23 offen offset:0 nt lds
    v_mfma_f32_16x16x32_bf16 v[108:111], a[172:175], v[216:219], v[108:111]
    v_exp_f32 v196, v196
    v_mfma_f32_16x16x32_bf16 v[112:115], a[176:179], v[216:219], v[112:115]
    s_add_u32 m0, s21, 118656
    v_add_f32 v241, v241, v202
    v_mfma_f32_16x16x32_bf16 v[116:119], a[180:183], v[216:219], v[116:119]
    v_exp_f32 v197, v197
    v_mfma_f32_16x16x32_bf16 v[120:123], a[184:187], v[216:219], v[120:123]
    v_add_f32 v241, v241, v203
    v_cvt_pk_bf16_f32 v201, v202, v203
    v_mfma_f32_16x16x32_bf16 v[124:127], a[188:191], v[216:219], v[124:127]
    v_exp_f32 v198, v198
    v_mfma_f32_16x16x32_bf16 v[208:211], a[128:131], a[96:99], v[232:235]
    v_add_f32 v240, v240, v196
    v_exp_f32 v199, v199
    v_mfma_f32_16x16x32_bf16 v[216:219], a[128:131], a[112:115], v[232:235]
    v_add_f32 v240, v240, v197
    v_cvt_pk_bf16_f32 v194, v196, v197
    v_mfma_f32_16x16x32_bf16 v[208:211], a[132:135], a[100:103], v[208:211]
    v_exp_f32 v204, v204
    v_mfma_f32_16x16x32_bf16 v[216:219], a[132:135], a[116:119], v[216:219]
    ds_read_b128 a[128:131], v224 offset:0
    v_add_f32 v240, v240, v198
    v_mfma_f32_16x16x32_bf16 v[208:211], a[136:139], a[104:107], v[208:211]
    v_exp_f32 v205, v205
    v_mfma_f32_16x16x32_bf16 v[216:219], a[136:139], a[120:123], v[216:219]
    v_add_f32 v240, v240, v199
    v_cvt_pk_bf16_f32 v195, v198, v199
    v_mfma_f32_16x16x32_bf16 v[208:211], a[140:143], a[108:111], v[208:211]
    buffer_load_dwordx4 v244, s[8:11], s23 offen offset:128 nt lds
    v_mfma_f32_16x16x32_bf16 v[216:219], a[140:143], a[124:127], v[216:219]
    v_exp_f32 v206, v206
    v_mfma_f32_16x16x32_bf16 v[128:131], a[160:163], v[192:195], v[128:131]
    s_add_u32 m0, s21, 122880
    ds_read_b128 a[132:135], v225 offset:0
    v_add_f32 v241, v241, v204
    v_mfma_f32_16x16x32_bf16 v[132:135], a[164:167], v[192:195], v[132:135]
    v_exp_f32 v207, v207
    v_mfma_f32_16x16x32_bf16 v[136:139], a[168:171], v[192:195], v[136:139]
    v_add_f32 v241, v241, v205
    v_cvt_pk_bf16_f32 v202, v204, v205
    v_mfma_f32_16x16x32_bf16 v[140:143], a[172:175], v[192:195], v[140:143]
    v_add_f32 v241, v241, v206
    v_add_f32 v241, v241, v207
    v_mfma_f32_16x16x32_bf16 v[144:147], a[176:179], v[192:195], v[144:147]
    ds_read_b128 a[136:139], v224 offset:4096
    v_cvt_pk_bf16_f32 v203, v206, v207
    v_mfma_f32_16x16x32_bf16 v[148:151], a[180:183], v[192:195], v[148:151]
    v_exp_f32 v208, v208
    v_mfma_f32_16x16x32_bf16 v[152:155], a[184:187], v[192:195], v[152:155]
    v_exp_f32 v209, v209
    v_mfma_f32_16x16x32_bf16 v[156:159], a[188:191], v[192:195], v[156:159]
    v_exp_f32 v210, v210
    v_mfma_f32_16x16x32_bf16 v[212:215], a[144:147], a[96:99], v[232:235]
    ds_read_b128 a[140:143], v225 offset:4096
    v_add_f32 v242, v242, v208
    v_mfma_f32_16x16x32_bf16 v[220:223], a[144:147], a[112:115], v[232:235]
    v_exp_f32 v211, v211
    v_mfma_f32_16x16x32_bf16 v[212:215], a[148:151], a[100:103], v[212:215]
    buffer_load_dwordx4 v244, s[12:15], s23 offen offset:0 nt lds
    v_mfma_f32_16x16x32_bf16 v[220:223], a[148:151], a[116:119], v[220:223]
    v_add_f32 v242, v242, v209
    v_cvt_pk_bf16_f32 v208, v208, v209
    v_mfma_f32_16x16x32_bf16 v[212:215], a[152:155], a[104:107], v[212:215]
    s_add_u32 m0, s21, 126848
    v_exp_f32 v216, v216
    v_mfma_f32_16x16x32_bf16 v[220:223], a[152:155], a[120:123], v[220:223]
    ds_read_b128 a[144:147], v224 offset:2048
    v_add_f32 v242, v242, v210
    v_mfma_f32_16x16x32_bf16 v[212:215], a[156:159], a[108:111], v[212:215]
    v_exp_f32 v217, v217
    v_mfma_f32_16x16x32_bf16 v[220:223], a[156:159], a[124:127], v[220:223]
    v_add_f32 v242, v242, v211
    v_cvt_pk_bf16_f32 v209, v210, v211
    v_mfma_f32_16x16x32_bf16 v[160:163], a[160:163], v[200:203], v[160:163]
    v_exp_f32 v218, v218
    v_mfma_f32_16x16x32_bf16 v[164:167], a[164:167], v[200:203], v[164:167]
    ds_read_b128 a[148:151], v225 offset:2048
    v_add_f32 v243, v243, v216
    v_mfma_f32_16x16x32_bf16 v[168:171], a[168:171], v[200:203], v[168:171]
    v_exp_f32 v219, v219
    v_mfma_f32_16x16x32_bf16 v[172:175], a[172:175], v[200:203], v[172:175]
    v_add_f32 v243, v243, v217
    v_cvt_pk_bf16_f32 v216, v216, v217
    v_mfma_f32_16x16x32_bf16 v[176:179], a[176:179], v[200:203], v[176:179]
    v_exp_f32 v212, v212
    v_mfma_f32_16x16x32_bf16 v[180:183], a[180:183], v[200:203], v[180:183]
    ds_read_b128 a[152:155], v224 offset:6144
    v_add_f32 v243, v243, v218
    v_mfma_f32_16x16x32_bf16 v[184:187], a[184:187], v[200:203], v[184:187]
    v_exp_f32 v213, v213
    v_add_f32 v243, v243, v219
    v_mfma_f32_16x16x32_bf16 v[188:191], a[188:191], v[200:203], v[188:191]
    s_waitcnt lgkmcnt(1)
    buffer_load_dwordx4 v244, s[12:15], s23 offen offset:128 nt lds
    v_cvt_pk_bf16_f32 v217, v218, v219
    v_mfma_f32_16x16x32_bf16 v[192:195], a[128:131], a[0:3], v[232:235]
    v_exp_f32 v214, v214
    v_add_f32 v242, v242, v212
    v_mfma_f32_16x16x32_bf16 v[200:203], a[128:131], a[16:19], v[232:235]
    v_exp_f32 v215, v215
    v_mfma_f32_16x16x32_bf16 v[192:195], a[132:135], a[4:7], v[192:195]
    v_add_f32 v242, v242, v213
    v_cvt_pk_bf16_f32 v210, v212, v213
    v_mfma_f32_16x16x32_bf16 v[200:203], a[132:135], a[20:23], v[200:203]
    v_exp_f32 v220, v220
    v_mfma_f32_16x16x32_bf16 v[192:195], a[136:139], a[8:11], v[192:195]
    ds_read_b128 a[156:159], v225 offset:6144
    v_add_f32 v242, v242, v214
    v_mfma_f32_16x16x32_bf16 v[200:203], a[136:139], a[24:27], v[200:203]
    v_exp_f32 v221, v221
    v_add_f32 v242, v242, v215
    v_mfma_f32_16x16x32_bf16 v[192:195], a[140:143], a[12:15], v[192:195]
    v_cvt_pk_bf16_f32 v211, v214, v215
    v_mfma_f32_16x16x32_bf16 v[200:203], a[140:143], a[28:31], v[200:203]
    v_exp_f32 v222, v222
    v_mfma_f32_16x16x32_bf16 a[192:195], a[160:163], v[208:211], a[192:195]
    v_add_f32 v243, v243, v220
    v_mfma_f32_16x16x32_bf16 a[196:199], a[164:167], v[208:211], a[196:199]
    v_exp_f32 v223, v223
    v_mfma_f32_16x16x32_bf16 a[200:203], a[168:171], v[208:211], a[200:203]
    v_add_f32 v243, v243, v221
    v_cvt_pk_bf16_f32 v218, v220, v221
    v_mfma_f32_16x16x32_bf16 a[204:207], a[172:175], v[208:211], a[204:207]
    v_add_f32 v243, v243, v222
    v_add_f32 v243, v243, v223
    v_mfma_f32_16x16x32_bf16 a[208:211], a[176:179], v[208:211], a[208:211]
    v_cvt_pk_bf16_f32 v219, v222, v223
    v_mfma_f32_16x16x32_bf16 a[212:215], a[180:183], v[208:211], a[212:215]
    v_exp_f32 v192, v192
    v_mfma_f32_16x16x32_bf16 a[216:219], a[184:187], v[208:211], a[216:219]
    v_exp_f32 v193, v193
    v_mfma_f32_16x16x32_bf16 a[220:223], a[188:191], v[208:211], a[220:223]
    v_exp_f32 v194, v194
    v_mfma_f32_16x16x32_bf16 v[196:199], a[144:147], a[0:3], v[232:235]
    v_add_f32 v236, v236, v192
    v_mfma_f32_16x16x32_bf16 v[204:207], a[144:147], a[16:19], v[232:235]
    v_exp_f32 v195, v195
    v_mfma_f32_16x16x32_bf16 v[196:199], a[148:151], a[4:7], v[196:199]
    v_add_f32 v236, v236, v193
    v_cvt_pk_bf16_f32 v192, v192, v193
    v_mfma_f32_16x16x32_bf16 v[204:207], a[148:151], a[20:23], v[204:207]
    s_waitcnt lgkmcnt(0)
    v_exp_f32 v200, v200
    v_mfma_f32_16x16x32_bf16 v[196:199], a[152:155], a[8:11], v[196:199]
    v_add_f32 v236, v236, v194
    v_mfma_f32_16x16x32_bf16 v[204:207], a[152:155], a[24:27], v[204:207]
    v_exp_f32 v201, v201
    v_mfma_f32_16x16x32_bf16 v[196:199], a[156:159], a[12:15], v[196:199]
    v_add_f32 v236, v236, v195
    v_cvt_pk_bf16_f32 v193, v194, v195
    v_mfma_f32_16x16x32_bf16 v[204:207], a[156:159], a[28:31], v[204:207]
    v_exp_f32 v202, v202
    v_mfma_f32_16x16x32_bf16 a[224:227], a[160:163], v[216:219], a[224:227]
    ds_read_b64_tr_b16 a[160:161], v226 offset:8192
    v_add_f32 v237, v237, v200
    v_mfma_f32_16x16x32_bf16 a[228:231], a[164:167], v[216:219], a[228:231]
    ds_read_b64_tr_b16 a[162:163], v226 offset:10240
    ds_read_b64_tr_b16 a[164:165], v227 offset:8192
    v_mfma_f32_16x16x32_bf16 a[232:235], a[168:171], v[216:219], a[232:235]
    v_exp_f32 v203, v203
    v_mfma_f32_16x16x32_bf16 a[236:239], a[172:175], v[216:219], a[236:239]
    ds_read_b64_tr_b16 a[166:167], v227 offset:10240
    v_add_f32 v237, v237, v201
    v_cvt_pk_bf16_f32 v200, v200, v201
    v_mfma_f32_16x16x32_bf16 a[240:243], a[176:179], v[216:219], a[240:243]
    ds_read_b64_tr_b16 a[168:169], v228 offset:8192
    v_exp_f32 v196, v196
    v_mfma_f32_16x16x32_bf16 a[244:247], a[180:183], v[216:219], a[244:247]
    ds_read_b64_tr_b16 a[170:171], v228 offset:10240
    v_add_f32 v237, v237, v202
    v_mfma_f32_16x16x32_bf16 a[248:251], a[184:187], v[216:219], a[248:251]
    ds_read_b64_tr_b16 a[172:173], v229 offset:8192
    v_exp_f32 v197, v197
    v_add_f32 v237, v237, v203
    v_mfma_f32_16x16x32_bf16 a[252:255], a[188:191], v[216:219], a[252:255]
    ds_read_b64_tr_b16 a[174:175], v229 offset:10240
    v_cvt_pk_bf16_f32 v201, v202, v203
    v_mfma_f32_16x16x32_bf16 v[208:211], a[128:131], a[32:35], v[232:235]
    ds_read_b64_tr_b16 a[176:177], v226 offset:12288
    v_exp_f32 v198, v198
    v_add_f32 v236, v236, v196
    v_mfma_f32_16x16x32_bf16 v[216:219], a[128:131], a[48:51], v[232:235]
    ds_read_b64_tr_b16 a[178:179], v226 offset:14336
    v_exp_f32 v199, v199
    v_mfma_f32_16x16x32_bf16 v[208:211], a[132:135], a[36:39], v[208:211]
    ds_read_b64_tr_b16 a[180:181], v227 offset:12288
    v_add_f32 v236, v236, v197
    v_cvt_pk_bf16_f32 v194, v196, v197
    v_mfma_f32_16x16x32_bf16 v[216:219], a[132:135], a[52:55], v[216:219]
    ds_read_b64_tr_b16 a[182:183], v227 offset:14336
    v_exp_f32 v204, v204
    v_mfma_f32_16x16x32_bf16 v[208:211], a[136:139], a[40:43], v[208:211]
    ds_read_b64_tr_b16 a[184:185], v228 offset:12288
    v_add_f32 v236, v236, v198
    v_mfma_f32_16x16x32_bf16 v[216:219], a[136:139], a[56:59], v[216:219]
    ds_read_b64_tr_b16 a[186:187], v228 offset:14336
    v_exp_f32 v205, v205
    v_add_f32 v236, v236, v199
    v_mfma_f32_16x16x32_bf16 v[208:211], a[140:143], a[44:47], v[208:211]
    ds_read_b64_tr_b16 a[188:189], v229 offset:12288
    v_cvt_pk_bf16_f32 v195, v198, v199
    v_mfma_f32_16x16x32_bf16 v[216:219], a[140:143], a[60:63], v[216:219]
    s_waitcnt lgkmcnt(4)
    ds_read_b64_tr_b16 a[190:191], v229 offset:14336
    v_mfma_f32_16x16x32_bf16 v[0:3], a[160:163], v[192:195], v[0:3]
    v_exp_f32 v206, v206
    v_mfma_f32_16x16x32_bf16 v[4:7], a[164:167], v[192:195], v[4:7]
    v_add_f32 v237, v237, v204
    v_mfma_f32_16x16x32_bf16 v[8:11], a[168:171], v[192:195], v[8:11]
    v_exp_f32 v207, v207
    v_mfma_f32_16x16x32_bf16 v[12:15], a[172:175], v[192:195], v[12:15]
    v_add_f32 v237, v237, v205
    v_cvt_pk_bf16_f32 v202, v204, v205
    v_mfma_f32_16x16x32_bf16 v[16:19], a[176:179], v[192:195], v[16:19]
    s_waitcnt lgkmcnt(1)
    v_add_f32 v237, v237, v206
    v_add_f32 v237, v237, v207
    v_mfma_f32_16x16x32_bf16 v[20:23], a[180:183], v[192:195], v[20:23]
    v_cvt_pk_bf16_f32 v203, v206, v207
    v_mfma_f32_16x16x32_bf16 v[24:27], a[184:187], v[192:195], v[24:27]
    s_waitcnt lgkmcnt(0)
    v_exp_f32 v208, v208
    v_mfma_f32_16x16x32_bf16 v[28:31], a[188:191], v[192:195], v[28:31]
    v_exp_f32 v209, v209
    v_mfma_f32_16x16x32_bf16 v[212:215], a[144:147], a[32:35], v[232:235]
    v_exp_f32 v210, v210
    v_mfma_f32_16x16x32_bf16 v[220:223], a[144:147], a[48:51], v[232:235]
    v_add_f32 v238, v238, v208
    v_mfma_f32_16x16x32_bf16 v[212:215], a[148:151], a[36:39], v[212:215]
    v_exp_f32 v211, v211
    v_mfma_f32_16x16x32_bf16 v[220:223], a[148:151], a[52:55], v[220:223]
    v_add_f32 v238, v238, v209
    v_cvt_pk_bf16_f32 v208, v208, v209
    v_mfma_f32_16x16x32_bf16 v[212:215], a[152:155], a[40:43], v[212:215]
    v_exp_f32 v216, v216
    v_mfma_f32_16x16x32_bf16 v[220:223], a[152:155], a[56:59], v[220:223]
    v_add_f32 v238, v238, v210
    v_mfma_f32_16x16x32_bf16 v[212:215], a[156:159], a[44:47], v[212:215]
    v_exp_f32 v217, v217
    v_mfma_f32_16x16x32_bf16 v[220:223], a[156:159], a[60:63], v[220:223]
    v_add_f32 v238, v238, v211
    v_cvt_pk_bf16_f32 v209, v210, v211
    v_mfma_f32_16x16x32_bf16 v[32:35], a[160:163], v[200:203], v[32:35]
    v_exp_f32 v218, v218
    v_mfma_f32_16x16x32_bf16 v[36:39], a[164:167], v[200:203], v[36:39]
    v_add_f32 v239, v239, v216
    v_exp_f32 v219, v219
    v_mfma_f32_16x16x32_bf16 v[40:43], a[168:171], v[200:203], v[40:43]
    v_add_f32 v239, v239, v217
    v_cvt_pk_bf16_f32 v216, v216, v217
    v_mfma_f32_16x16x32_bf16 v[44:47], a[172:175], v[200:203], v[44:47]
    v_exp_f32 v212, v212
    v_mfma_f32_16x16x32_bf16 v[48:51], a[176:179], v[200:203], v[48:51]
    v_add_f32 v239, v239, v218
    v_mfma_f32_16x16x32_bf16 v[52:55], a[180:183], v[200:203], v[52:55]
    v_exp_f32 v213, v213
    v_mfma_f32_16x16x32_bf16 v[56:59], a[184:187], v[200:203], v[56:59]
    v_add_f32 v239, v239, v219
    v_cvt_pk_bf16_f32 v217, v218, v219
    v_mfma_f32_16x16x32_bf16 v[60:63], a[188:191], v[200:203], v[60:63]
    v_exp_f32 v214, v214
    v_mfma_f32_16x16x32_bf16 v[192:195], a[128:131], a[64:67], v[232:235]
    v_add_f32 v238, v238, v212
    v_exp_f32 v215, v215
    v_mfma_f32_16x16x32_bf16 v[200:203], a[128:131], a[80:83], v[232:235]
    v_add_f32 v238, v238, v213
    v_cvt_pk_bf16_f32 v210, v212, v213
    v_mfma_f32_16x16x32_bf16 v[192:195], a[132:135], a[68:71], v[192:195]
    v_exp_f32 v220, v220
    v_mfma_f32_16x16x32_bf16 v[200:203], a[132:135], a[84:87], v[200:203]
    v_add_f32 v238, v238, v214
    v_mfma_f32_16x16x32_bf16 v[192:195], a[136:139], a[72:75], v[192:195]
    v_exp_f32 v221, v221
    v_mfma_f32_16x16x32_bf16 v[200:203], a[136:139], a[88:91], v[200:203]
    v_add_f32 v238, v238, v215
    v_cvt_pk_bf16_f32 v211, v214, v215
    v_mfma_f32_16x16x32_bf16 v[192:195], a[140:143], a[76:79], v[192:195]
    v_exp_f32 v222, v222
    v_mfma_f32_16x16x32_bf16 v[200:203], a[140:143], a[92:95], v[200:203]
    v_add_f32 v239, v239, v220
    v_mfma_f32_16x16x32_bf16 v[64:67], a[160:163], v[208:211], v[64:67]
    v_exp_f32 v223, v223
    v_mfma_f32_16x16x32_bf16 v[68:71], a[164:167], v[208:211], v[68:71]
    v_add_f32 v239, v239, v221
    v_cvt_pk_bf16_f32 v218, v220, v221
    v_mfma_f32_16x16x32_bf16 v[72:75], a[168:171], v[208:211], v[72:75]
    v_add_f32 v239, v239, v222
    v_add_f32 v239, v239, v223
    v_mfma_f32_16x16x32_bf16 v[76:79], a[172:175], v[208:211], v[76:79]
    v_cvt_pk_bf16_f32 v219, v222, v223
    v_mfma_f32_16x16x32_bf16 v[80:83], a[176:179], v[208:211], v[80:83]
    v_exp_f32 v192, v192
    v_mfma_f32_16x16x32_bf16 v[84:87], a[180:183], v[208:211], v[84:87]
    v_exp_f32 v193, v193
    v_mfma_f32_16x16x32_bf16 v[88:91], a[184:187], v[208:211], v[88:91]
    v_exp_f32 v194, v194
    v_mfma_f32_16x16x32_bf16 v[92:95], a[188:191], v[208:211], v[92:95]
    s_waitcnt vmcnt(8)
    s_barrier
    v_add_f32 v240, v240, v192
    v_mfma_f32_16x16x32_bf16 v[196:199], a[144:147], a[64:67], v[232:235]
    s_add_u32 m0, s21, 65536
    v_exp_f32 v195, v195
    v_mfma_f32_16x16x32_bf16 v[204:207], a[144:147], a[80:83], v[232:235]
    s_mov_b32 s23, 98304
    v_add_f32 v240, v240, v193
    v_cvt_pk_bf16_f32 v192, v192, v193
    v_mfma_f32_16x16x32_bf16 v[196:199], a[148:151], a[68:71], v[196:199]
    v_exp_f32 v200, v200
    v_mfma_f32_16x16x32_bf16 v[204:207], a[148:151], a[84:87], v[204:207]
    v_add_f32 v240, v240, v194
    v_mfma_f32_16x16x32_bf16 v[196:199], a[152:155], a[72:75], v[196:199]
    v_exp_f32 v201, v201
    v_mfma_f32_16x16x32_bf16 v[204:207], a[152:155], a[88:91], v[204:207]
    v_add_f32 v240, v240, v195
    v_cvt_pk_bf16_f32 v193, v194, v195
    v_mfma_f32_16x16x32_bf16 v[196:199], a[156:159], a[76:79], v[196:199]
    v_exp_f32 v202, v202
    v_mfma_f32_16x16x32_bf16 v[204:207], a[156:159], a[92:95], v[204:207]
    v_add_f32 v241, v241, v200
    v_mfma_f32_16x16x32_bf16 v[96:99], a[160:163], v[216:219], v[96:99]
    v_exp_f32 v203, v203
    v_mfma_f32_16x16x32_bf16 v[100:103], a[164:167], v[216:219], v[100:103]
    v_add_f32 v241, v241, v201
    v_cvt_pk_bf16_f32 v200, v200, v201
    v_mfma_f32_16x16x32_bf16 v[104:107], a[168:171], v[216:219], v[104:107]
    buffer_load_dwordx4 v244, s[8:11], s23 offen offset:0 nt lds
    v_mfma_f32_16x16x32_bf16 v[108:111], a[172:175], v[216:219], v[108:111]
    v_exp_f32 v196, v196
    v_mfma_f32_16x16x32_bf16 v[112:115], a[176:179], v[216:219], v[112:115]
    s_add_u32 m0, s21, 69504
    v_add_f32 v241, v241, v202
    v_mfma_f32_16x16x32_bf16 v[116:119], a[180:183], v[216:219], v[116:119]
    v_exp_f32 v197, v197
    v_mfma_f32_16x16x32_bf16 v[120:123], a[184:187], v[216:219], v[120:123]
    v_add_f32 v241, v241, v203
    v_cvt_pk_bf16_f32 v201, v202, v203
    v_mfma_f32_16x16x32_bf16 v[124:127], a[188:191], v[216:219], v[124:127]
    v_exp_f32 v198, v198
    v_mfma_f32_16x16x32_bf16 v[208:211], a[128:131], a[96:99], v[232:235]
    v_add_f32 v240, v240, v196
    v_exp_f32 v199, v199
    v_mfma_f32_16x16x32_bf16 v[216:219], a[128:131], a[112:115], v[232:235]
    v_add_f32 v240, v240, v197
    v_cvt_pk_bf16_f32 v194, v196, v197
    v_mfma_f32_16x16x32_bf16 v[208:211], a[132:135], a[100:103], v[208:211]
    v_exp_f32 v204, v204
    v_mfma_f32_16x16x32_bf16 v[216:219], a[132:135], a[116:119], v[216:219]
    ds_read_b128 a[128:131], v224 offset:16384
    v_add_f32 v240, v240, v198
    v_mfma_f32_16x16x32_bf16 v[208:211], a[136:139], a[104:107], v[208:211]
    v_exp_f32 v205, v205
    v_mfma_f32_16x16x32_bf16 v[216:219], a[136:139], a[120:123], v[216:219]
    v_add_f32 v240, v240, v199
    v_cvt_pk_bf16_f32 v195, v198, v199
    v_mfma_f32_16x16x32_bf16 v[208:211], a[140:143], a[108:111], v[208:211]
    buffer_load_dwordx4 v244, s[8:11], s23 offen offset:128 nt lds
    v_mfma_f32_16x16x32_bf16 v[216:219], a[140:143], a[124:127], v[216:219]
    v_exp_f32 v206, v206
    v_mfma_f32_16x16x32_bf16 v[128:131], a[160:163], v[192:195], v[128:131]
    s_add_u32 m0, s21, 73728
    ds_read_b128 a[132:135], v225 offset:16384
    v_add_f32 v241, v241, v204
    v_mfma_f32_16x16x32_bf16 v[132:135], a[164:167], v[192:195], v[132:135]
    v_exp_f32 v207, v207
    v_mfma_f32_16x16x32_bf16 v[136:139], a[168:171], v[192:195], v[136:139]
    v_add_f32 v241, v241, v205
    v_cvt_pk_bf16_f32 v202, v204, v205
    v_mfma_f32_16x16x32_bf16 v[140:143], a[172:175], v[192:195], v[140:143]
    v_add_f32 v241, v241, v206
    v_add_f32 v241, v241, v207
    v_mfma_f32_16x16x32_bf16 v[144:147], a[176:179], v[192:195], v[144:147]
    ds_read_b128 a[136:139], v224 offset:20480
    v_cvt_pk_bf16_f32 v203, v206, v207
    v_mfma_f32_16x16x32_bf16 v[148:151], a[180:183], v[192:195], v[148:151]
    v_exp_f32 v208, v208
    v_mfma_f32_16x16x32_bf16 v[152:155], a[184:187], v[192:195], v[152:155]
    v_exp_f32 v209, v209
    v_mfma_f32_16x16x32_bf16 v[156:159], a[188:191], v[192:195], v[156:159]
    v_exp_f32 v210, v210
    v_mfma_f32_16x16x32_bf16 v[212:215], a[144:147], a[96:99], v[232:235]
    ds_read_b128 a[140:143], v225 offset:20480
    v_add_f32 v242, v242, v208
    v_mfma_f32_16x16x32_bf16 v[220:223], a[144:147], a[112:115], v[232:235]
    v_exp_f32 v211, v211
    v_mfma_f32_16x16x32_bf16 v[212:215], a[148:151], a[100:103], v[212:215]
    buffer_load_dwordx4 v244, s[12:15], s23 offen offset:0 nt lds
    v_mfma_f32_16x16x32_bf16 v[220:223], a[148:151], a[116:119], v[220:223]
    v_add_f32 v242, v242, v209
    v_cvt_pk_bf16_f32 v208, v208, v209
    v_mfma_f32_16x16x32_bf16 v[212:215], a[152:155], a[104:107], v[212:215]
    s_add_u32 m0, s21, 77696
    v_exp_f32 v216, v216
    v_mfma_f32_16x16x32_bf16 v[220:223], a[152:155], a[120:123], v[220:223]
    ds_read_b128 a[144:147], v224 offset:18432
    v_add_f32 v242, v242, v210
    v_mfma_f32_16x16x32_bf16 v[212:215], a[156:159], a[108:111], v[212:215]
    v_exp_f32 v217, v217
    v_mfma_f32_16x16x32_bf16 v[220:223], a[156:159], a[124:127], v[220:223]
    v_add_f32 v242, v242, v211
    v_cvt_pk_bf16_f32 v209, v210, v211
    v_mfma_f32_16x16x32_bf16 v[160:163], a[160:163], v[200:203], v[160:163]
    v_exp_f32 v218, v218
    v_mfma_f32_16x16x32_bf16 v[164:167], a[164:167], v[200:203], v[164:167]
    ds_read_b128 a[148:151], v225 offset:18432
    v_add_f32 v243, v243, v216
    v_mfma_f32_16x16x32_bf16 v[168:171], a[168:171], v[200:203], v[168:171]
    v_exp_f32 v219, v219
    v_mfma_f32_16x16x32_bf16 v[172:175], a[172:175], v[200:203], v[172:175]
    v_add_f32 v243, v243, v217
    v_cvt_pk_bf16_f32 v216, v216, v217
    v_mfma_f32_16x16x32_bf16 v[176:179], a[176:179], v[200:203], v[176:179]
    v_exp_f32 v212, v212
    v_mfma_f32_16x16x32_bf16 v[180:183], a[180:183], v[200:203], v[180:183]
    ds_read_b128 a[152:155], v224 offset:22528
    v_add_f32 v243, v243, v218
    v_mfma_f32_16x16x32_bf16 v[184:187], a[184:187], v[200:203], v[184:187]
    v_exp_f32 v213, v213
    v_add_f32 v243, v243, v219
    v_mfma_f32_16x16x32_bf16 v[188:191], a[188:191], v[200:203], v[188:191]
    s_waitcnt lgkmcnt(1)
    buffer_load_dwordx4 v244, s[12:15], s23 offen offset:128 nt lds
    v_cvt_pk_bf16_f32 v217, v218, v219
    v_mfma_f32_16x16x32_bf16 v[192:195], a[128:131], a[0:3], v[232:235]
    v_exp_f32 v214, v214
    v_add_f32 v242, v242, v212
    v_mfma_f32_16x16x32_bf16 v[200:203], a[128:131], a[16:19], v[232:235]
    v_exp_f32 v215, v215
    v_mfma_f32_16x16x32_bf16 v[192:195], a[132:135], a[4:7], v[192:195]
    v_add_f32 v242, v242, v213
    v_cvt_pk_bf16_f32 v210, v212, v213
    v_mfma_f32_16x16x32_bf16 v[200:203], a[132:135], a[20:23], v[200:203]
    v_exp_f32 v220, v220
    v_mfma_f32_16x16x32_bf16 v[192:195], a[136:139], a[8:11], v[192:195]
    ds_read_b128 a[156:159], v225 offset:22528
    v_add_f32 v242, v242, v214
    v_mfma_f32_16x16x32_bf16 v[200:203], a[136:139], a[24:27], v[200:203]
    v_exp_f32 v221, v221
    v_add_f32 v242, v242, v215
    v_mfma_f32_16x16x32_bf16 v[192:195], a[140:143], a[12:15], v[192:195]
    v_cvt_pk_bf16_f32 v211, v214, v215
    v_mfma_f32_16x16x32_bf16 v[200:203], a[140:143], a[28:31], v[200:203]
    v_exp_f32 v222, v222
    v_mfma_f32_16x16x32_bf16 a[192:195], a[160:163], v[208:211], a[192:195]
    v_add_f32 v243, v243, v220
    v_mfma_f32_16x16x32_bf16 a[196:199], a[164:167], v[208:211], a[196:199]
    v_exp_f32 v223, v223
    v_mfma_f32_16x16x32_bf16 a[200:203], a[168:171], v[208:211], a[200:203]
    v_add_f32 v243, v243, v221
    v_cvt_pk_bf16_f32 v218, v220, v221
    v_mfma_f32_16x16x32_bf16 a[204:207], a[172:175], v[208:211], a[204:207]
    v_add_f32 v243, v243, v222
    v_add_f32 v243, v243, v223
    v_mfma_f32_16x16x32_bf16 a[208:211], a[176:179], v[208:211], a[208:211]
    v_cvt_pk_bf16_f32 v219, v222, v223
    v_mfma_f32_16x16x32_bf16 a[212:215], a[180:183], v[208:211], a[212:215]
    v_exp_f32 v192, v192
    v_mfma_f32_16x16x32_bf16 a[216:219], a[184:187], v[208:211], a[216:219]
    v_exp_f32 v193, v193
    v_mfma_f32_16x16x32_bf16 a[220:223], a[188:191], v[208:211], a[220:223]
    v_exp_f32 v194, v194
    v_mfma_f32_16x16x32_bf16 v[196:199], a[144:147], a[0:3], v[232:235]
    v_add_f32 v236, v236, v192
    v_mfma_f32_16x16x32_bf16 v[204:207], a[144:147], a[16:19], v[232:235]
    v_exp_f32 v195, v195
    v_mfma_f32_16x16x32_bf16 v[196:199], a[148:151], a[4:7], v[196:199]
    v_add_f32 v236, v236, v193
    v_cvt_pk_bf16_f32 v192, v192, v193
    v_mfma_f32_16x16x32_bf16 v[204:207], a[148:151], a[20:23], v[204:207]
    s_waitcnt lgkmcnt(0)
    v_exp_f32 v200, v200
    v_mfma_f32_16x16x32_bf16 v[196:199], a[152:155], a[8:11], v[196:199]
    v_add_f32 v236, v236, v194
    v_mfma_f32_16x16x32_bf16 v[204:207], a[152:155], a[24:27], v[204:207]
    v_exp_f32 v201, v201
    v_mfma_f32_16x16x32_bf16 v[196:199], a[156:159], a[12:15], v[196:199]
    v_add_f32 v236, v236, v195
    v_cvt_pk_bf16_f32 v193, v194, v195
    v_mfma_f32_16x16x32_bf16 v[204:207], a[156:159], a[28:31], v[204:207]
    v_exp_f32 v202, v202
    v_mfma_f32_16x16x32_bf16 a[224:227], a[160:163], v[216:219], a[224:227]
    ds_read_b64_tr_b16 a[160:161], v226 offset:24576
    v_add_f32 v237, v237, v200
    v_mfma_f32_16x16x32_bf16 a[228:231], a[164:167], v[216:219], a[228:231]
    ds_read_b64_tr_b16 a[162:163], v226 offset:26624
    ds_read_b64_tr_b16 a[164:165], v227 offset:24576
    v_mfma_f32_16x16x32_bf16 a[232:235], a[168:171], v[216:219], a[232:235]
    v_exp_f32 v203, v203
    v_mfma_f32_16x16x32_bf16 a[236:239], a[172:175], v[216:219], a[236:239]
    ds_read_b64_tr_b16 a[166:167], v227 offset:26624
    v_add_f32 v237, v237, v201
    v_cvt_pk_bf16_f32 v200, v200, v201
    v_mfma_f32_16x16x32_bf16 a[240:243], a[176:179], v[216:219], a[240:243]
    ds_read_b64_tr_b16 a[168:169], v228 offset:24576
    v_exp_f32 v196, v196
    v_mfma_f32_16x16x32_bf16 a[244:247], a[180:183], v[216:219], a[244:247]
    ds_read_b64_tr_b16 a[170:171], v228 offset:26624
    v_add_f32 v237, v237, v202
    v_mfma_f32_16x16x32_bf16 a[248:251], a[184:187], v[216:219], a[248:251]
    ds_read_b64_tr_b16 a[172:173], v229 offset:24576
    v_exp_f32 v197, v197
    v_add_f32 v237, v237, v203
    v_mfma_f32_16x16x32_bf16 a[252:255], a[188:191], v[216:219], a[252:255]
    ds_read_b64_tr_b16 a[174:175], v229 offset:26624
    v_cvt_pk_bf16_f32 v201, v202, v203
    v_mfma_f32_16x16x32_bf16 v[208:211], a[128:131], a[32:35], v[232:235]
    ds_read_b64_tr_b16 a[176:177], v226 offset:28672
    v_exp_f32 v198, v198
    v_add_f32 v236, v236, v196
    v_mfma_f32_16x16x32_bf16 v[216:219], a[128:131], a[48:51], v[232:235]
    ds_read_b64_tr_b16 a[178:179], v226 offset:30720
    v_exp_f32 v199, v199
    v_mfma_f32_16x16x32_bf16 v[208:211], a[132:135], a[36:39], v[208:211]
    ds_read_b64_tr_b16 a[180:181], v227 offset:28672
    v_add_f32 v236, v236, v197
    v_cvt_pk_bf16_f32 v194, v196, v197
    v_mfma_f32_16x16x32_bf16 v[216:219], a[132:135], a[52:55], v[216:219]
    ds_read_b64_tr_b16 a[182:183], v227 offset:30720
    v_exp_f32 v204, v204
    v_mfma_f32_16x16x32_bf16 v[208:211], a[136:139], a[40:43], v[208:211]
    ds_read_b64_tr_b16 a[184:185], v228 offset:28672
    v_add_f32 v236, v236, v198
    v_mfma_f32_16x16x32_bf16 v[216:219], a[136:139], a[56:59], v[216:219]
    ds_read_b64_tr_b16 a[186:187], v228 offset:30720
    v_exp_f32 v205, v205
    v_add_f32 v236, v236, v199
    v_mfma_f32_16x16x32_bf16 v[208:211], a[140:143], a[44:47], v[208:211]
    ds_read_b64_tr_b16 a[188:189], v229 offset:28672
    v_cvt_pk_bf16_f32 v195, v198, v199
    v_mfma_f32_16x16x32_bf16 v[216:219], a[140:143], a[60:63], v[216:219]
    s_waitcnt lgkmcnt(4)
    ds_read_b64_tr_b16 a[190:191], v229 offset:30720
    v_mfma_f32_16x16x32_bf16 v[0:3], a[160:163], v[192:195], v[0:3]
    v_exp_f32 v206, v206
    v_mfma_f32_16x16x32_bf16 v[4:7], a[164:167], v[192:195], v[4:7]
    v_add_f32 v237, v237, v204
    v_mfma_f32_16x16x32_bf16 v[8:11], a[168:171], v[192:195], v[8:11]
    v_exp_f32 v207, v207
    v_mfma_f32_16x16x32_bf16 v[12:15], a[172:175], v[192:195], v[12:15]
    v_add_f32 v237, v237, v205
    v_cvt_pk_bf16_f32 v202, v204, v205
    v_mfma_f32_16x16x32_bf16 v[16:19], a[176:179], v[192:195], v[16:19]
    s_waitcnt lgkmcnt(1)
    v_add_f32 v237, v237, v206
    v_add_f32 v237, v237, v207
    v_mfma_f32_16x16x32_bf16 v[20:23], a[180:183], v[192:195], v[20:23]
    v_cvt_pk_bf16_f32 v203, v206, v207
    v_mfma_f32_16x16x32_bf16 v[24:27], a[184:187], v[192:195], v[24:27]
    s_waitcnt lgkmcnt(0)
    v_exp_f32 v208, v208
    v_mfma_f32_16x16x32_bf16 v[28:31], a[188:191], v[192:195], v[28:31]
    v_exp_f32 v209, v209
    v_mfma_f32_16x16x32_bf16 v[212:215], a[144:147], a[32:35], v[232:235]
    v_exp_f32 v210, v210
    v_mfma_f32_16x16x32_bf16 v[220:223], a[144:147], a[48:51], v[232:235]
    v_add_f32 v238, v238, v208
    v_mfma_f32_16x16x32_bf16 v[212:215], a[148:151], a[36:39], v[212:215]
    v_exp_f32 v211, v211
    v_mfma_f32_16x16x32_bf16 v[220:223], a[148:151], a[52:55], v[220:223]
    v_add_f32 v238, v238, v209
    v_cvt_pk_bf16_f32 v208, v208, v209
    v_mfma_f32_16x16x32_bf16 v[212:215], a[152:155], a[40:43], v[212:215]
    v_exp_f32 v216, v216
    v_mfma_f32_16x16x32_bf16 v[220:223], a[152:155], a[56:59], v[220:223]
    v_add_f32 v238, v238, v210
    v_mfma_f32_16x16x32_bf16 v[212:215], a[156:159], a[44:47], v[212:215]
    v_exp_f32 v217, v217
    v_mfma_f32_16x16x32_bf16 v[220:223], a[156:159], a[60:63], v[220:223]
    v_add_f32 v238, v238, v211
    v_cvt_pk_bf16_f32 v209, v210, v211
    v_mfma_f32_16x16x32_bf16 v[32:35], a[160:163], v[200:203], v[32:35]
    v_exp_f32 v218, v218
    v_mfma_f32_16x16x32_bf16 v[36:39], a[164:167], v[200:203], v[36:39]
    v_add_f32 v239, v239, v216
    v_exp_f32 v219, v219
    v_mfma_f32_16x16x32_bf16 v[40:43], a[168:171], v[200:203], v[40:43]
    v_add_f32 v239, v239, v217
    v_cvt_pk_bf16_f32 v216, v216, v217
    v_mfma_f32_16x16x32_bf16 v[44:47], a[172:175], v[200:203], v[44:47]
    v_exp_f32 v212, v212
    v_mfma_f32_16x16x32_bf16 v[48:51], a[176:179], v[200:203], v[48:51]
    v_add_f32 v239, v239, v218
    v_mfma_f32_16x16x32_bf16 v[52:55], a[180:183], v[200:203], v[52:55]
    v_exp_f32 v213, v213
    v_mfma_f32_16x16x32_bf16 v[56:59], a[184:187], v[200:203], v[56:59]
    v_add_f32 v239, v239, v219
    v_cvt_pk_bf16_f32 v217, v218, v219
    v_mfma_f32_16x16x32_bf16 v[60:63], a[188:191], v[200:203], v[60:63]
    v_exp_f32 v214, v214
    v_mfma_f32_16x16x32_bf16 v[192:195], a[128:131], a[64:67], v[232:235]
    v_add_f32 v238, v238, v212
    v_exp_f32 v215, v215
    v_mfma_f32_16x16x32_bf16 v[200:203], a[128:131], a[80:83], v[232:235]
    v_add_f32 v238, v238, v213
    v_cvt_pk_bf16_f32 v210, v212, v213
    v_mfma_f32_16x16x32_bf16 v[192:195], a[132:135], a[68:71], v[192:195]
    v_exp_f32 v220, v220
    v_mfma_f32_16x16x32_bf16 v[200:203], a[132:135], a[84:87], v[200:203]
    v_add_f32 v238, v238, v214
    v_mfma_f32_16x16x32_bf16 v[192:195], a[136:139], a[72:75], v[192:195]
    v_exp_f32 v221, v221
    v_mfma_f32_16x16x32_bf16 v[200:203], a[136:139], a[88:91], v[200:203]
    v_add_f32 v238, v238, v215
    v_cvt_pk_bf16_f32 v211, v214, v215
    v_mfma_f32_16x16x32_bf16 v[192:195], a[140:143], a[76:79], v[192:195]
    v_exp_f32 v222, v222
    v_mfma_f32_16x16x32_bf16 v[200:203], a[140:143], a[92:95], v[200:203]
    v_add_f32 v239, v239, v220
    v_mfma_f32_16x16x32_bf16 v[64:67], a[160:163], v[208:211], v[64:67]
    v_exp_f32 v223, v223
    v_mfma_f32_16x16x32_bf16 v[68:71], a[164:167], v[208:211], v[68:71]
    v_add_f32 v239, v239, v221
    v_cvt_pk_bf16_f32 v218, v220, v221
    v_mfma_f32_16x16x32_bf16 v[72:75], a[168:171], v[208:211], v[72:75]
    v_add_f32 v239, v239, v222
    v_add_f32 v239, v239, v223
    v_mfma_f32_16x16x32_bf16 v[76:79], a[172:175], v[208:211], v[76:79]
    v_cvt_pk_bf16_f32 v219, v222, v223
    v_mfma_f32_16x16x32_bf16 v[80:83], a[176:179], v[208:211], v[80:83]
    v_exp_f32 v192, v192
    v_mfma_f32_16x16x32_bf16 v[84:87], a[180:183], v[208:211], v[84:87]
    v_exp_f32 v193, v193
    v_mfma_f32_16x16x32_bf16 v[88:91], a[184:187], v[208:211], v[88:91]
    v_exp_f32 v194, v194
    v_mfma_f32_16x16x32_bf16 v[92:95], a[188:191], v[208:211], v[92:95]
    s_waitcnt vmcnt(8)
    s_barrier
    v_add_f32 v240, v240, v192
    v_mfma_f32_16x16x32_bf16 v[196:199], a[144:147], a[64:67], v[232:235]
    s_add_u32 m0, s21, 81920
    v_exp_f32 v195, v195
    v_mfma_f32_16x16x32_bf16 v[204:207], a[144:147], a[80:83], v[232:235]
    s_mov_b32 s23, 106496
    v_add_f32 v240, v240, v193
    v_cvt_pk_bf16_f32 v192, v192, v193
    v_mfma_f32_16x16x32_bf16 v[196:199], a[148:151], a[68:71], v[196:199]
    v_exp_f32 v200, v200
    v_mfma_f32_16x16x32_bf16 v[204:207], a[148:151], a[84:87], v[204:207]
    v_add_f32 v240, v240, v194
    v_mfma_f32_16x16x32_bf16 v[196:199], a[152:155], a[72:75], v[196:199]
    v_exp_f32 v201, v201
    v_mfma_f32_16x16x32_bf16 v[204:207], a[152:155], a[88:91], v[204:207]
    v_add_f32 v240, v240, v195
    v_cvt_pk_bf16_f32 v193, v194, v195
    v_mfma_f32_16x16x32_bf16 v[196:199], a[156:159], a[76:79], v[196:199]
    v_exp_f32 v202, v202
    v_mfma_f32_16x16x32_bf16 v[204:207], a[156:159], a[92:95], v[204:207]
    v_add_f32 v241, v241, v200
    v_mfma_f32_16x16x32_bf16 v[96:99], a[160:163], v[216:219], v[96:99]
    v_exp_f32 v203, v203
    v_mfma_f32_16x16x32_bf16 v[100:103], a[164:167], v[216:219], v[100:103]
    v_add_f32 v241, v241, v201
    v_cvt_pk_bf16_f32 v200, v200, v201
    v_mfma_f32_16x16x32_bf16 v[104:107], a[168:171], v[216:219], v[104:107]
    buffer_load_dwordx4 v244, s[8:11], s23 offen offset:0 nt lds
    v_mfma_f32_16x16x32_bf16 v[108:111], a[172:175], v[216:219], v[108:111]
    v_exp_f32 v196, v196
    v_mfma_f32_16x16x32_bf16 v[112:115], a[176:179], v[216:219], v[112:115]
    s_add_u32 m0, s21, 85888
    v_add_f32 v241, v241, v202
    v_mfma_f32_16x16x32_bf16 v[116:119], a[180:183], v[216:219], v[116:119]
    v_exp_f32 v197, v197
    v_mfma_f32_16x16x32_bf16 v[120:123], a[184:187], v[216:219], v[120:123]
    v_add_f32 v241, v241, v203
    v_cvt_pk_bf16_f32 v201, v202, v203
    v_mfma_f32_16x16x32_bf16 v[124:127], a[188:191], v[216:219], v[124:127]
    v_exp_f32 v198, v198
    v_mfma_f32_16x16x32_bf16 v[208:211], a[128:131], a[96:99], v[232:235]
    v_add_f32 v240, v240, v196
    v_exp_f32 v199, v199
    v_mfma_f32_16x16x32_bf16 v[216:219], a[128:131], a[112:115], v[232:235]
    v_add_f32 v240, v240, v197
    v_cvt_pk_bf16_f32 v194, v196, v197
    v_mfma_f32_16x16x32_bf16 v[208:211], a[132:135], a[100:103], v[208:211]
    v_exp_f32 v204, v204
    v_mfma_f32_16x16x32_bf16 v[216:219], a[132:135], a[116:119], v[216:219]
    ds_read_b128 a[128:131], v224 offset:32768
    v_add_f32 v240, v240, v198
    v_mfma_f32_16x16x32_bf16 v[208:211], a[136:139], a[104:107], v[208:211]
    v_exp_f32 v205, v205
    v_mfma_f32_16x16x32_bf16 v[216:219], a[136:139], a[120:123], v[216:219]
    v_add_f32 v240, v240, v199
    v_cvt_pk_bf16_f32 v195, v198, v199
    v_mfma_f32_16x16x32_bf16 v[208:211], a[140:143], a[108:111], v[208:211]
    buffer_load_dwordx4 v244, s[8:11], s23 offen offset:128 nt lds
    v_mfma_f32_16x16x32_bf16 v[216:219], a[140:143], a[124:127], v[216:219]
    v_exp_f32 v206, v206
    v_mfma_f32_16x16x32_bf16 v[128:131], a[160:163], v[192:195], v[128:131]
    s_add_u32 m0, s21, 90112
    ds_read_b128 a[132:135], v225 offset:32768
    v_add_f32 v241, v241, v204
    v_mfma_f32_16x16x32_bf16 v[132:135], a[164:167], v[192:195], v[132:135]
    v_exp_f32 v207, v207
    v_mfma_f32_16x16x32_bf16 v[136:139], a[168:171], v[192:195], v[136:139]
    v_add_f32 v241, v241, v205
    v_cvt_pk_bf16_f32 v202, v204, v205
    v_mfma_f32_16x16x32_bf16 v[140:143], a[172:175], v[192:195], v[140:143]
    v_add_f32 v241, v241, v206
    v_add_f32 v241, v241, v207
    v_mfma_f32_16x16x32_bf16 v[144:147], a[176:179], v[192:195], v[144:147]
    ds_read_b128 a[136:139], v224 offset:36864
    v_cvt_pk_bf16_f32 v203, v206, v207
    v_mfma_f32_16x16x32_bf16 v[148:151], a[180:183], v[192:195], v[148:151]
    v_exp_f32 v208, v208
    v_mfma_f32_16x16x32_bf16 v[152:155], a[184:187], v[192:195], v[152:155]
    v_exp_f32 v209, v209
    v_mfma_f32_16x16x32_bf16 v[156:159], a[188:191], v[192:195], v[156:159]
    v_exp_f32 v210, v210
    v_mfma_f32_16x16x32_bf16 v[212:215], a[144:147], a[96:99], v[232:235]
    ds_read_b128 a[140:143], v225 offset:36864
    v_add_f32 v242, v242, v208
    v_mfma_f32_16x16x32_bf16 v[220:223], a[144:147], a[112:115], v[232:235]
    v_exp_f32 v211, v211
    v_mfma_f32_16x16x32_bf16 v[212:215], a[148:151], a[100:103], v[212:215]
    buffer_load_dwordx4 v244, s[12:15], s23 offen offset:0 nt lds
    v_mfma_f32_16x16x32_bf16 v[220:223], a[148:151], a[116:119], v[220:223]
    v_add_f32 v242, v242, v209
    v_cvt_pk_bf16_f32 v208, v208, v209
    v_mfma_f32_16x16x32_bf16 v[212:215], a[152:155], a[104:107], v[212:215]
    s_add_u32 m0, s21, 94080
    v_exp_f32 v216, v216
    v_mfma_f32_16x16x32_bf16 v[220:223], a[152:155], a[120:123], v[220:223]
    ds_read_b128 a[144:147], v224 offset:34816
    v_add_f32 v242, v242, v210
    v_mfma_f32_16x16x32_bf16 v[212:215], a[156:159], a[108:111], v[212:215]
    v_exp_f32 v217, v217
    v_mfma_f32_16x16x32_bf16 v[220:223], a[156:159], a[124:127], v[220:223]
    v_add_f32 v242, v242, v211
    v_cvt_pk_bf16_f32 v209, v210, v211
    v_mfma_f32_16x16x32_bf16 v[160:163], a[160:163], v[200:203], v[160:163]
    v_exp_f32 v218, v218
    v_mfma_f32_16x16x32_bf16 v[164:167], a[164:167], v[200:203], v[164:167]
    ds_read_b128 a[148:151], v225 offset:34816
    v_add_f32 v243, v243, v216
    v_mfma_f32_16x16x32_bf16 v[168:171], a[168:171], v[200:203], v[168:171]
    v_exp_f32 v219, v219
    v_mfma_f32_16x16x32_bf16 v[172:175], a[172:175], v[200:203], v[172:175]
    v_add_f32 v243, v243, v217
    v_cvt_pk_bf16_f32 v216, v216, v217
    v_mfma_f32_16x16x32_bf16 v[176:179], a[176:179], v[200:203], v[176:179]
    v_exp_f32 v212, v212
    v_mfma_f32_16x16x32_bf16 v[180:183], a[180:183], v[200:203], v[180:183]
    ds_read_b128 a[152:155], v224 offset:38912
    v_add_f32 v243, v243, v218
    v_mfma_f32_16x16x32_bf16 v[184:187], a[184:187], v[200:203], v[184:187]
    v_exp_f32 v213, v213
    v_add_f32 v243, v243, v219
    v_mfma_f32_16x16x32_bf16 v[188:191], a[188:191], v[200:203], v[188:191]
    s_waitcnt lgkmcnt(1)
    buffer_load_dwordx4 v244, s[12:15], s23 offen offset:128 nt lds
    v_cvt_pk_bf16_f32 v217, v218, v219
    v_mfma_f32_16x16x32_bf16 v[192:195], a[128:131], a[0:3], v[232:235]
    v_exp_f32 v214, v214
    v_add_f32 v242, v242, v212
    v_mfma_f32_16x16x32_bf16 v[200:203], a[128:131], a[16:19], v[232:235]
    v_exp_f32 v215, v215
    v_mfma_f32_16x16x32_bf16 v[192:195], a[132:135], a[4:7], v[192:195]
    v_add_f32 v242, v242, v213
    v_cvt_pk_bf16_f32 v210, v212, v213
    v_mfma_f32_16x16x32_bf16 v[200:203], a[132:135], a[20:23], v[200:203]
    v_exp_f32 v220, v220
    v_mfma_f32_16x16x32_bf16 v[192:195], a[136:139], a[8:11], v[192:195]
    ds_read_b128 a[156:159], v225 offset:38912
    v_add_f32 v242, v242, v214
    v_mfma_f32_16x16x32_bf16 v[200:203], a[136:139], a[24:27], v[200:203]
    v_exp_f32 v221, v221
    v_add_f32 v242, v242, v215
    v_mfma_f32_16x16x32_bf16 v[192:195], a[140:143], a[12:15], v[192:195]
    v_cvt_pk_bf16_f32 v211, v214, v215
    v_mfma_f32_16x16x32_bf16 v[200:203], a[140:143], a[28:31], v[200:203]
    v_exp_f32 v222, v222
    v_mfma_f32_16x16x32_bf16 a[192:195], a[160:163], v[208:211], a[192:195]
    v_add_f32 v243, v243, v220
    v_mfma_f32_16x16x32_bf16 a[196:199], a[164:167], v[208:211], a[196:199]
    v_exp_f32 v223, v223
    v_mfma_f32_16x16x32_bf16 a[200:203], a[168:171], v[208:211], a[200:203]
    v_add_f32 v243, v243, v221
    v_cvt_pk_bf16_f32 v218, v220, v221
    v_mfma_f32_16x16x32_bf16 a[204:207], a[172:175], v[208:211], a[204:207]
    v_add_f32 v243, v243, v222
    v_add_f32 v243, v243, v223
    v_mfma_f32_16x16x32_bf16 a[208:211], a[176:179], v[208:211], a[208:211]
    v_cvt_pk_bf16_f32 v219, v222, v223
    v_mfma_f32_16x16x32_bf16 a[212:215], a[180:183], v[208:211], a[212:215]
    v_exp_f32 v192, v192
    v_mfma_f32_16x16x32_bf16 a[216:219], a[184:187], v[208:211], a[216:219]
    v_exp_f32 v193, v193
    v_mfma_f32_16x16x32_bf16 a[220:223], a[188:191], v[208:211], a[220:223]
    v_exp_f32 v194, v194
    v_mfma_f32_16x16x32_bf16 v[196:199], a[144:147], a[0:3], v[232:235]
    v_add_f32 v236, v236, v192
    v_mfma_f32_16x16x32_bf16 v[204:207], a[144:147], a[16:19], v[232:235]
    v_exp_f32 v195, v195
    v_mfma_f32_16x16x32_bf16 v[196:199], a[148:151], a[4:7], v[196:199]
    v_add_f32 v236, v236, v193
    v_cvt_pk_bf16_f32 v192, v192, v193
    v_mfma_f32_16x16x32_bf16 v[204:207], a[148:151], a[20:23], v[204:207]
    s_waitcnt lgkmcnt(0)
    v_exp_f32 v200, v200
    v_mfma_f32_16x16x32_bf16 v[196:199], a[152:155], a[8:11], v[196:199]
    v_add_f32 v236, v236, v194
    v_mfma_f32_16x16x32_bf16 v[204:207], a[152:155], a[24:27], v[204:207]
    v_exp_f32 v201, v201
    v_mfma_f32_16x16x32_bf16 v[196:199], a[156:159], a[12:15], v[196:199]
    v_add_f32 v236, v236, v195
    v_cvt_pk_bf16_f32 v193, v194, v195
    v_mfma_f32_16x16x32_bf16 v[204:207], a[156:159], a[28:31], v[204:207]
    v_exp_f32 v202, v202
    v_mfma_f32_16x16x32_bf16 a[224:227], a[160:163], v[216:219], a[224:227]
    ds_read_b64_tr_b16 a[160:161], v226 offset:40960
    v_add_f32 v237, v237, v200
    v_mfma_f32_16x16x32_bf16 a[228:231], a[164:167], v[216:219], a[228:231]
    ds_read_b64_tr_b16 a[162:163], v226 offset:43008
    ds_read_b64_tr_b16 a[164:165], v227 offset:40960
    v_mfma_f32_16x16x32_bf16 a[232:235], a[168:171], v[216:219], a[232:235]
    v_exp_f32 v203, v203
    v_mfma_f32_16x16x32_bf16 a[236:239], a[172:175], v[216:219], a[236:239]
    ds_read_b64_tr_b16 a[166:167], v227 offset:43008
    v_add_f32 v237, v237, v201
    v_cvt_pk_bf16_f32 v200, v200, v201
    v_mfma_f32_16x16x32_bf16 a[240:243], a[176:179], v[216:219], a[240:243]
    ds_read_b64_tr_b16 a[168:169], v228 offset:40960
    v_exp_f32 v196, v196
    v_mfma_f32_16x16x32_bf16 a[244:247], a[180:183], v[216:219], a[244:247]
    ds_read_b64_tr_b16 a[170:171], v228 offset:43008
    v_add_f32 v237, v237, v202
    v_mfma_f32_16x16x32_bf16 a[248:251], a[184:187], v[216:219], a[248:251]
    ds_read_b64_tr_b16 a[172:173], v229 offset:40960
    v_exp_f32 v197, v197
    v_add_f32 v237, v237, v203
    v_mfma_f32_16x16x32_bf16 a[252:255], a[188:191], v[216:219], a[252:255]
    ds_read_b64_tr_b16 a[174:175], v229 offset:43008
    v_cvt_pk_bf16_f32 v201, v202, v203
    v_mfma_f32_16x16x32_bf16 v[208:211], a[128:131], a[32:35], v[232:235]
    ds_read_b64_tr_b16 a[176:177], v226 offset:45056
    v_exp_f32 v198, v198
    v_add_f32 v236, v236, v196
    v_mfma_f32_16x16x32_bf16 v[216:219], a[128:131], a[48:51], v[232:235]
    ds_read_b64_tr_b16 a[178:179], v226 offset:47104
    v_exp_f32 v199, v199
    v_mfma_f32_16x16x32_bf16 v[208:211], a[132:135], a[36:39], v[208:211]
    ds_read_b64_tr_b16 a[180:181], v227 offset:45056
    v_add_f32 v236, v236, v197
    v_cvt_pk_bf16_f32 v194, v196, v197
    v_mfma_f32_16x16x32_bf16 v[216:219], a[132:135], a[52:55], v[216:219]
    ds_read_b64_tr_b16 a[182:183], v227 offset:47104
    v_exp_f32 v204, v204
    v_mfma_f32_16x16x32_bf16 v[208:211], a[136:139], a[40:43], v[208:211]
    ds_read_b64_tr_b16 a[184:185], v228 offset:45056
    v_add_f32 v236, v236, v198
    v_mfma_f32_16x16x32_bf16 v[216:219], a[136:139], a[56:59], v[216:219]
    ds_read_b64_tr_b16 a[186:187], v228 offset:47104
    v_exp_f32 v205, v205
    v_add_f32 v236, v236, v199
    v_mfma_f32_16x16x32_bf16 v[208:211], a[140:143], a[44:47], v[208:211]
    ds_read_b64_tr_b16 a[188:189], v229 offset:45056
    v_cvt_pk_bf16_f32 v195, v198, v199
    v_mfma_f32_16x16x32_bf16 v[216:219], a[140:143], a[60:63], v[216:219]
    s_waitcnt lgkmcnt(4)
    ds_read_b64_tr_b16 a[190:191], v229 offset:47104
    v_mfma_f32_16x16x32_bf16 v[0:3], a[160:163], v[192:195], v[0:3]
    v_exp_f32 v206, v206
    v_mfma_f32_16x16x32_bf16 v[4:7], a[164:167], v[192:195], v[4:7]
    v_add_f32 v237, v237, v204
    v_mfma_f32_16x16x32_bf16 v[8:11], a[168:171], v[192:195], v[8:11]
    v_exp_f32 v207, v207
    v_mfma_f32_16x16x32_bf16 v[12:15], a[172:175], v[192:195], v[12:15]
    v_add_f32 v237, v237, v205
    v_cvt_pk_bf16_f32 v202, v204, v205
    v_mfma_f32_16x16x32_bf16 v[16:19], a[176:179], v[192:195], v[16:19]
    s_waitcnt lgkmcnt(1)
    v_add_f32 v237, v237, v206
    v_add_f32 v237, v237, v207
    v_mfma_f32_16x16x32_bf16 v[20:23], a[180:183], v[192:195], v[20:23]
    v_cvt_pk_bf16_f32 v203, v206, v207
    v_mfma_f32_16x16x32_bf16 v[24:27], a[184:187], v[192:195], v[24:27]
    s_waitcnt lgkmcnt(0)
    v_exp_f32 v208, v208
    v_mfma_f32_16x16x32_bf16 v[28:31], a[188:191], v[192:195], v[28:31]
    v_exp_f32 v209, v209
    v_mfma_f32_16x16x32_bf16 v[212:215], a[144:147], a[32:35], v[232:235]
    v_exp_f32 v210, v210
    v_mfma_f32_16x16x32_bf16 v[220:223], a[144:147], a[48:51], v[232:235]
    v_add_f32 v238, v238, v208
    v_mfma_f32_16x16x32_bf16 v[212:215], a[148:151], a[36:39], v[212:215]
    v_exp_f32 v211, v211
    v_mfma_f32_16x16x32_bf16 v[220:223], a[148:151], a[52:55], v[220:223]
    v_add_f32 v238, v238, v209
    v_cvt_pk_bf16_f32 v208, v208, v209
    v_mfma_f32_16x16x32_bf16 v[212:215], a[152:155], a[40:43], v[212:215]
    v_exp_f32 v216, v216
    v_mfma_f32_16x16x32_bf16 v[220:223], a[152:155], a[56:59], v[220:223]
    v_add_f32 v238, v238, v210
    v_mfma_f32_16x16x32_bf16 v[212:215], a[156:159], a[44:47], v[212:215]
    v_exp_f32 v217, v217
    v_mfma_f32_16x16x32_bf16 v[220:223], a[156:159], a[60:63], v[220:223]
    v_add_f32 v238, v238, v211
    v_cvt_pk_bf16_f32 v209, v210, v211
    v_mfma_f32_16x16x32_bf16 v[32:35], a[160:163], v[200:203], v[32:35]
    v_exp_f32 v218, v218
    v_mfma_f32_16x16x32_bf16 v[36:39], a[164:167], v[200:203], v[36:39]
    v_add_f32 v239, v239, v216
    v_exp_f32 v219, v219
    v_mfma_f32_16x16x32_bf16 v[40:43], a[168:171], v[200:203], v[40:43]
    v_add_f32 v239, v239, v217
    v_cvt_pk_bf16_f32 v216, v216, v217
    v_mfma_f32_16x16x32_bf16 v[44:47], a[172:175], v[200:203], v[44:47]
    v_exp_f32 v212, v212
    v_mfma_f32_16x16x32_bf16 v[48:51], a[176:179], v[200:203], v[48:51]
    v_add_f32 v239, v239, v218
    v_mfma_f32_16x16x32_bf16 v[52:55], a[180:183], v[200:203], v[52:55]
    v_exp_f32 v213, v213
    v_mfma_f32_16x16x32_bf16 v[56:59], a[184:187], v[200:203], v[56:59]
    v_add_f32 v239, v239, v219
    v_cvt_pk_bf16_f32 v217, v218, v219
    v_mfma_f32_16x16x32_bf16 v[60:63], a[188:191], v[200:203], v[60:63]
    v_exp_f32 v214, v214
    v_mfma_f32_16x16x32_bf16 v[192:195], a[128:131], a[64:67], v[232:235]
    v_add_f32 v238, v238, v212
    v_exp_f32 v215, v215
    v_mfma_f32_16x16x32_bf16 v[200:203], a[128:131], a[80:83], v[232:235]
    v_add_f32 v238, v238, v213
    v_cvt_pk_bf16_f32 v210, v212, v213
    v_mfma_f32_16x16x32_bf16 v[192:195], a[132:135], a[68:71], v[192:195]
    v_exp_f32 v220, v220
    v_mfma_f32_16x16x32_bf16 v[200:203], a[132:135], a[84:87], v[200:203]
    v_add_f32 v238, v238, v214
    v_mfma_f32_16x16x32_bf16 v[192:195], a[136:139], a[72:75], v[192:195]
    v_exp_f32 v221, v221
    v_mfma_f32_16x16x32_bf16 v[200:203], a[136:139], a[88:91], v[200:203]
    v_add_f32 v238, v238, v215
    v_cvt_pk_bf16_f32 v211, v214, v215
    v_mfma_f32_16x16x32_bf16 v[192:195], a[140:143], a[76:79], v[192:195]
    v_exp_f32 v222, v222
    v_mfma_f32_16x16x32_bf16 v[200:203], a[140:143], a[92:95], v[200:203]
    v_add_f32 v239, v239, v220
    v_mfma_f32_16x16x32_bf16 v[64:67], a[160:163], v[208:211], v[64:67]
    v_exp_f32 v223, v223
    v_mfma_f32_16x16x32_bf16 v[68:71], a[164:167], v[208:211], v[68:71]
    v_add_f32 v239, v239, v221
    v_cvt_pk_bf16_f32 v218, v220, v221
    v_mfma_f32_16x16x32_bf16 v[72:75], a[168:171], v[208:211], v[72:75]
    v_add_f32 v239, v239, v222
    v_add_f32 v239, v239, v223
    v_mfma_f32_16x16x32_bf16 v[76:79], a[172:175], v[208:211], v[76:79]
    v_cvt_pk_bf16_f32 v219, v222, v223
    v_mfma_f32_16x16x32_bf16 v[80:83], a[176:179], v[208:211], v[80:83]
    v_exp_f32 v192, v192
    v_mfma_f32_16x16x32_bf16 v[84:87], a[180:183], v[208:211], v[84:87]
    v_exp_f32 v193, v193
    v_mfma_f32_16x16x32_bf16 v[88:91], a[184:187], v[208:211], v[88:91]
    v_exp_f32 v194, v194
    v_mfma_f32_16x16x32_bf16 v[92:95], a[188:191], v[208:211], v[92:95]
    s_waitcnt vmcnt(8)
    s_barrier
    v_add_f32 v240, v240, v192
    v_mfma_f32_16x16x32_bf16 v[196:199], a[144:147], a[64:67], v[232:235]
    s_add_u32 m0, s21, 98304
    v_exp_f32 v195, v195
    v_mfma_f32_16x16x32_bf16 v[204:207], a[144:147], a[80:83], v[232:235]
    s_mov_b32 s23, 114688
    v_add_f32 v240, v240, v193
    v_cvt_pk_bf16_f32 v192, v192, v193
    v_mfma_f32_16x16x32_bf16 v[196:199], a[148:151], a[68:71], v[196:199]
    v_exp_f32 v200, v200
    v_mfma_f32_16x16x32_bf16 v[204:207], a[148:151], a[84:87], v[204:207]
    v_add_f32 v240, v240, v194
    v_mfma_f32_16x16x32_bf16 v[196:199], a[152:155], a[72:75], v[196:199]
    v_exp_f32 v201, v201
    v_mfma_f32_16x16x32_bf16 v[204:207], a[152:155], a[88:91], v[204:207]
    v_add_f32 v240, v240, v195
    v_cvt_pk_bf16_f32 v193, v194, v195
    v_mfma_f32_16x16x32_bf16 v[196:199], a[156:159], a[76:79], v[196:199]
    v_exp_f32 v202, v202
    v_mfma_f32_16x16x32_bf16 v[204:207], a[156:159], a[92:95], v[204:207]
    v_add_f32 v241, v241, v200
    v_mfma_f32_16x16x32_bf16 v[96:99], a[160:163], v[216:219], v[96:99]
    v_exp_f32 v203, v203
    v_mfma_f32_16x16x32_bf16 v[100:103], a[164:167], v[216:219], v[100:103]
    v_add_f32 v241, v241, v201
    v_cvt_pk_bf16_f32 v200, v200, v201
    v_mfma_f32_16x16x32_bf16 v[104:107], a[168:171], v[216:219], v[104:107]
    buffer_load_dwordx4 v244, s[8:11], s23 offen offset:0 nt lds
    v_mfma_f32_16x16x32_bf16 v[108:111], a[172:175], v[216:219], v[108:111]
    v_exp_f32 v196, v196
    v_mfma_f32_16x16x32_bf16 v[112:115], a[176:179], v[216:219], v[112:115]
    s_add_u32 m0, s21, 102272
    v_add_f32 v241, v241, v202
    v_mfma_f32_16x16x32_bf16 v[116:119], a[180:183], v[216:219], v[116:119]
    v_exp_f32 v197, v197
    v_mfma_f32_16x16x32_bf16 v[120:123], a[184:187], v[216:219], v[120:123]
    v_add_f32 v241, v241, v203
    v_cvt_pk_bf16_f32 v201, v202, v203
    v_mfma_f32_16x16x32_bf16 v[124:127], a[188:191], v[216:219], v[124:127]
    v_exp_f32 v198, v198
    v_mfma_f32_16x16x32_bf16 v[208:211], a[128:131], a[96:99], v[232:235]
    v_add_f32 v240, v240, v196
    v_exp_f32 v199, v199
    v_mfma_f32_16x16x32_bf16 v[216:219], a[128:131], a[112:115], v[232:235]
    v_add_f32 v240, v240, v197
    v_cvt_pk_bf16_f32 v194, v196, v197
    v_mfma_f32_16x16x32_bf16 v[208:211], a[132:135], a[100:103], v[208:211]
    v_exp_f32 v204, v204
    v_mfma_f32_16x16x32_bf16 v[216:219], a[132:135], a[116:119], v[216:219]
    ds_read_b128 a[128:131], v224 offset:49152
    v_add_f32 v240, v240, v198
    v_mfma_f32_16x16x32_bf16 v[208:211], a[136:139], a[104:107], v[208:211]
    v_exp_f32 v205, v205
    v_mfma_f32_16x16x32_bf16 v[216:219], a[136:139], a[120:123], v[216:219]
    v_add_f32 v240, v240, v199
    v_cvt_pk_bf16_f32 v195, v198, v199
    v_mfma_f32_16x16x32_bf16 v[208:211], a[140:143], a[108:111], v[208:211]
    buffer_load_dwordx4 v244, s[8:11], s23 offen offset:128 nt lds
    v_mfma_f32_16x16x32_bf16 v[216:219], a[140:143], a[124:127], v[216:219]
    v_exp_f32 v206, v206
    v_mfma_f32_16x16x32_bf16 v[128:131], a[160:163], v[192:195], v[128:131]
    s_add_u32 m0, s21, 106496
    ds_read_b128 a[132:135], v225 offset:49152
    v_add_f32 v241, v241, v204
    v_mfma_f32_16x16x32_bf16 v[132:135], a[164:167], v[192:195], v[132:135]
    v_exp_f32 v207, v207
    v_mfma_f32_16x16x32_bf16 v[136:139], a[168:171], v[192:195], v[136:139]
    v_add_f32 v241, v241, v205
    v_cvt_pk_bf16_f32 v202, v204, v205
    v_mfma_f32_16x16x32_bf16 v[140:143], a[172:175], v[192:195], v[140:143]
    v_add_f32 v241, v241, v206
    v_add_f32 v241, v241, v207
    v_mfma_f32_16x16x32_bf16 v[144:147], a[176:179], v[192:195], v[144:147]
    ds_read_b128 a[136:139], v224 offset:53248
    v_cvt_pk_bf16_f32 v203, v206, v207
    v_mfma_f32_16x16x32_bf16 v[148:151], a[180:183], v[192:195], v[148:151]
    v_exp_f32 v208, v208
    v_mfma_f32_16x16x32_bf16 v[152:155], a[184:187], v[192:195], v[152:155]
    v_exp_f32 v209, v209
    v_mfma_f32_16x16x32_bf16 v[156:159], a[188:191], v[192:195], v[156:159]
    v_exp_f32 v210, v210
    v_mfma_f32_16x16x32_bf16 v[212:215], a[144:147], a[96:99], v[232:235]
    ds_read_b128 a[140:143], v225 offset:53248
    v_add_f32 v242, v242, v208
    v_mfma_f32_16x16x32_bf16 v[220:223], a[144:147], a[112:115], v[232:235]
    v_exp_f32 v211, v211
    v_mfma_f32_16x16x32_bf16 v[212:215], a[148:151], a[100:103], v[212:215]
    buffer_load_dwordx4 v244, s[12:15], s23 offen offset:0 nt lds
    v_mfma_f32_16x16x32_bf16 v[220:223], a[148:151], a[116:119], v[220:223]
    v_add_f32 v242, v242, v209
    v_cvt_pk_bf16_f32 v208, v208, v209
    v_mfma_f32_16x16x32_bf16 v[212:215], a[152:155], a[104:107], v[212:215]
    s_add_u32 m0, s21, 110464
    v_exp_f32 v216, v216
    v_mfma_f32_16x16x32_bf16 v[220:223], a[152:155], a[120:123], v[220:223]
    ds_read_b128 a[144:147], v224 offset:51200
    v_add_f32 v242, v242, v210
    v_mfma_f32_16x16x32_bf16 v[212:215], a[156:159], a[108:111], v[212:215]
    v_exp_f32 v217, v217
    v_mfma_f32_16x16x32_bf16 v[220:223], a[156:159], a[124:127], v[220:223]
    v_add_f32 v242, v242, v211
    v_cvt_pk_bf16_f32 v209, v210, v211
    v_mfma_f32_16x16x32_bf16 v[160:163], a[160:163], v[200:203], v[160:163]
    v_exp_f32 v218, v218
    v_mfma_f32_16x16x32_bf16 v[164:167], a[164:167], v[200:203], v[164:167]
    ds_read_b128 a[148:151], v225 offset:51200
    v_add_f32 v243, v243, v216
    v_mfma_f32_16x16x32_bf16 v[168:171], a[168:171], v[200:203], v[168:171]
    v_exp_f32 v219, v219
    v_mfma_f32_16x16x32_bf16 v[172:175], a[172:175], v[200:203], v[172:175]
    v_add_f32 v243, v243, v217
    v_cvt_pk_bf16_f32 v216, v216, v217
    v_mfma_f32_16x16x32_bf16 v[176:179], a[176:179], v[200:203], v[176:179]
    v_exp_f32 v212, v212
    v_mfma_f32_16x16x32_bf16 v[180:183], a[180:183], v[200:203], v[180:183]
    ds_read_b128 a[152:155], v224 offset:55296
    v_add_f32 v243, v243, v218
    v_mfma_f32_16x16x32_bf16 v[184:187], a[184:187], v[200:203], v[184:187]
    v_exp_f32 v213, v213
    v_add_f32 v243, v243, v219
    v_mfma_f32_16x16x32_bf16 v[188:191], a[188:191], v[200:203], v[188:191]
    s_waitcnt lgkmcnt(1)
    buffer_load_dwordx4 v244, s[12:15], s23 offen offset:128 nt lds
    v_cvt_pk_bf16_f32 v217, v218, v219
    v_mfma_f32_16x16x32_bf16 v[192:195], a[128:131], a[0:3], v[232:235]
    v_exp_f32 v214, v214
    v_add_f32 v242, v242, v212
    v_mfma_f32_16x16x32_bf16 v[200:203], a[128:131], a[16:19], v[232:235]
    v_exp_f32 v215, v215
    v_mfma_f32_16x16x32_bf16 v[192:195], a[132:135], a[4:7], v[192:195]
    v_add_f32 v242, v242, v213
    v_cvt_pk_bf16_f32 v210, v212, v213
    v_mfma_f32_16x16x32_bf16 v[200:203], a[132:135], a[20:23], v[200:203]
    v_exp_f32 v220, v220
    v_mfma_f32_16x16x32_bf16 v[192:195], a[136:139], a[8:11], v[192:195]
    ds_read_b128 a[156:159], v225 offset:55296
    v_add_f32 v242, v242, v214
    v_mfma_f32_16x16x32_bf16 v[200:203], a[136:139], a[24:27], v[200:203]
    v_exp_f32 v221, v221
    v_add_f32 v242, v242, v215
    v_mfma_f32_16x16x32_bf16 v[192:195], a[140:143], a[12:15], v[192:195]
    v_cvt_pk_bf16_f32 v211, v214, v215
    v_mfma_f32_16x16x32_bf16 v[200:203], a[140:143], a[28:31], v[200:203]
    v_exp_f32 v222, v222
    v_mfma_f32_16x16x32_bf16 a[192:195], a[160:163], v[208:211], a[192:195]
    v_add_f32 v243, v243, v220
    v_mfma_f32_16x16x32_bf16 a[196:199], a[164:167], v[208:211], a[196:199]
    v_exp_f32 v223, v223
    v_mfma_f32_16x16x32_bf16 a[200:203], a[168:171], v[208:211], a[200:203]
    v_add_f32 v243, v243, v221
    v_cvt_pk_bf16_f32 v218, v220, v221
    v_mfma_f32_16x16x32_bf16 a[204:207], a[172:175], v[208:211], a[204:207]
    v_add_f32 v243, v243, v222
    v_add_f32 v243, v243, v223
    v_mfma_f32_16x16x32_bf16 a[208:211], a[176:179], v[208:211], a[208:211]
    v_cvt_pk_bf16_f32 v219, v222, v223
    v_mfma_f32_16x16x32_bf16 a[212:215], a[180:183], v[208:211], a[212:215]
    v_exp_f32 v192, v192
    v_mfma_f32_16x16x32_bf16 a[216:219], a[184:187], v[208:211], a[216:219]
    v_exp_f32 v193, v193
    v_mfma_f32_16x16x32_bf16 a[220:223], a[188:191], v[208:211], a[220:223]
    v_exp_f32 v194, v194
    v_mfma_f32_16x16x32_bf16 v[196:199], a[144:147], a[0:3], v[232:235]
    v_add_f32 v236, v236, v192
    v_mfma_f32_16x16x32_bf16 v[204:207], a[144:147], a[16:19], v[232:235]
    v_exp_f32 v195, v195
    v_mfma_f32_16x16x32_bf16 v[196:199], a[148:151], a[4:7], v[196:199]
    v_add_f32 v236, v236, v193
    v_cvt_pk_bf16_f32 v192, v192, v193
    v_mfma_f32_16x16x32_bf16 v[204:207], a[148:151], a[20:23], v[204:207]
    s_waitcnt lgkmcnt(0)
    v_exp_f32 v200, v200
    v_mfma_f32_16x16x32_bf16 v[196:199], a[152:155], a[8:11], v[196:199]
    v_add_f32 v236, v236, v194
    v_mfma_f32_16x16x32_bf16 v[204:207], a[152:155], a[24:27], v[204:207]
    v_exp_f32 v201, v201
    v_mfma_f32_16x16x32_bf16 v[196:199], a[156:159], a[12:15], v[196:199]
    v_add_f32 v236, v236, v195
    v_cvt_pk_bf16_f32 v193, v194, v195
    v_mfma_f32_16x16x32_bf16 v[204:207], a[156:159], a[28:31], v[204:207]
    v_exp_f32 v202, v202
    v_mfma_f32_16x16x32_bf16 a[224:227], a[160:163], v[216:219], a[224:227]
    ds_read_b64_tr_b16 a[160:161], v226 offset:57344
    v_add_f32 v237, v237, v200
    v_mfma_f32_16x16x32_bf16 a[228:231], a[164:167], v[216:219], a[228:231]
    ds_read_b64_tr_b16 a[162:163], v226 offset:59392
    ds_read_b64_tr_b16 a[164:165], v227 offset:57344
    v_mfma_f32_16x16x32_bf16 a[232:235], a[168:171], v[216:219], a[232:235]
    v_exp_f32 v203, v203
    v_mfma_f32_16x16x32_bf16 a[236:239], a[172:175], v[216:219], a[236:239]
    ds_read_b64_tr_b16 a[166:167], v227 offset:59392
    v_add_f32 v237, v237, v201
    v_cvt_pk_bf16_f32 v200, v200, v201
    v_mfma_f32_16x16x32_bf16 a[240:243], a[176:179], v[216:219], a[240:243]
    ds_read_b64_tr_b16 a[168:169], v228 offset:57344
    v_exp_f32 v196, v196
    v_mfma_f32_16x16x32_bf16 a[244:247], a[180:183], v[216:219], a[244:247]
    ds_read_b64_tr_b16 a[170:171], v228 offset:59392
    v_add_f32 v237, v237, v202
    v_mfma_f32_16x16x32_bf16 a[248:251], a[184:187], v[216:219], a[248:251]
    ds_read_b64_tr_b16 a[172:173], v229 offset:57344
    v_exp_f32 v197, v197
    v_add_f32 v237, v237, v203
    v_mfma_f32_16x16x32_bf16 a[252:255], a[188:191], v[216:219], a[252:255]
    ds_read_b64_tr_b16 a[174:175], v229 offset:59392
    v_cvt_pk_bf16_f32 v201, v202, v203
    v_mfma_f32_16x16x32_bf16 v[208:211], a[128:131], a[32:35], v[232:235]
    ds_read_b64_tr_b16 a[176:177], v226 offset:61440
    v_exp_f32 v198, v198
    v_add_f32 v236, v236, v196
    v_mfma_f32_16x16x32_bf16 v[216:219], a[128:131], a[48:51], v[232:235]
    ds_read_b64_tr_b16 a[178:179], v226 offset:63488
    v_exp_f32 v199, v199
    v_mfma_f32_16x16x32_bf16 v[208:211], a[132:135], a[36:39], v[208:211]
    ds_read_b64_tr_b16 a[180:181], v227 offset:61440
    v_add_f32 v236, v236, v197
    v_cvt_pk_bf16_f32 v194, v196, v197
    v_mfma_f32_16x16x32_bf16 v[216:219], a[132:135], a[52:55], v[216:219]
    ds_read_b64_tr_b16 a[182:183], v227 offset:63488
    v_exp_f32 v204, v204
    v_mfma_f32_16x16x32_bf16 v[208:211], a[136:139], a[40:43], v[208:211]
    ds_read_b64_tr_b16 a[184:185], v228 offset:61440
    v_add_f32 v236, v236, v198
    v_mfma_f32_16x16x32_bf16 v[216:219], a[136:139], a[56:59], v[216:219]
    ds_read_b64_tr_b16 a[186:187], v228 offset:63488
    v_exp_f32 v205, v205
    v_add_f32 v236, v236, v199
    v_mfma_f32_16x16x32_bf16 v[208:211], a[140:143], a[44:47], v[208:211]
    ds_read_b64_tr_b16 a[188:189], v229 offset:61440
    v_cvt_pk_bf16_f32 v195, v198, v199
    v_mfma_f32_16x16x32_bf16 v[216:219], a[140:143], a[60:63], v[216:219]
    s_waitcnt lgkmcnt(4)
    ds_read_b64_tr_b16 a[190:191], v229 offset:63488
    v_mfma_f32_16x16x32_bf16 v[0:3], a[160:163], v[192:195], v[0:3]
    v_exp_f32 v206, v206
    v_mfma_f32_16x16x32_bf16 v[4:7], a[164:167], v[192:195], v[4:7]
    v_add_f32 v237, v237, v204
    v_mfma_f32_16x16x32_bf16 v[8:11], a[168:171], v[192:195], v[8:11]
    v_exp_f32 v207, v207
    v_mfma_f32_16x16x32_bf16 v[12:15], a[172:175], v[192:195], v[12:15]
    v_add_f32 v237, v237, v205
    v_cvt_pk_bf16_f32 v202, v204, v205
    v_mfma_f32_16x16x32_bf16 v[16:19], a[176:179], v[192:195], v[16:19]
    s_waitcnt lgkmcnt(1)
    v_add_f32 v237, v237, v206
    v_add_f32 v237, v237, v207
    v_mfma_f32_16x16x32_bf16 v[20:23], a[180:183], v[192:195], v[20:23]
    v_cvt_pk_bf16_f32 v203, v206, v207
    v_mfma_f32_16x16x32_bf16 v[24:27], a[184:187], v[192:195], v[24:27]
    s_waitcnt lgkmcnt(0)
    v_exp_f32 v208, v208
    v_mfma_f32_16x16x32_bf16 v[28:31], a[188:191], v[192:195], v[28:31]
    v_exp_f32 v209, v209
    v_mfma_f32_16x16x32_bf16 v[212:215], a[144:147], a[32:35], v[232:235]
    v_exp_f32 v210, v210
    v_mfma_f32_16x16x32_bf16 v[220:223], a[144:147], a[48:51], v[232:235]
    v_add_f32 v238, v238, v208
    v_mfma_f32_16x16x32_bf16 v[212:215], a[148:151], a[36:39], v[212:215]
    v_exp_f32 v211, v211
    v_mfma_f32_16x16x32_bf16 v[220:223], a[148:151], a[52:55], v[220:223]
    v_add_f32 v238, v238, v209
    v_cvt_pk_bf16_f32 v208, v208, v209
    v_mfma_f32_16x16x32_bf16 v[212:215], a[152:155], a[40:43], v[212:215]
    v_exp_f32 v216, v216
    v_mfma_f32_16x16x32_bf16 v[220:223], a[152:155], a[56:59], v[220:223]
    v_add_f32 v238, v238, v210
    v_mfma_f32_16x16x32_bf16 v[212:215], a[156:159], a[44:47], v[212:215]
    v_exp_f32 v217, v217
    v_mfma_f32_16x16x32_bf16 v[220:223], a[156:159], a[60:63], v[220:223]
    v_add_f32 v238, v238, v211
    v_cvt_pk_bf16_f32 v209, v210, v211
    v_mfma_f32_16x16x32_bf16 v[32:35], a[160:163], v[200:203], v[32:35]
    v_exp_f32 v218, v218
    v_mfma_f32_16x16x32_bf16 v[36:39], a[164:167], v[200:203], v[36:39]
    v_add_f32 v239, v239, v216
    v_exp_f32 v219, v219
    v_mfma_f32_16x16x32_bf16 v[40:43], a[168:171], v[200:203], v[40:43]
    v_add_f32 v239, v239, v217
    v_cvt_pk_bf16_f32 v216, v216, v217
    v_mfma_f32_16x16x32_bf16 v[44:47], a[172:175], v[200:203], v[44:47]
    v_exp_f32 v212, v212
    v_mfma_f32_16x16x32_bf16 v[48:51], a[176:179], v[200:203], v[48:51]
    v_add_f32 v239, v239, v218
    v_mfma_f32_16x16x32_bf16 v[52:55], a[180:183], v[200:203], v[52:55]
    v_exp_f32 v213, v213
    v_mfma_f32_16x16x32_bf16 v[56:59], a[184:187], v[200:203], v[56:59]
    v_add_f32 v239, v239, v219
    v_cvt_pk_bf16_f32 v217, v218, v219
    v_mfma_f32_16x16x32_bf16 v[60:63], a[188:191], v[200:203], v[60:63]
    v_exp_f32 v214, v214
    v_mfma_f32_16x16x32_bf16 v[192:195], a[128:131], a[64:67], v[232:235]
    v_add_f32 v238, v238, v212
    v_exp_f32 v215, v215
    v_mfma_f32_16x16x32_bf16 v[200:203], a[128:131], a[80:83], v[232:235]
    v_add_f32 v238, v238, v213
    v_cvt_pk_bf16_f32 v210, v212, v213
    v_mfma_f32_16x16x32_bf16 v[192:195], a[132:135], a[68:71], v[192:195]
    v_exp_f32 v220, v220
    v_mfma_f32_16x16x32_bf16 v[200:203], a[132:135], a[84:87], v[200:203]
    v_add_f32 v238, v238, v214
    v_mfma_f32_16x16x32_bf16 v[192:195], a[136:139], a[72:75], v[192:195]
    v_exp_f32 v221, v221
    v_mfma_f32_16x16x32_bf16 v[200:203], a[136:139], a[88:91], v[200:203]
    v_add_f32 v238, v238, v215
    v_cvt_pk_bf16_f32 v211, v214, v215
    v_mfma_f32_16x16x32_bf16 v[192:195], a[140:143], a[76:79], v[192:195]
    v_exp_f32 v222, v222
    v_mfma_f32_16x16x32_bf16 v[200:203], a[140:143], a[92:95], v[200:203]
    v_add_f32 v239, v239, v220
    v_mfma_f32_16x16x32_bf16 v[64:67], a[160:163], v[208:211], v[64:67]
    v_exp_f32 v223, v223
    v_mfma_f32_16x16x32_bf16 v[68:71], a[164:167], v[208:211], v[68:71]
    v_add_f32 v239, v239, v221
    v_cvt_pk_bf16_f32 v218, v220, v221
    v_mfma_f32_16x16x32_bf16 v[72:75], a[168:171], v[208:211], v[72:75]
    v_add_f32 v239, v239, v222
    v_add_f32 v239, v239, v223
    v_mfma_f32_16x16x32_bf16 v[76:79], a[172:175], v[208:211], v[76:79]
    v_cvt_pk_bf16_f32 v219, v222, v223
    v_mfma_f32_16x16x32_bf16 v[80:83], a[176:179], v[208:211], v[80:83]
    v_exp_f32 v192, v192
    v_mfma_f32_16x16x32_bf16 v[84:87], a[180:183], v[208:211], v[84:87]
    v_exp_f32 v193, v193
    v_mfma_f32_16x16x32_bf16 v[88:91], a[184:187], v[208:211], v[88:91]
    v_exp_f32 v194, v194
    v_mfma_f32_16x16x32_bf16 v[92:95], a[188:191], v[208:211], v[92:95]
    s_waitcnt vmcnt(8)
    s_barrier
    v_add_f32 v240, v240, v192
    v_mfma_f32_16x16x32_bf16 v[196:199], a[144:147], a[64:67], v[232:235]
    s_add_u32 m0, s21, 114688
    v_exp_f32 v195, v195
    v_mfma_f32_16x16x32_bf16 v[204:207], a[144:147], a[80:83], v[232:235]
    s_mov_b32 s23, 122880
    v_add_f32 v240, v240, v193
    v_cvt_pk_bf16_f32 v192, v192, v193
    v_mfma_f32_16x16x32_bf16 v[196:199], a[148:151], a[68:71], v[196:199]
    v_exp_f32 v200, v200
    v_mfma_f32_16x16x32_bf16 v[204:207], a[148:151], a[84:87], v[204:207]
    v_add_f32 v240, v240, v194
    v_mfma_f32_16x16x32_bf16 v[196:199], a[152:155], a[72:75], v[196:199]
    v_exp_f32 v201, v201
    v_mfma_f32_16x16x32_bf16 v[204:207], a[152:155], a[88:91], v[204:207]
    v_add_f32 v240, v240, v195
    v_cvt_pk_bf16_f32 v193, v194, v195
    v_mfma_f32_16x16x32_bf16 v[196:199], a[156:159], a[76:79], v[196:199]
    v_exp_f32 v202, v202
    v_mfma_f32_16x16x32_bf16 v[204:207], a[156:159], a[92:95], v[204:207]
    v_add_f32 v241, v241, v200
    v_mfma_f32_16x16x32_bf16 v[96:99], a[160:163], v[216:219], v[96:99]
    v_exp_f32 v203, v203
    v_mfma_f32_16x16x32_bf16 v[100:103], a[164:167], v[216:219], v[100:103]
    v_add_f32 v241, v241, v201
    v_cvt_pk_bf16_f32 v200, v200, v201
    v_mfma_f32_16x16x32_bf16 v[104:107], a[168:171], v[216:219], v[104:107]
    buffer_load_dwordx4 v244, s[8:11], s23 offen offset:0 nt lds
    v_mfma_f32_16x16x32_bf16 v[108:111], a[172:175], v[216:219], v[108:111]
    v_exp_f32 v196, v196
    v_mfma_f32_16x16x32_bf16 v[112:115], a[176:179], v[216:219], v[112:115]
    s_add_u32 m0, s21, 118656
    v_add_f32 v241, v241, v202
    v_mfma_f32_16x16x32_bf16 v[116:119], a[180:183], v[216:219], v[116:119]
    v_exp_f32 v197, v197
    v_mfma_f32_16x16x32_bf16 v[120:123], a[184:187], v[216:219], v[120:123]
    v_add_f32 v241, v241, v203
    v_cvt_pk_bf16_f32 v201, v202, v203
    v_mfma_f32_16x16x32_bf16 v[124:127], a[188:191], v[216:219], v[124:127]
    v_exp_f32 v198, v198
    v_mfma_f32_16x16x32_bf16 v[208:211], a[128:131], a[96:99], v[232:235]
    v_add_f32 v240, v240, v196
    v_exp_f32 v199, v199
    v_mfma_f32_16x16x32_bf16 v[216:219], a[128:131], a[112:115], v[232:235]
    v_add_f32 v240, v240, v197
    v_cvt_pk_bf16_f32 v194, v196, v197
    v_mfma_f32_16x16x32_bf16 v[208:211], a[132:135], a[100:103], v[208:211]
    v_exp_f32 v204, v204
    v_mfma_f32_16x16x32_bf16 v[216:219], a[132:135], a[116:119], v[216:219]
    ds_read_b128 a[128:131], v224 offset:0
    v_add_f32 v240, v240, v198
    v_mfma_f32_16x16x32_bf16 v[208:211], a[136:139], a[104:107], v[208:211]
    v_exp_f32 v205, v205
    v_mfma_f32_16x16x32_bf16 v[216:219], a[136:139], a[120:123], v[216:219]
    v_add_f32 v240, v240, v199
    v_cvt_pk_bf16_f32 v195, v198, v199
    v_mfma_f32_16x16x32_bf16 v[208:211], a[140:143], a[108:111], v[208:211]
    buffer_load_dwordx4 v244, s[8:11], s23 offen offset:128 nt lds
    v_mfma_f32_16x16x32_bf16 v[216:219], a[140:143], a[124:127], v[216:219]
    v_exp_f32 v206, v206
    v_mfma_f32_16x16x32_bf16 v[128:131], a[160:163], v[192:195], v[128:131]
    s_add_u32 m0, s21, 122880
    ds_read_b128 a[132:135], v225 offset:0
    v_add_f32 v241, v241, v204
    v_mfma_f32_16x16x32_bf16 v[132:135], a[164:167], v[192:195], v[132:135]
    v_exp_f32 v207, v207
    v_mfma_f32_16x16x32_bf16 v[136:139], a[168:171], v[192:195], v[136:139]
    v_add_f32 v241, v241, v205
    v_cvt_pk_bf16_f32 v202, v204, v205
    v_mfma_f32_16x16x32_bf16 v[140:143], a[172:175], v[192:195], v[140:143]
    v_add_f32 v241, v241, v206
    v_add_f32 v241, v241, v207
    v_mfma_f32_16x16x32_bf16 v[144:147], a[176:179], v[192:195], v[144:147]
    ds_read_b128 a[136:139], v224 offset:4096
    v_cvt_pk_bf16_f32 v203, v206, v207
    v_mfma_f32_16x16x32_bf16 v[148:151], a[180:183], v[192:195], v[148:151]
    v_exp_f32 v208, v208
    v_mfma_f32_16x16x32_bf16 v[152:155], a[184:187], v[192:195], v[152:155]
    v_exp_f32 v209, v209
    v_mfma_f32_16x16x32_bf16 v[156:159], a[188:191], v[192:195], v[156:159]
    v_exp_f32 v210, v210
    v_mfma_f32_16x16x32_bf16 v[212:215], a[144:147], a[96:99], v[232:235]
    ds_read_b128 a[140:143], v225 offset:4096
    v_add_f32 v242, v242, v208
    v_mfma_f32_16x16x32_bf16 v[220:223], a[144:147], a[112:115], v[232:235]
    v_exp_f32 v211, v211
    v_mfma_f32_16x16x32_bf16 v[212:215], a[148:151], a[100:103], v[212:215]
    buffer_load_dwordx4 v244, s[12:15], s23 offen offset:0 nt lds
    v_mfma_f32_16x16x32_bf16 v[220:223], a[148:151], a[116:119], v[220:223]
    v_add_f32 v242, v242, v209
    v_cvt_pk_bf16_f32 v208, v208, v209
    v_mfma_f32_16x16x32_bf16 v[212:215], a[152:155], a[104:107], v[212:215]
    s_add_u32 m0, s21, 126848
    v_exp_f32 v216, v216
    v_mfma_f32_16x16x32_bf16 v[220:223], a[152:155], a[120:123], v[220:223]
    ds_read_b128 a[144:147], v224 offset:2048
    v_add_f32 v242, v242, v210
    v_mfma_f32_16x16x32_bf16 v[212:215], a[156:159], a[108:111], v[212:215]
    v_exp_f32 v217, v217
    v_mfma_f32_16x16x32_bf16 v[220:223], a[156:159], a[124:127], v[220:223]
    v_add_f32 v242, v242, v211
    v_cvt_pk_bf16_f32 v209, v210, v211
    v_mfma_f32_16x16x32_bf16 v[160:163], a[160:163], v[200:203], v[160:163]
    v_exp_f32 v218, v218
    v_mfma_f32_16x16x32_bf16 v[164:167], a[164:167], v[200:203], v[164:167]
    ds_read_b128 a[148:151], v225 offset:2048
    v_add_f32 v243, v243, v216
    v_mfma_f32_16x16x32_bf16 v[168:171], a[168:171], v[200:203], v[168:171]
    v_exp_f32 v219, v219
    v_mfma_f32_16x16x32_bf16 v[172:175], a[172:175], v[200:203], v[172:175]
    v_add_f32 v243, v243, v217
    v_cvt_pk_bf16_f32 v216, v216, v217
    v_mfma_f32_16x16x32_bf16 v[176:179], a[176:179], v[200:203], v[176:179]
    v_exp_f32 v212, v212
    v_mfma_f32_16x16x32_bf16 v[180:183], a[180:183], v[200:203], v[180:183]
    ds_read_b128 a[152:155], v224 offset:6144
    v_add_f32 v243, v243, v218
    v_mfma_f32_16x16x32_bf16 v[184:187], a[184:187], v[200:203], v[184:187]
    v_exp_f32 v213, v213
    v_add_f32 v243, v243, v219
    v_mfma_f32_16x16x32_bf16 v[188:191], a[188:191], v[200:203], v[188:191]
    s_waitcnt lgkmcnt(1)
    buffer_load_dwordx4 v244, s[12:15], s23 offen offset:128 nt lds
    v_cvt_pk_bf16_f32 v217, v218, v219
    v_mfma_f32_16x16x32_bf16 v[192:195], a[128:131], a[0:3], v[232:235]
    v_exp_f32 v214, v214
    v_add_f32 v242, v242, v212
    v_mfma_f32_16x16x32_bf16 v[200:203], a[128:131], a[16:19], v[232:235]
    v_exp_f32 v215, v215
    v_mfma_f32_16x16x32_bf16 v[192:195], a[132:135], a[4:7], v[192:195]
    v_add_f32 v242, v242, v213
    v_cvt_pk_bf16_f32 v210, v212, v213
    v_mfma_f32_16x16x32_bf16 v[200:203], a[132:135], a[20:23], v[200:203]
    v_exp_f32 v220, v220
    v_mfma_f32_16x16x32_bf16 v[192:195], a[136:139], a[8:11], v[192:195]
    ds_read_b128 a[156:159], v225 offset:6144
    v_add_f32 v242, v242, v214
    v_mfma_f32_16x16x32_bf16 v[200:203], a[136:139], a[24:27], v[200:203]
    v_exp_f32 v221, v221
    v_add_f32 v242, v242, v215
    v_mfma_f32_16x16x32_bf16 v[192:195], a[140:143], a[12:15], v[192:195]
    v_cvt_pk_bf16_f32 v211, v214, v215
    v_mfma_f32_16x16x32_bf16 v[200:203], a[140:143], a[28:31], v[200:203]
    v_exp_f32 v222, v222
    v_mfma_f32_16x16x32_bf16 a[192:195], a[160:163], v[208:211], a[192:195]
    v_add_f32 v243, v243, v220
    v_mfma_f32_16x16x32_bf16 a[196:199], a[164:167], v[208:211], a[196:199]
    v_exp_f32 v223, v223
    v_mfma_f32_16x16x32_bf16 a[200:203], a[168:171], v[208:211], a[200:203]
    v_add_f32 v243, v243, v221
    v_cvt_pk_bf16_f32 v218, v220, v221
    v_mfma_f32_16x16x32_bf16 a[204:207], a[172:175], v[208:211], a[204:207]
    v_add_f32 v243, v243, v222
    v_add_f32 v243, v243, v223
    v_mfma_f32_16x16x32_bf16 a[208:211], a[176:179], v[208:211], a[208:211]
    v_cvt_pk_bf16_f32 v219, v222, v223
    v_mfma_f32_16x16x32_bf16 a[212:215], a[180:183], v[208:211], a[212:215]
    v_exp_f32 v192, v192
    v_mfma_f32_16x16x32_bf16 a[216:219], a[184:187], v[208:211], a[216:219]
    v_exp_f32 v193, v193
    v_mfma_f32_16x16x32_bf16 a[220:223], a[188:191], v[208:211], a[220:223]
    v_exp_f32 v194, v194
    v_mfma_f32_16x16x32_bf16 v[196:199], a[144:147], a[0:3], v[232:235]
    v_add_f32 v236, v236, v192
    v_mfma_f32_16x16x32_bf16 v[204:207], a[144:147], a[16:19], v[232:235]
    v_exp_f32 v195, v195
    v_mfma_f32_16x16x32_bf16 v[196:199], a[148:151], a[4:7], v[196:199]
    v_add_f32 v236, v236, v193
    v_cvt_pk_bf16_f32 v192, v192, v193
    v_mfma_f32_16x16x32_bf16 v[204:207], a[148:151], a[20:23], v[204:207]
    s_waitcnt lgkmcnt(0)
    v_exp_f32 v200, v200
    v_mfma_f32_16x16x32_bf16 v[196:199], a[152:155], a[8:11], v[196:199]
    v_add_f32 v236, v236, v194
    v_mfma_f32_16x16x32_bf16 v[204:207], a[152:155], a[24:27], v[204:207]
    v_exp_f32 v201, v201
    v_mfma_f32_16x16x32_bf16 v[196:199], a[156:159], a[12:15], v[196:199]
    v_add_f32 v236, v236, v195
    v_cvt_pk_bf16_f32 v193, v194, v195
    v_mfma_f32_16x16x32_bf16 v[204:207], a[156:159], a[28:31], v[204:207]
    v_exp_f32 v202, v202
    v_mfma_f32_16x16x32_bf16 a[224:227], a[160:163], v[216:219], a[224:227]
    ds_read_b64_tr_b16 a[160:161], v226 offset:8192
    v_add_f32 v237, v237, v200
    v_mfma_f32_16x16x32_bf16 a[228:231], a[164:167], v[216:219], a[228:231]
    ds_read_b64_tr_b16 a[162:163], v226 offset:10240
    ds_read_b64_tr_b16 a[164:165], v227 offset:8192
    v_mfma_f32_16x16x32_bf16 a[232:235], a[168:171], v[216:219], a[232:235]
    v_exp_f32 v203, v203
    v_mfma_f32_16x16x32_bf16 a[236:239], a[172:175], v[216:219], a[236:239]
    ds_read_b64_tr_b16 a[166:167], v227 offset:10240
    v_add_f32 v237, v237, v201
    v_cvt_pk_bf16_f32 v200, v200, v201
    v_mfma_f32_16x16x32_bf16 a[240:243], a[176:179], v[216:219], a[240:243]
    ds_read_b64_tr_b16 a[168:169], v228 offset:8192
    v_exp_f32 v196, v196
    v_mfma_f32_16x16x32_bf16 a[244:247], a[180:183], v[216:219], a[244:247]
    ds_read_b64_tr_b16 a[170:171], v228 offset:10240
    v_add_f32 v237, v237, v202
    v_mfma_f32_16x16x32_bf16 a[248:251], a[184:187], v[216:219], a[248:251]
    ds_read_b64_tr_b16 a[172:173], v229 offset:8192
    v_exp_f32 v197, v197
    v_add_f32 v237, v237, v203
    v_mfma_f32_16x16x32_bf16 a[252:255], a[188:191], v[216:219], a[252:255]
    ds_read_b64_tr_b16 a[174:175], v229 offset:10240
    v_cvt_pk_bf16_f32 v201, v202, v203
    v_mfma_f32_16x16x32_bf16 v[208:211], a[128:131], a[32:35], v[232:235]
    ds_read_b64_tr_b16 a[176:177], v226 offset:12288
    v_exp_f32 v198, v198
    v_add_f32 v236, v236, v196
    v_mfma_f32_16x16x32_bf16 v[216:219], a[128:131], a[48:51], v[232:235]
    ds_read_b64_tr_b16 a[178:179], v226 offset:14336
    v_exp_f32 v199, v199
    v_mfma_f32_16x16x32_bf16 v[208:211], a[132:135], a[36:39], v[208:211]
    ds_read_b64_tr_b16 a[180:181], v227 offset:12288
    v_add_f32 v236, v236, v197
    v_cvt_pk_bf16_f32 v194, v196, v197
    v_mfma_f32_16x16x32_bf16 v[216:219], a[132:135], a[52:55], v[216:219]
    ds_read_b64_tr_b16 a[182:183], v227 offset:14336
    v_exp_f32 v204, v204
    v_mfma_f32_16x16x32_bf16 v[208:211], a[136:139], a[40:43], v[208:211]
    ds_read_b64_tr_b16 a[184:185], v228 offset:12288
    v_add_f32 v236, v236, v198
    v_mfma_f32_16x16x32_bf16 v[216:219], a[136:139], a[56:59], v[216:219]
    ds_read_b64_tr_b16 a[186:187], v228 offset:14336
    v_exp_f32 v205, v205
    v_add_f32 v236, v236, v199
    v_mfma_f32_16x16x32_bf16 v[208:211], a[140:143], a[44:47], v[208:211]
    ds_read_b64_tr_b16 a[188:189], v229 offset:12288
    v_cvt_pk_bf16_f32 v195, v198, v199
    v_mfma_f32_16x16x32_bf16 v[216:219], a[140:143], a[60:63], v[216:219]
    s_waitcnt lgkmcnt(4)
    ds_read_b64_tr_b16 a[190:191], v229 offset:14336
    v_mfma_f32_16x16x32_bf16 v[0:3], a[160:163], v[192:195], v[0:3]
    v_exp_f32 v206, v206
    v_mfma_f32_16x16x32_bf16 v[4:7], a[164:167], v[192:195], v[4:7]
    v_add_f32 v237, v237, v204
    v_mfma_f32_16x16x32_bf16 v[8:11], a[168:171], v[192:195], v[8:11]
    v_exp_f32 v207, v207
    v_mfma_f32_16x16x32_bf16 v[12:15], a[172:175], v[192:195], v[12:15]
    v_add_f32 v237, v237, v205
    v_cvt_pk_bf16_f32 v202, v204, v205
    v_mfma_f32_16x16x32_bf16 v[16:19], a[176:179], v[192:195], v[16:19]
    s_waitcnt lgkmcnt(1)
    v_add_f32 v237, v237, v206
    v_add_f32 v237, v237, v207
    v_mfma_f32_16x16x32_bf16 v[20:23], a[180:183], v[192:195], v[20:23]
    v_cvt_pk_bf16_f32 v203, v206, v207
    v_mfma_f32_16x16x32_bf16 v[24:27], a[184:187], v[192:195], v[24:27]
    s_waitcnt lgkmcnt(0)
    v_exp_f32 v208, v208
    v_mfma_f32_16x16x32_bf16 v[28:31], a[188:191], v[192:195], v[28:31]
    v_exp_f32 v209, v209
    v_mfma_f32_16x16x32_bf16 v[212:215], a[144:147], a[32:35], v[232:235]
    v_exp_f32 v210, v210
    v_mfma_f32_16x16x32_bf16 v[220:223], a[144:147], a[48:51], v[232:235]
    v_add_f32 v238, v238, v208
    v_mfma_f32_16x16x32_bf16 v[212:215], a[148:151], a[36:39], v[212:215]
    v_exp_f32 v211, v211
    v_mfma_f32_16x16x32_bf16 v[220:223], a[148:151], a[52:55], v[220:223]
    v_add_f32 v238, v238, v209
    v_cvt_pk_bf16_f32 v208, v208, v209
    v_mfma_f32_16x16x32_bf16 v[212:215], a[152:155], a[40:43], v[212:215]
    v_exp_f32 v216, v216
    v_mfma_f32_16x16x32_bf16 v[220:223], a[152:155], a[56:59], v[220:223]
    v_add_f32 v238, v238, v210
    v_mfma_f32_16x16x32_bf16 v[212:215], a[156:159], a[44:47], v[212:215]
    v_exp_f32 v217, v217
    v_mfma_f32_16x16x32_bf16 v[220:223], a[156:159], a[60:63], v[220:223]
    v_add_f32 v238, v238, v211
    v_cvt_pk_bf16_f32 v209, v210, v211
    v_mfma_f32_16x16x32_bf16 v[32:35], a[160:163], v[200:203], v[32:35]
    v_exp_f32 v218, v218
    v_mfma_f32_16x16x32_bf16 v[36:39], a[164:167], v[200:203], v[36:39]
    v_add_f32 v239, v239, v216
    v_exp_f32 v219, v219
    v_mfma_f32_16x16x32_bf16 v[40:43], a[168:171], v[200:203], v[40:43]
    v_add_f32 v239, v239, v217
    v_cvt_pk_bf16_f32 v216, v216, v217
    v_mfma_f32_16x16x32_bf16 v[44:47], a[172:175], v[200:203], v[44:47]
    v_exp_f32 v212, v212
    v_mfma_f32_16x16x32_bf16 v[48:51], a[176:179], v[200:203], v[48:51]
    v_add_f32 v239, v239, v218
    v_mfma_f32_16x16x32_bf16 v[52:55], a[180:183], v[200:203], v[52:55]
    v_exp_f32 v213, v213
    v_mfma_f32_16x16x32_bf16 v[56:59], a[184:187], v[200:203], v[56:59]
    v_add_f32 v239, v239, v219
    v_cvt_pk_bf16_f32 v217, v218, v219
    v_mfma_f32_16x16x32_bf16 v[60:63], a[188:191], v[200:203], v[60:63]
    v_exp_f32 v214, v214
    v_mfma_f32_16x16x32_bf16 v[192:195], a[128:131], a[64:67], v[232:235]
    v_add_f32 v238, v238, v212
    v_exp_f32 v215, v215
    v_mfma_f32_16x16x32_bf16 v[200:203], a[128:131], a[80:83], v[232:235]
    v_add_f32 v238, v238, v213
    v_cvt_pk_bf16_f32 v210, v212, v213
    v_mfma_f32_16x16x32_bf16 v[192:195], a[132:135], a[68:71], v[192:195]
    v_exp_f32 v220, v220
    v_mfma_f32_16x16x32_bf16 v[200:203], a[132:135], a[84:87], v[200:203]
    v_add_f32 v238, v238, v214
    v_mfma_f32_16x16x32_bf16 v[192:195], a[136:139], a[72:75], v[192:195]
    v_exp_f32 v221, v221
    v_mfma_f32_16x16x32_bf16 v[200:203], a[136:139], a[88:91], v[200:203]
    v_add_f32 v238, v238, v215
    v_cvt_pk_bf16_f32 v211, v214, v215
    v_mfma_f32_16x16x32_bf16 v[192:195], a[140:143], a[76:79], v[192:195]
    v_exp_f32 v222, v222
    v_mfma_f32_16x16x32_bf16 v[200:203], a[140:143], a[92:95], v[200:203]
    v_add_f32 v239, v239, v220
    v_mfma_f32_16x16x32_bf16 v[64:67], a[160:163], v[208:211], v[64:67]
    v_exp_f32 v223, v223
    v_mfma_f32_16x16x32_bf16 v[68:71], a[164:167], v[208:211], v[68:71]
    v_add_f32 v239, v239, v221
    v_cvt_pk_bf16_f32 v218, v220, v221
    v_mfma_f32_16x16x32_bf16 v[72:75], a[168:171], v[208:211], v[72:75]
    v_add_f32 v239, v239, v222
    v_add_f32 v239, v239, v223
    v_mfma_f32_16x16x32_bf16 v[76:79], a[172:175], v[208:211], v[76:79]
    v_cvt_pk_bf16_f32 v219, v222, v223
    v_mfma_f32_16x16x32_bf16 v[80:83], a[176:179], v[208:211], v[80:83]
    v_exp_f32 v192, v192
    v_mfma_f32_16x16x32_bf16 v[84:87], a[180:183], v[208:211], v[84:87]
    v_exp_f32 v193, v193
    v_mfma_f32_16x16x32_bf16 v[88:91], a[184:187], v[208:211], v[88:91]
    v_exp_f32 v194, v194
    v_mfma_f32_16x16x32_bf16 v[92:95], a[188:191], v[208:211], v[92:95]
    s_waitcnt vmcnt(8)
    s_barrier
    v_add_f32 v240, v240, v192
    v_mfma_f32_16x16x32_bf16 v[196:199], a[144:147], a[64:67], v[232:235]
    v_exp_f32 v195, v195
    v_mfma_f32_16x16x32_bf16 v[204:207], a[144:147], a[80:83], v[232:235]
    v_add_f32 v240, v240, v193
    v_cvt_pk_bf16_f32 v192, v192, v193
    v_mfma_f32_16x16x32_bf16 v[196:199], a[148:151], a[68:71], v[196:199]
    v_exp_f32 v200, v200
    v_mfma_f32_16x16x32_bf16 v[204:207], a[148:151], a[84:87], v[204:207]
    v_add_f32 v240, v240, v194
    v_mfma_f32_16x16x32_bf16 v[196:199], a[152:155], a[72:75], v[196:199]
    v_exp_f32 v201, v201
    v_mfma_f32_16x16x32_bf16 v[204:207], a[152:155], a[88:91], v[204:207]
    v_add_f32 v240, v240, v195
    v_cvt_pk_bf16_f32 v193, v194, v195
    v_mfma_f32_16x16x32_bf16 v[196:199], a[156:159], a[76:79], v[196:199]
    v_exp_f32 v202, v202
    v_mfma_f32_16x16x32_bf16 v[204:207], a[156:159], a[92:95], v[204:207]
    v_add_f32 v241, v241, v200
    v_mfma_f32_16x16x32_bf16 v[96:99], a[160:163], v[216:219], v[96:99]
    v_exp_f32 v203, v203
    v_mfma_f32_16x16x32_bf16 v[100:103], a[164:167], v[216:219], v[100:103]
    v_add_f32 v241, v241, v201
    v_cvt_pk_bf16_f32 v200, v200, v201
    v_mfma_f32_16x16x32_bf16 v[104:107], a[168:171], v[216:219], v[104:107]
    v_mfma_f32_16x16x32_bf16 v[108:111], a[172:175], v[216:219], v[108:111]
    v_exp_f32 v196, v196
    v_mfma_f32_16x16x32_bf16 v[112:115], a[176:179], v[216:219], v[112:115]
    v_add_f32 v241, v241, v202
    v_mfma_f32_16x16x32_bf16 v[116:119], a[180:183], v[216:219], v[116:119]
    v_exp_f32 v197, v197
    v_mfma_f32_16x16x32_bf16 v[120:123], a[184:187], v[216:219], v[120:123]
    v_add_f32 v241, v241, v203
    v_cvt_pk_bf16_f32 v201, v202, v203
    v_mfma_f32_16x16x32_bf16 v[124:127], a[188:191], v[216:219], v[124:127]
    v_exp_f32 v198, v198
    v_mfma_f32_16x16x32_bf16 v[208:211], a[128:131], a[96:99], v[232:235]
    v_add_f32 v240, v240, v196
    v_exp_f32 v199, v199
    v_mfma_f32_16x16x32_bf16 v[216:219], a[128:131], a[112:115], v[232:235]
    v_add_f32 v240, v240, v197
    v_cvt_pk_bf16_f32 v194, v196, v197
    v_mfma_f32_16x16x32_bf16 v[208:211], a[132:135], a[100:103], v[208:211]
    v_exp_f32 v204, v204
    v_mfma_f32_16x16x32_bf16 v[216:219], a[132:135], a[116:119], v[216:219]
    ds_read_b128 a[128:131], v224 offset:16384
    v_add_f32 v240, v240, v198
    v_mfma_f32_16x16x32_bf16 v[208:211], a[136:139], a[104:107], v[208:211]
    v_exp_f32 v205, v205
    v_mfma_f32_16x16x32_bf16 v[216:219], a[136:139], a[120:123], v[216:219]
    v_add_f32 v240, v240, v199
    v_cvt_pk_bf16_f32 v195, v198, v199
    v_mfma_f32_16x16x32_bf16 v[208:211], a[140:143], a[108:111], v[208:211]
    v_exp_f32 v206, v206
    v_mfma_f32_16x16x32_bf16 v[216:219], a[140:143], a[124:127], v[216:219]
    ds_read_b128 a[132:135], v225 offset:16384
    v_add_f32 v241, v241, v204
    v_mfma_f32_16x16x32_bf16 v[128:131], a[160:163], v[192:195], v[128:131]
    v_exp_f32 v207, v207
    v_mfma_f32_16x16x32_bf16 v[132:135], a[164:167], v[192:195], v[132:135]
    v_add_f32 v241, v241, v205
    v_cvt_pk_bf16_f32 v202, v204, v205
    v_mfma_f32_16x16x32_bf16 v[136:139], a[168:171], v[192:195], v[136:139]
    v_add_f32 v241, v241, v206
    v_add_f32 v241, v241, v207
    v_mfma_f32_16x16x32_bf16 v[140:143], a[172:175], v[192:195], v[140:143]
    ds_read_b128 a[136:139], v224 offset:20480
    v_cvt_pk_bf16_f32 v203, v206, v207
    v_mfma_f32_16x16x32_bf16 v[144:147], a[176:179], v[192:195], v[144:147]
    v_exp_f32 v208, v208
    v_mfma_f32_16x16x32_bf16 v[148:151], a[180:183], v[192:195], v[148:151]
    v_exp_f32 v209, v209
    v_mfma_f32_16x16x32_bf16 v[152:155], a[184:187], v[192:195], v[152:155]
    v_exp_f32 v210, v210
    v_mfma_f32_16x16x32_bf16 v[156:159], a[188:191], v[192:195], v[156:159]
    ds_read_b128 a[140:143], v225 offset:20480
    v_add_f32 v242, v242, v208
    v_mfma_f32_16x16x32_bf16 v[212:215], a[144:147], a[96:99], v[232:235]
    v_exp_f32 v211, v211
    v_mfma_f32_16x16x32_bf16 v[220:223], a[144:147], a[112:115], v[232:235]
    v_add_f32 v242, v242, v209
    v_cvt_pk_bf16_f32 v208, v208, v209
    v_mfma_f32_16x16x32_bf16 v[212:215], a[148:151], a[100:103], v[212:215]
    v_exp_f32 v216, v216
    v_mfma_f32_16x16x32_bf16 v[220:223], a[148:151], a[116:119], v[220:223]
    ds_read_b128 a[144:147], v224 offset:18432
    v_add_f32 v242, v242, v210
    v_mfma_f32_16x16x32_bf16 v[212:215], a[152:155], a[104:107], v[212:215]
    v_exp_f32 v217, v217
    v_mfma_f32_16x16x32_bf16 v[220:223], a[152:155], a[120:123], v[220:223]
    v_add_f32 v242, v242, v211
    v_cvt_pk_bf16_f32 v209, v210, v211
    v_mfma_f32_16x16x32_bf16 v[212:215], a[156:159], a[108:111], v[212:215]
    v_exp_f32 v218, v218
    v_mfma_f32_16x16x32_bf16 v[220:223], a[156:159], a[124:127], v[220:223]
    ds_read_b128 a[148:151], v225 offset:18432
    v_add_f32 v243, v243, v216
    v_mfma_f32_16x16x32_bf16 v[160:163], a[160:163], v[200:203], v[160:163]
    v_exp_f32 v219, v219
    v_mfma_f32_16x16x32_bf16 v[164:167], a[164:167], v[200:203], v[164:167]
    v_add_f32 v243, v243, v217
    v_cvt_pk_bf16_f32 v216, v216, v217
    v_mfma_f32_16x16x32_bf16 v[168:171], a[168:171], v[200:203], v[168:171]
    ds_read_b128 a[152:155], v224 offset:22528
    ds_read_b128 a[156:159], v225 offset:22528
    v_mfma_f32_16x16x32_bf16 v[172:175], a[172:175], v[200:203], v[172:175]
    v_exp_f32 v212, v212
    v_mfma_f32_16x16x32_bf16 v[176:179], a[176:179], v[200:203], v[176:179]
    v_add_f32 v243, v243, v218
    v_mfma_f32_16x16x32_bf16 v[180:183], a[180:183], v[200:203], v[180:183]
    v_exp_f32 v213, v213
    v_mfma_f32_16x16x32_bf16 v[184:187], a[184:187], v[200:203], v[184:187]
    v_add_f32 v243, v243, v219
    v_cvt_pk_bf16_f32 v217, v218, v219
    v_mfma_f32_16x16x32_bf16 v[188:191], a[188:191], v[200:203], v[188:191]
    s_waitcnt lgkmcnt(2)
    v_exp_f32 v214, v214
    v_mfma_f32_16x16x32_bf16 v[192:195], a[128:131], a[0:3], v[232:235]
    v_add_f32 v242, v242, v212
    v_exp_f32 v215, v215
    v_mfma_f32_16x16x32_bf16 v[200:203], a[128:131], a[16:19], v[232:235]
    v_add_f32 v242, v242, v213
    v_cvt_pk_bf16_f32 v210, v212, v213
    v_mfma_f32_16x16x32_bf16 v[192:195], a[132:135], a[4:7], v[192:195]
    v_exp_f32 v220, v220
    v_mfma_f32_16x16x32_bf16 v[200:203], a[132:135], a[20:23], v[200:203]
    v_add_f32 v242, v242, v214
    v_mfma_f32_16x16x32_bf16 v[192:195], a[136:139], a[8:11], v[192:195]
    v_exp_f32 v221, v221
    v_mfma_f32_16x16x32_bf16 v[200:203], a[136:139], a[24:27], v[200:203]
    v_add_f32 v242, v242, v215
    v_cvt_pk_bf16_f32 v211, v214, v215
    v_mfma_f32_16x16x32_bf16 v[192:195], a[140:143], a[12:15], v[192:195]
    v_exp_f32 v222, v222
    v_mfma_f32_16x16x32_bf16 v[200:203], a[140:143], a[28:31], v[200:203]
    v_add_f32 v243, v243, v220
    v_mfma_f32_16x16x32_bf16 a[192:195], a[160:163], v[208:211], a[192:195]
    v_exp_f32 v223, v223
    v_mfma_f32_16x16x32_bf16 a[196:199], a[164:167], v[208:211], a[196:199]
    v_add_f32 v243, v243, v221
    v_cvt_pk_bf16_f32 v218, v220, v221
    v_mfma_f32_16x16x32_bf16 a[200:203], a[168:171], v[208:211], a[200:203]
    v_add_f32 v243, v243, v222
    v_add_f32 v243, v243, v223
    v_mfma_f32_16x16x32_bf16 a[204:207], a[172:175], v[208:211], a[204:207]
    v_cvt_pk_bf16_f32 v219, v222, v223
    v_mfma_f32_16x16x32_bf16 a[208:211], a[176:179], v[208:211], a[208:211]
    v_exp_f32 v192, v192
    v_mfma_f32_16x16x32_bf16 a[212:215], a[180:183], v[208:211], a[212:215]
    v_exp_f32 v193, v193
    v_mfma_f32_16x16x32_bf16 a[216:219], a[184:187], v[208:211], a[216:219]
    v_exp_f32 v194, v194
    v_mfma_f32_16x16x32_bf16 a[220:223], a[188:191], v[208:211], a[220:223]
    v_add_f32 v236, v236, v192
    v_mfma_f32_16x16x32_bf16 v[196:199], a[144:147], a[0:3], v[232:235]
    v_exp_f32 v195, v195
    v_mfma_f32_16x16x32_bf16 v[204:207], a[144:147], a[16:19], v[232:235]
    v_add_f32 v236, v236, v193
    v_cvt_pk_bf16_f32 v192, v192, v193
    v_mfma_f32_16x16x32_bf16 v[196:199], a[148:151], a[4:7], v[196:199]
    v_exp_f32 v200, v200
    v_mfma_f32_16x16x32_bf16 v[204:207], a[148:151], a[20:23], v[204:207]
    s_waitcnt lgkmcnt(0)
    v_add_f32 v236, v236, v194
    v_mfma_f32_16x16x32_bf16 v[196:199], a[152:155], a[8:11], v[196:199]
    v_exp_f32 v201, v201
    v_mfma_f32_16x16x32_bf16 v[204:207], a[152:155], a[24:27], v[204:207]
    v_add_f32 v236, v236, v195
    v_cvt_pk_bf16_f32 v193, v194, v195
    v_mfma_f32_16x16x32_bf16 v[196:199], a[156:159], a[12:15], v[196:199]
    v_exp_f32 v202, v202
    v_mfma_f32_16x16x32_bf16 v[204:207], a[156:159], a[28:31], v[204:207]
    v_add_f32 v237, v237, v200
    v_mfma_f32_16x16x32_bf16 a[224:227], a[160:163], v[216:219], a[224:227]
    ds_read_b64_tr_b16 a[160:161], v226 offset:24576
    ds_read_b64_tr_b16 a[162:163], v226 offset:26624
    v_mfma_f32_16x16x32_bf16 a[228:231], a[164:167], v[216:219], a[228:231]
    v_exp_f32 v203, v203
    v_mfma_f32_16x16x32_bf16 a[232:235], a[168:171], v[216:219], a[232:235]
    ds_read_b64_tr_b16 a[164:165], v227 offset:24576
    v_add_f32 v237, v237, v201
    v_mfma_f32_16x16x32_bf16 a[236:239], a[172:175], v[216:219], a[236:239]
    ds_read_b64_tr_b16 a[166:167], v227 offset:26624
    v_cvt_pk_bf16_f32 v200, v200, v201
    v_mfma_f32_16x16x32_bf16 a[240:243], a[176:179], v[216:219], a[240:243]
    ds_read_b64_tr_b16 a[168:169], v228 offset:24576
    v_exp_f32 v196, v196
    v_mfma_f32_16x16x32_bf16 a[244:247], a[180:183], v[216:219], a[244:247]
    ds_read_b64_tr_b16 a[170:171], v228 offset:26624
    v_add_f32 v237, v237, v202
    v_mfma_f32_16x16x32_bf16 a[248:251], a[184:187], v[216:219], a[248:251]
    ds_read_b64_tr_b16 a[172:173], v229 offset:24576
    v_exp_f32 v197, v197
    v_add_f32 v237, v237, v203
    v_mfma_f32_16x16x32_bf16 a[252:255], a[188:191], v[216:219], a[252:255]
    ds_read_b64_tr_b16 a[174:175], v229 offset:26624
    v_cvt_pk_bf16_f32 v201, v202, v203
    v_mfma_f32_16x16x32_bf16 v[208:211], a[128:131], a[32:35], v[232:235]
    ds_read_b64_tr_b16 a[176:177], v226 offset:28672
    v_exp_f32 v198, v198
    v_add_f32 v236, v236, v196
    v_mfma_f32_16x16x32_bf16 v[216:219], a[128:131], a[48:51], v[232:235]
    ds_read_b64_tr_b16 a[178:179], v226 offset:30720
    v_exp_f32 v199, v199
    v_mfma_f32_16x16x32_bf16 v[208:211], a[132:135], a[36:39], v[208:211]
    ds_read_b64_tr_b16 a[180:181], v227 offset:28672
    v_add_f32 v236, v236, v197
    v_cvt_pk_bf16_f32 v194, v196, v197
    v_mfma_f32_16x16x32_bf16 v[216:219], a[132:135], a[52:55], v[216:219]
    ds_read_b64_tr_b16 a[182:183], v227 offset:30720
    v_exp_f32 v204, v204
    v_mfma_f32_16x16x32_bf16 v[208:211], a[136:139], a[40:43], v[208:211]
    ds_read_b64_tr_b16 a[184:185], v228 offset:28672
    v_add_f32 v236, v236, v198
    v_mfma_f32_16x16x32_bf16 v[216:219], a[136:139], a[56:59], v[216:219]
    ds_read_b64_tr_b16 a[186:187], v228 offset:30720
    v_exp_f32 v205, v205
    v_add_f32 v236, v236, v199
    v_mfma_f32_16x16x32_bf16 v[208:211], a[140:143], a[44:47], v[208:211]
    ds_read_b64_tr_b16 a[188:189], v229 offset:28672
    v_cvt_pk_bf16_f32 v195, v198, v199
    v_mfma_f32_16x16x32_bf16 v[216:219], a[140:143], a[60:63], v[216:219]
    s_waitcnt lgkmcnt(4)
    ds_read_b64_tr_b16 a[190:191], v229 offset:30720
    v_mfma_f32_16x16x32_bf16 v[0:3], a[160:163], v[192:195], v[0:3]
    v_exp_f32 v206, v206
    v_mfma_f32_16x16x32_bf16 v[4:7], a[164:167], v[192:195], v[4:7]
    v_add_f32 v237, v237, v204
    v_mfma_f32_16x16x32_bf16 v[8:11], a[168:171], v[192:195], v[8:11]
    v_exp_f32 v207, v207
    v_mfma_f32_16x16x32_bf16 v[12:15], a[172:175], v[192:195], v[12:15]
    v_add_f32 v237, v237, v205
    v_cvt_pk_bf16_f32 v202, v204, v205
    v_mfma_f32_16x16x32_bf16 v[16:19], a[176:179], v[192:195], v[16:19]
    s_waitcnt lgkmcnt(1)
    v_add_f32 v237, v237, v206
    v_add_f32 v237, v237, v207
    v_mfma_f32_16x16x32_bf16 v[20:23], a[180:183], v[192:195], v[20:23]
    v_cvt_pk_bf16_f32 v203, v206, v207
    v_mfma_f32_16x16x32_bf16 v[24:27], a[184:187], v[192:195], v[24:27]
    s_waitcnt lgkmcnt(0)
    v_exp_f32 v208, v208
    v_mfma_f32_16x16x32_bf16 v[28:31], a[188:191], v[192:195], v[28:31]
    v_exp_f32 v209, v209
    v_mfma_f32_16x16x32_bf16 v[212:215], a[144:147], a[32:35], v[232:235]
    v_exp_f32 v210, v210
    v_mfma_f32_16x16x32_bf16 v[220:223], a[144:147], a[48:51], v[232:235]
    v_add_f32 v238, v238, v208
    v_mfma_f32_16x16x32_bf16 v[212:215], a[148:151], a[36:39], v[212:215]
    v_exp_f32 v211, v211
    v_mfma_f32_16x16x32_bf16 v[220:223], a[148:151], a[52:55], v[220:223]
    v_add_f32 v238, v238, v209
    v_cvt_pk_bf16_f32 v208, v208, v209
    v_mfma_f32_16x16x32_bf16 v[212:215], a[152:155], a[40:43], v[212:215]
    v_exp_f32 v216, v216
    v_mfma_f32_16x16x32_bf16 v[220:223], a[152:155], a[56:59], v[220:223]
    v_add_f32 v238, v238, v210
    v_mfma_f32_16x16x32_bf16 v[212:215], a[156:159], a[44:47], v[212:215]
    v_exp_f32 v217, v217
    v_mfma_f32_16x16x32_bf16 v[220:223], a[156:159], a[60:63], v[220:223]
    v_add_f32 v238, v238, v211
    v_cvt_pk_bf16_f32 v209, v210, v211
    v_mfma_f32_16x16x32_bf16 v[32:35], a[160:163], v[200:203], v[32:35]
    v_exp_f32 v218, v218
    v_mfma_f32_16x16x32_bf16 v[36:39], a[164:167], v[200:203], v[36:39]
    v_add_f32 v239, v239, v216
    v_exp_f32 v219, v219
    v_mfma_f32_16x16x32_bf16 v[40:43], a[168:171], v[200:203], v[40:43]
    v_add_f32 v239, v239, v217
    v_cvt_pk_bf16_f32 v216, v216, v217
    v_mfma_f32_16x16x32_bf16 v[44:47], a[172:175], v[200:203], v[44:47]
    v_exp_f32 v212, v212
    v_mfma_f32_16x16x32_bf16 v[48:51], a[176:179], v[200:203], v[48:51]
    v_add_f32 v239, v239, v218
    v_mfma_f32_16x16x32_bf16 v[52:55], a[180:183], v[200:203], v[52:55]
    v_exp_f32 v213, v213
    v_mfma_f32_16x16x32_bf16 v[56:59], a[184:187], v[200:203], v[56:59]
    v_add_f32 v239, v239, v219
    v_cvt_pk_bf16_f32 v217, v218, v219
    v_mfma_f32_16x16x32_bf16 v[60:63], a[188:191], v[200:203], v[60:63]
    v_exp_f32 v214, v214
    v_mfma_f32_16x16x32_bf16 v[192:195], a[128:131], a[64:67], v[232:235]
    v_add_f32 v238, v238, v212
    v_exp_f32 v215, v215
    v_mfma_f32_16x16x32_bf16 v[200:203], a[128:131], a[80:83], v[232:235]
    v_add_f32 v238, v238, v213
    v_cvt_pk_bf16_f32 v210, v212, v213
    v_mfma_f32_16x16x32_bf16 v[192:195], a[132:135], a[68:71], v[192:195]
    v_exp_f32 v220, v220
    v_mfma_f32_16x16x32_bf16 v[200:203], a[132:135], a[84:87], v[200:203]
    v_add_f32 v238, v238, v214
    v_mfma_f32_16x16x32_bf16 v[192:195], a[136:139], a[72:75], v[192:195]
    v_exp_f32 v221, v221
    v_mfma_f32_16x16x32_bf16 v[200:203], a[136:139], a[88:91], v[200:203]
    v_add_f32 v238, v238, v215
    v_cvt_pk_bf16_f32 v211, v214, v215
    v_mfma_f32_16x16x32_bf16 v[192:195], a[140:143], a[76:79], v[192:195]
    v_exp_f32 v222, v222
    v_mfma_f32_16x16x32_bf16 v[200:203], a[140:143], a[92:95], v[200:203]
    v_add_f32 v239, v239, v220
    v_mfma_f32_16x16x32_bf16 v[64:67], a[160:163], v[208:211], v[64:67]
    v_exp_f32 v223, v223
    v_mfma_f32_16x16x32_bf16 v[68:71], a[164:167], v[208:211], v[68:71]
    v_add_f32 v239, v239, v221
    v_cvt_pk_bf16_f32 v218, v220, v221
    v_mfma_f32_16x16x32_bf16 v[72:75], a[168:171], v[208:211], v[72:75]
    v_add_f32 v239, v239, v222
    v_add_f32 v239, v239, v223
    v_mfma_f32_16x16x32_bf16 v[76:79], a[172:175], v[208:211], v[76:79]
    v_cvt_pk_bf16_f32 v219, v222, v223
    v_mfma_f32_16x16x32_bf16 v[80:83], a[176:179], v[208:211], v[80:83]
    v_exp_f32 v192, v192
    v_mfma_f32_16x16x32_bf16 v[84:87], a[180:183], v[208:211], v[84:87]
    v_exp_f32 v193, v193
    v_mfma_f32_16x16x32_bf16 v[88:91], a[184:187], v[208:211], v[88:91]
    v_exp_f32 v194, v194
    v_mfma_f32_16x16x32_bf16 v[92:95], a[188:191], v[208:211], v[92:95]
    s_waitcnt vmcnt(4)
    s_barrier
    v_add_f32 v240, v240, v192
    v_mfma_f32_16x16x32_bf16 v[196:199], a[144:147], a[64:67], v[232:235]
    v_exp_f32 v195, v195
    v_mfma_f32_16x16x32_bf16 v[204:207], a[144:147], a[80:83], v[232:235]
    v_add_f32 v240, v240, v193
    v_cvt_pk_bf16_f32 v192, v192, v193
    v_mfma_f32_16x16x32_bf16 v[196:199], a[148:151], a[68:71], v[196:199]
    v_exp_f32 v200, v200
    v_mfma_f32_16x16x32_bf16 v[204:207], a[148:151], a[84:87], v[204:207]
    v_add_f32 v240, v240, v194
    v_mfma_f32_16x16x32_bf16 v[196:199], a[152:155], a[72:75], v[196:199]
    v_exp_f32 v201, v201
    v_mfma_f32_16x16x32_bf16 v[204:207], a[152:155], a[88:91], v[204:207]
    v_add_f32 v240, v240, v195
    v_cvt_pk_bf16_f32 v193, v194, v195
    v_mfma_f32_16x16x32_bf16 v[196:199], a[156:159], a[76:79], v[196:199]
    v_exp_f32 v202, v202
    v_mfma_f32_16x16x32_bf16 v[204:207], a[156:159], a[92:95], v[204:207]
    v_add_f32 v241, v241, v200
    v_mfma_f32_16x16x32_bf16 v[96:99], a[160:163], v[216:219], v[96:99]
    v_exp_f32 v203, v203
    v_mfma_f32_16x16x32_bf16 v[100:103], a[164:167], v[216:219], v[100:103]
    v_add_f32 v241, v241, v201
    v_cvt_pk_bf16_f32 v200, v200, v201
    v_mfma_f32_16x16x32_bf16 v[104:107], a[168:171], v[216:219], v[104:107]
    v_mfma_f32_16x16x32_bf16 v[108:111], a[172:175], v[216:219], v[108:111]
    v_exp_f32 v196, v196
    v_mfma_f32_16x16x32_bf16 v[112:115], a[176:179], v[216:219], v[112:115]
    v_add_f32 v241, v241, v202
    v_mfma_f32_16x16x32_bf16 v[116:119], a[180:183], v[216:219], v[116:119]
    v_exp_f32 v197, v197
    v_mfma_f32_16x16x32_bf16 v[120:123], a[184:187], v[216:219], v[120:123]
    v_add_f32 v241, v241, v203
    v_cvt_pk_bf16_f32 v201, v202, v203
    v_mfma_f32_16x16x32_bf16 v[124:127], a[188:191], v[216:219], v[124:127]
    v_exp_f32 v198, v198
    v_mfma_f32_16x16x32_bf16 v[208:211], a[128:131], a[96:99], v[232:235]
    v_add_f32 v240, v240, v196
    v_exp_f32 v199, v199
    v_mfma_f32_16x16x32_bf16 v[216:219], a[128:131], a[112:115], v[232:235]
    v_add_f32 v240, v240, v197
    v_cvt_pk_bf16_f32 v194, v196, v197
    v_mfma_f32_16x16x32_bf16 v[208:211], a[132:135], a[100:103], v[208:211]
    v_exp_f32 v204, v204
    v_mfma_f32_16x16x32_bf16 v[216:219], a[132:135], a[116:119], v[216:219]
    ds_read_b128 a[128:131], v224 offset:32768
    v_add_f32 v240, v240, v198
    v_mfma_f32_16x16x32_bf16 v[208:211], a[136:139], a[104:107], v[208:211]
    v_exp_f32 v205, v205
    v_mfma_f32_16x16x32_bf16 v[216:219], a[136:139], a[120:123], v[216:219]
    v_add_f32 v240, v240, v199
    v_cvt_pk_bf16_f32 v195, v198, v199
    v_mfma_f32_16x16x32_bf16 v[208:211], a[140:143], a[108:111], v[208:211]
    v_exp_f32 v206, v206
    v_mfma_f32_16x16x32_bf16 v[216:219], a[140:143], a[124:127], v[216:219]
    ds_read_b128 a[132:135], v225 offset:32768
    v_add_f32 v241, v241, v204
    v_mfma_f32_16x16x32_bf16 v[128:131], a[160:163], v[192:195], v[128:131]
    v_exp_f32 v207, v207
    v_mfma_f32_16x16x32_bf16 v[132:135], a[164:167], v[192:195], v[132:135]
    v_add_f32 v241, v241, v205
    v_cvt_pk_bf16_f32 v202, v204, v205
    v_mfma_f32_16x16x32_bf16 v[136:139], a[168:171], v[192:195], v[136:139]
    v_add_f32 v241, v241, v206
    v_add_f32 v241, v241, v207
    v_mfma_f32_16x16x32_bf16 v[140:143], a[172:175], v[192:195], v[140:143]
    ds_read_b128 a[136:139], v224 offset:36864
    v_cvt_pk_bf16_f32 v203, v206, v207
    v_mfma_f32_16x16x32_bf16 v[144:147], a[176:179], v[192:195], v[144:147]
    v_exp_f32 v208, v208
    v_mfma_f32_16x16x32_bf16 v[148:151], a[180:183], v[192:195], v[148:151]
    v_exp_f32 v209, v209
    v_mfma_f32_16x16x32_bf16 v[152:155], a[184:187], v[192:195], v[152:155]
    v_exp_f32 v210, v210
    v_mfma_f32_16x16x32_bf16 v[156:159], a[188:191], v[192:195], v[156:159]
    ds_read_b128 a[140:143], v225 offset:36864
    v_add_f32 v242, v242, v208
    v_mfma_f32_16x16x32_bf16 v[212:215], a[144:147], a[96:99], v[232:235]
    v_exp_f32 v211, v211
    v_mfma_f32_16x16x32_bf16 v[220:223], a[144:147], a[112:115], v[232:235]
    v_add_f32 v242, v242, v209
    v_cvt_pk_bf16_f32 v208, v208, v209
    v_mfma_f32_16x16x32_bf16 v[212:215], a[148:151], a[100:103], v[212:215]
    v_exp_f32 v216, v216
    v_mfma_f32_16x16x32_bf16 v[220:223], a[148:151], a[116:119], v[220:223]
    ds_read_b128 a[144:147], v224 offset:34816
    v_add_f32 v242, v242, v210
    v_mfma_f32_16x16x32_bf16 v[212:215], a[152:155], a[104:107], v[212:215]
    v_exp_f32 v217, v217
    v_mfma_f32_16x16x32_bf16 v[220:223], a[152:155], a[120:123], v[220:223]
    v_add_f32 v242, v242, v211
    v_cvt_pk_bf16_f32 v209, v210, v211
    v_mfma_f32_16x16x32_bf16 v[212:215], a[156:159], a[108:111], v[212:215]
    v_exp_f32 v218, v218
    v_mfma_f32_16x16x32_bf16 v[220:223], a[156:159], a[124:127], v[220:223]
    ds_read_b128 a[148:151], v225 offset:34816
    v_add_f32 v243, v243, v216
    v_mfma_f32_16x16x32_bf16 v[160:163], a[160:163], v[200:203], v[160:163]
    v_exp_f32 v219, v219
    v_mfma_f32_16x16x32_bf16 v[164:167], a[164:167], v[200:203], v[164:167]
    v_add_f32 v243, v243, v217
    v_cvt_pk_bf16_f32 v216, v216, v217
    v_mfma_f32_16x16x32_bf16 v[168:171], a[168:171], v[200:203], v[168:171]
    ds_read_b128 a[152:155], v224 offset:38912
    ds_read_b128 a[156:159], v225 offset:38912
    v_mfma_f32_16x16x32_bf16 v[172:175], a[172:175], v[200:203], v[172:175]
    v_exp_f32 v212, v212
    v_mfma_f32_16x16x32_bf16 v[176:179], a[176:179], v[200:203], v[176:179]
    v_add_f32 v243, v243, v218
    v_mfma_f32_16x16x32_bf16 v[180:183], a[180:183], v[200:203], v[180:183]
    v_exp_f32 v213, v213
    v_mfma_f32_16x16x32_bf16 v[184:187], a[184:187], v[200:203], v[184:187]
    v_add_f32 v243, v243, v219
    v_cvt_pk_bf16_f32 v217, v218, v219
    v_mfma_f32_16x16x32_bf16 v[188:191], a[188:191], v[200:203], v[188:191]
    s_waitcnt lgkmcnt(2)
    v_exp_f32 v214, v214
    v_mfma_f32_16x16x32_bf16 v[192:195], a[128:131], a[0:3], v[232:235]
    v_add_f32 v242, v242, v212
    v_exp_f32 v215, v215
    v_mfma_f32_16x16x32_bf16 v[200:203], a[128:131], a[16:19], v[232:235]
    v_add_f32 v242, v242, v213
    v_cvt_pk_bf16_f32 v210, v212, v213
    v_mfma_f32_16x16x32_bf16 v[192:195], a[132:135], a[4:7], v[192:195]
    v_exp_f32 v220, v220
    v_mfma_f32_16x16x32_bf16 v[200:203], a[132:135], a[20:23], v[200:203]
    v_add_f32 v242, v242, v214
    v_mfma_f32_16x16x32_bf16 v[192:195], a[136:139], a[8:11], v[192:195]
    v_exp_f32 v221, v221
    v_mfma_f32_16x16x32_bf16 v[200:203], a[136:139], a[24:27], v[200:203]
    v_add_f32 v242, v242, v215
    v_cvt_pk_bf16_f32 v211, v214, v215
    v_mfma_f32_16x16x32_bf16 v[192:195], a[140:143], a[12:15], v[192:195]
    v_exp_f32 v222, v222
    v_mfma_f32_16x16x32_bf16 v[200:203], a[140:143], a[28:31], v[200:203]
    v_add_f32 v243, v243, v220
    v_mfma_f32_16x16x32_bf16 a[192:195], a[160:163], v[208:211], a[192:195]
    v_exp_f32 v223, v223
    v_mfma_f32_16x16x32_bf16 a[196:199], a[164:167], v[208:211], a[196:199]
    v_add_f32 v243, v243, v221
    v_cvt_pk_bf16_f32 v218, v220, v221
    v_mfma_f32_16x16x32_bf16 a[200:203], a[168:171], v[208:211], a[200:203]
    v_add_f32 v243, v243, v222
    v_add_f32 v243, v243, v223
    v_mfma_f32_16x16x32_bf16 a[204:207], a[172:175], v[208:211], a[204:207]
    v_cvt_pk_bf16_f32 v219, v222, v223
    v_mfma_f32_16x16x32_bf16 a[208:211], a[176:179], v[208:211], a[208:211]
    v_exp_f32 v192, v192
    v_mfma_f32_16x16x32_bf16 a[212:215], a[180:183], v[208:211], a[212:215]
    v_exp_f32 v193, v193
    v_mfma_f32_16x16x32_bf16 a[216:219], a[184:187], v[208:211], a[216:219]
    v_exp_f32 v194, v194
    v_mfma_f32_16x16x32_bf16 a[220:223], a[188:191], v[208:211], a[220:223]
    v_add_f32 v236, v236, v192
    v_mfma_f32_16x16x32_bf16 v[196:199], a[144:147], a[0:3], v[232:235]
    v_exp_f32 v195, v195
    v_mfma_f32_16x16x32_bf16 v[204:207], a[144:147], a[16:19], v[232:235]
    v_add_f32 v236, v236, v193
    v_cvt_pk_bf16_f32 v192, v192, v193
    v_mfma_f32_16x16x32_bf16 v[196:199], a[148:151], a[4:7], v[196:199]
    v_exp_f32 v200, v200
    v_mfma_f32_16x16x32_bf16 v[204:207], a[148:151], a[20:23], v[204:207]
    s_waitcnt lgkmcnt(0)
    v_add_f32 v236, v236, v194
    v_mfma_f32_16x16x32_bf16 v[196:199], a[152:155], a[8:11], v[196:199]
    v_exp_f32 v201, v201
    v_mfma_f32_16x16x32_bf16 v[204:207], a[152:155], a[24:27], v[204:207]
    v_add_f32 v236, v236, v195
    v_cvt_pk_bf16_f32 v193, v194, v195
    v_mfma_f32_16x16x32_bf16 v[196:199], a[156:159], a[12:15], v[196:199]
    v_exp_f32 v202, v202
    v_mfma_f32_16x16x32_bf16 v[204:207], a[156:159], a[28:31], v[204:207]
    v_add_f32 v237, v237, v200
    v_mfma_f32_16x16x32_bf16 a[224:227], a[160:163], v[216:219], a[224:227]
    ds_read_b64_tr_b16 a[160:161], v226 offset:40960
    ds_read_b64_tr_b16 a[162:163], v226 offset:43008
    v_mfma_f32_16x16x32_bf16 a[228:231], a[164:167], v[216:219], a[228:231]
    v_exp_f32 v203, v203
    v_mfma_f32_16x16x32_bf16 a[232:235], a[168:171], v[216:219], a[232:235]
    ds_read_b64_tr_b16 a[164:165], v227 offset:40960
    v_add_f32 v237, v237, v201
    v_mfma_f32_16x16x32_bf16 a[236:239], a[172:175], v[216:219], a[236:239]
    ds_read_b64_tr_b16 a[166:167], v227 offset:43008
    v_cvt_pk_bf16_f32 v200, v200, v201
    v_mfma_f32_16x16x32_bf16 a[240:243], a[176:179], v[216:219], a[240:243]
    ds_read_b64_tr_b16 a[168:169], v228 offset:40960
    v_exp_f32 v196, v196
    v_mfma_f32_16x16x32_bf16 a[244:247], a[180:183], v[216:219], a[244:247]
    ds_read_b64_tr_b16 a[170:171], v228 offset:43008
    v_add_f32 v237, v237, v202
    v_mfma_f32_16x16x32_bf16 a[248:251], a[184:187], v[216:219], a[248:251]
    ds_read_b64_tr_b16 a[172:173], v229 offset:40960
    v_exp_f32 v197, v197
    v_add_f32 v237, v237, v203
    v_mfma_f32_16x16x32_bf16 a[252:255], a[188:191], v[216:219], a[252:255]
    ds_read_b64_tr_b16 a[174:175], v229 offset:43008
    v_cvt_pk_bf16_f32 v201, v202, v203
    v_mfma_f32_16x16x32_bf16 v[208:211], a[128:131], a[32:35], v[232:235]
    ds_read_b64_tr_b16 a[176:177], v226 offset:45056
    v_exp_f32 v198, v198
    v_add_f32 v236, v236, v196
    v_mfma_f32_16x16x32_bf16 v[216:219], a[128:131], a[48:51], v[232:235]
    ds_read_b64_tr_b16 a[178:179], v226 offset:47104
    v_exp_f32 v199, v199
    v_mfma_f32_16x16x32_bf16 v[208:211], a[132:135], a[36:39], v[208:211]
    ds_read_b64_tr_b16 a[180:181], v227 offset:45056
    v_add_f32 v236, v236, v197
    v_cvt_pk_bf16_f32 v194, v196, v197
    v_mfma_f32_16x16x32_bf16 v[216:219], a[132:135], a[52:55], v[216:219]
    ds_read_b64_tr_b16 a[182:183], v227 offset:47104
    v_exp_f32 v204, v204
    v_mfma_f32_16x16x32_bf16 v[208:211], a[136:139], a[40:43], v[208:211]
    ds_read_b64_tr_b16 a[184:185], v228 offset:45056
    v_add_f32 v236, v236, v198
    v_mfma_f32_16x16x32_bf16 v[216:219], a[136:139], a[56:59], v[216:219]
    ds_read_b64_tr_b16 a[186:187], v228 offset:47104
    v_exp_f32 v205, v205
    v_add_f32 v236, v236, v199
    v_mfma_f32_16x16x32_bf16 v[208:211], a[140:143], a[44:47], v[208:211]
    ds_read_b64_tr_b16 a[188:189], v229 offset:45056
    v_cvt_pk_bf16_f32 v195, v198, v199
    v_mfma_f32_16x16x32_bf16 v[216:219], a[140:143], a[60:63], v[216:219]
    s_waitcnt lgkmcnt(4)
    ds_read_b64_tr_b16 a[190:191], v229 offset:47104
    v_mfma_f32_16x16x32_bf16 v[0:3], a[160:163], v[192:195], v[0:3]
    v_exp_f32 v206, v206
    v_mfma_f32_16x16x32_bf16 v[4:7], a[164:167], v[192:195], v[4:7]
    v_add_f32 v237, v237, v204
    v_mfma_f32_16x16x32_bf16 v[8:11], a[168:171], v[192:195], v[8:11]
    v_exp_f32 v207, v207
    v_mfma_f32_16x16x32_bf16 v[12:15], a[172:175], v[192:195], v[12:15]
    v_add_f32 v237, v237, v205
    v_cvt_pk_bf16_f32 v202, v204, v205
    v_mfma_f32_16x16x32_bf16 v[16:19], a[176:179], v[192:195], v[16:19]
    s_waitcnt lgkmcnt(1)
    v_add_f32 v237, v237, v206
    v_add_f32 v237, v237, v207
    v_mfma_f32_16x16x32_bf16 v[20:23], a[180:183], v[192:195], v[20:23]
    v_cvt_pk_bf16_f32 v203, v206, v207
    v_mfma_f32_16x16x32_bf16 v[24:27], a[184:187], v[192:195], v[24:27]
    s_waitcnt lgkmcnt(0)
    v_exp_f32 v208, v208
    v_mfma_f32_16x16x32_bf16 v[28:31], a[188:191], v[192:195], v[28:31]
    v_exp_f32 v209, v209
    v_mfma_f32_16x16x32_bf16 v[212:215], a[144:147], a[32:35], v[232:235]
    v_exp_f32 v210, v210
    v_mfma_f32_16x16x32_bf16 v[220:223], a[144:147], a[48:51], v[232:235]
    v_add_f32 v238, v238, v208
    v_mfma_f32_16x16x32_bf16 v[212:215], a[148:151], a[36:39], v[212:215]
    v_exp_f32 v211, v211
    v_mfma_f32_16x16x32_bf16 v[220:223], a[148:151], a[52:55], v[220:223]
    v_add_f32 v238, v238, v209
    v_cvt_pk_bf16_f32 v208, v208, v209
    v_mfma_f32_16x16x32_bf16 v[212:215], a[152:155], a[40:43], v[212:215]
    v_exp_f32 v216, v216
    v_mfma_f32_16x16x32_bf16 v[220:223], a[152:155], a[56:59], v[220:223]
    v_add_f32 v238, v238, v210
    v_mfma_f32_16x16x32_bf16 v[212:215], a[156:159], a[44:47], v[212:215]
    v_exp_f32 v217, v217
    v_mfma_f32_16x16x32_bf16 v[220:223], a[156:159], a[60:63], v[220:223]
    v_add_f32 v238, v238, v211
    v_cvt_pk_bf16_f32 v209, v210, v211
    v_mfma_f32_16x16x32_bf16 v[32:35], a[160:163], v[200:203], v[32:35]
    v_exp_f32 v218, v218
    v_mfma_f32_16x16x32_bf16 v[36:39], a[164:167], v[200:203], v[36:39]
    v_add_f32 v239, v239, v216
    v_exp_f32 v219, v219
    v_mfma_f32_16x16x32_bf16 v[40:43], a[168:171], v[200:203], v[40:43]
    v_add_f32 v239, v239, v217
    v_cvt_pk_bf16_f32 v216, v216, v217
    v_mfma_f32_16x16x32_bf16 v[44:47], a[172:175], v[200:203], v[44:47]
    v_exp_f32 v212, v212
    v_mfma_f32_16x16x32_bf16 v[48:51], a[176:179], v[200:203], v[48:51]
    v_add_f32 v239, v239, v218
    v_mfma_f32_16x16x32_bf16 v[52:55], a[180:183], v[200:203], v[52:55]
    v_exp_f32 v213, v213
    v_mfma_f32_16x16x32_bf16 v[56:59], a[184:187], v[200:203], v[56:59]
    v_add_f32 v239, v239, v219
    v_cvt_pk_bf16_f32 v217, v218, v219
    v_mfma_f32_16x16x32_bf16 v[60:63], a[188:191], v[200:203], v[60:63]
    v_exp_f32 v214, v214
    v_mfma_f32_16x16x32_bf16 v[192:195], a[128:131], a[64:67], v[232:235]
    v_add_f32 v238, v238, v212
    v_exp_f32 v215, v215
    v_mfma_f32_16x16x32_bf16 v[200:203], a[128:131], a[80:83], v[232:235]
    v_add_f32 v238, v238, v213
    v_cvt_pk_bf16_f32 v210, v212, v213
    v_mfma_f32_16x16x32_bf16 v[192:195], a[132:135], a[68:71], v[192:195]
    v_exp_f32 v220, v220
    v_mfma_f32_16x16x32_bf16 v[200:203], a[132:135], a[84:87], v[200:203]
    v_add_f32 v238, v238, v214
    v_mfma_f32_16x16x32_bf16 v[192:195], a[136:139], a[72:75], v[192:195]
    v_exp_f32 v221, v221
    v_mfma_f32_16x16x32_bf16 v[200:203], a[136:139], a[88:91], v[200:203]
    v_add_f32 v238, v238, v215
    v_cvt_pk_bf16_f32 v211, v214, v215
    v_mfma_f32_16x16x32_bf16 v[192:195], a[140:143], a[76:79], v[192:195]
    v_exp_f32 v222, v222
    v_mfma_f32_16x16x32_bf16 v[200:203], a[140:143], a[92:95], v[200:203]
    v_add_f32 v239, v239, v220
    v_mfma_f32_16x16x32_bf16 v[64:67], a[160:163], v[208:211], v[64:67]
    v_exp_f32 v223, v223
    v_mfma_f32_16x16x32_bf16 v[68:71], a[164:167], v[208:211], v[68:71]
    v_add_f32 v239, v239, v221
    v_cvt_pk_bf16_f32 v218, v220, v221
    v_mfma_f32_16x16x32_bf16 v[72:75], a[168:171], v[208:211], v[72:75]
    v_add_f32 v239, v239, v222
    v_add_f32 v239, v239, v223
    v_mfma_f32_16x16x32_bf16 v[76:79], a[172:175], v[208:211], v[76:79]
    v_cvt_pk_bf16_f32 v219, v222, v223
    v_mfma_f32_16x16x32_bf16 v[80:83], a[176:179], v[208:211], v[80:83]
    v_exp_f32 v192, v192
    v_mfma_f32_16x16x32_bf16 v[84:87], a[180:183], v[208:211], v[84:87]
    v_exp_f32 v193, v193
    v_mfma_f32_16x16x32_bf16 v[88:91], a[184:187], v[208:211], v[88:91]
    v_exp_f32 v194, v194
    v_mfma_f32_16x16x32_bf16 v[92:95], a[188:191], v[208:211], v[92:95]
    s_waitcnt vmcnt(0)
    s_barrier
    v_add_f32 v240, v240, v192
    v_mfma_f32_16x16x32_bf16 v[196:199], a[144:147], a[64:67], v[232:235]
    v_exp_f32 v195, v195
    v_mfma_f32_16x16x32_bf16 v[204:207], a[144:147], a[80:83], v[232:235]
    v_add_f32 v240, v240, v193
    v_cvt_pk_bf16_f32 v192, v192, v193
    v_mfma_f32_16x16x32_bf16 v[196:199], a[148:151], a[68:71], v[196:199]
    v_exp_f32 v200, v200
    v_mfma_f32_16x16x32_bf16 v[204:207], a[148:151], a[84:87], v[204:207]
    v_add_f32 v240, v240, v194
    v_mfma_f32_16x16x32_bf16 v[196:199], a[152:155], a[72:75], v[196:199]
    v_exp_f32 v201, v201
    v_mfma_f32_16x16x32_bf16 v[204:207], a[152:155], a[88:91], v[204:207]
    v_add_f32 v240, v240, v195
    v_cvt_pk_bf16_f32 v193, v194, v195
    v_mfma_f32_16x16x32_bf16 v[196:199], a[156:159], a[76:79], v[196:199]
    v_exp_f32 v202, v202
    v_mfma_f32_16x16x32_bf16 v[204:207], a[156:159], a[92:95], v[204:207]
    v_add_f32 v241, v241, v200
    v_mfma_f32_16x16x32_bf16 v[96:99], a[160:163], v[216:219], v[96:99]
    v_exp_f32 v203, v203
    v_mfma_f32_16x16x32_bf16 v[100:103], a[164:167], v[216:219], v[100:103]
    v_add_f32 v241, v241, v201
    v_cvt_pk_bf16_f32 v200, v200, v201
    v_mfma_f32_16x16x32_bf16 v[104:107], a[168:171], v[216:219], v[104:107]
    v_mfma_f32_16x16x32_bf16 v[108:111], a[172:175], v[216:219], v[108:111]
    v_exp_f32 v196, v196
    v_mfma_f32_16x16x32_bf16 v[112:115], a[176:179], v[216:219], v[112:115]
    v_add_f32 v241, v241, v202
    v_mfma_f32_16x16x32_bf16 v[116:119], a[180:183], v[216:219], v[116:119]
    v_exp_f32 v197, v197
    v_mfma_f32_16x16x32_bf16 v[120:123], a[184:187], v[216:219], v[120:123]
    v_add_f32 v241, v241, v203
    v_cvt_pk_bf16_f32 v201, v202, v203
    v_mfma_f32_16x16x32_bf16 v[124:127], a[188:191], v[216:219], v[124:127]
    v_exp_f32 v198, v198
    v_mfma_f32_16x16x32_bf16 v[208:211], a[128:131], a[96:99], v[232:235]
    v_add_f32 v240, v240, v196
    v_exp_f32 v199, v199
    v_mfma_f32_16x16x32_bf16 v[216:219], a[128:131], a[112:115], v[232:235]
    v_add_f32 v240, v240, v197
    v_cvt_pk_bf16_f32 v194, v196, v197
    v_mfma_f32_16x16x32_bf16 v[208:211], a[132:135], a[100:103], v[208:211]
    v_exp_f32 v204, v204
    v_mfma_f32_16x16x32_bf16 v[216:219], a[132:135], a[116:119], v[216:219]
    ds_read_b128 a[128:131], v224 offset:49152
    v_add_f32 v240, v240, v198
    v_mfma_f32_16x16x32_bf16 v[208:211], a[136:139], a[104:107], v[208:211]
    v_exp_f32 v205, v205
    v_mfma_f32_16x16x32_bf16 v[216:219], a[136:139], a[120:123], v[216:219]
    v_add_f32 v240, v240, v199
    v_cvt_pk_bf16_f32 v195, v198, v199
    v_mfma_f32_16x16x32_bf16 v[208:211], a[140:143], a[108:111], v[208:211]
    v_exp_f32 v206, v206
    v_mfma_f32_16x16x32_bf16 v[216:219], a[140:143], a[124:127], v[216:219]
    ds_read_b128 a[132:135], v225 offset:49152
    v_add_f32 v241, v241, v204
    v_mfma_f32_16x16x32_bf16 v[128:131], a[160:163], v[192:195], v[128:131]
    v_exp_f32 v207, v207
    v_mfma_f32_16x16x32_bf16 v[132:135], a[164:167], v[192:195], v[132:135]
    v_add_f32 v241, v241, v205
    v_cvt_pk_bf16_f32 v202, v204, v205
    v_mfma_f32_16x16x32_bf16 v[136:139], a[168:171], v[192:195], v[136:139]
    v_add_f32 v241, v241, v206
    v_add_f32 v241, v241, v207
    v_mfma_f32_16x16x32_bf16 v[140:143], a[172:175], v[192:195], v[140:143]
    ds_read_b128 a[136:139], v224 offset:53248
    v_cvt_pk_bf16_f32 v203, v206, v207
    v_mfma_f32_16x16x32_bf16 v[144:147], a[176:179], v[192:195], v[144:147]
    v_exp_f32 v208, v208
    v_mfma_f32_16x16x32_bf16 v[148:151], a[180:183], v[192:195], v[148:151]
    v_exp_f32 v209, v209
    v_mfma_f32_16x16x32_bf16 v[152:155], a[184:187], v[192:195], v[152:155]
    v_exp_f32 v210, v210
    v_mfma_f32_16x16x32_bf16 v[156:159], a[188:191], v[192:195], v[156:159]
    ds_read_b128 a[140:143], v225 offset:53248
    v_add_f32 v242, v242, v208
    v_mfma_f32_16x16x32_bf16 v[212:215], a[144:147], a[96:99], v[232:235]
    v_exp_f32 v211, v211
    v_mfma_f32_16x16x32_bf16 v[220:223], a[144:147], a[112:115], v[232:235]
    v_add_f32 v242, v242, v209
    v_cvt_pk_bf16_f32 v208, v208, v209
    v_mfma_f32_16x16x32_bf16 v[212:215], a[148:151], a[100:103], v[212:215]
    v_exp_f32 v216, v216
    v_mfma_f32_16x16x32_bf16 v[220:223], a[148:151], a[116:119], v[220:223]
    ds_read_b128 a[144:147], v224 offset:51200
    v_add_f32 v242, v242, v210
    v_mfma_f32_16x16x32_bf16 v[212:215], a[152:155], a[104:107], v[212:215]
    v_exp_f32 v217, v217
    v_mfma_f32_16x16x32_bf16 v[220:223], a[152:155], a[120:123], v[220:223]
    v_add_f32 v242, v242, v211
    v_cvt_pk_bf16_f32 v209, v210, v211
    v_mfma_f32_16x16x32_bf16 v[212:215], a[156:159], a[108:111], v[212:215]
    v_exp_f32 v218, v218
    v_mfma_f32_16x16x32_bf16 v[220:223], a[156:159], a[124:127], v[220:223]
    ds_read_b128 a[148:151], v225 offset:51200
    v_add_f32 v243, v243, v216
    v_mfma_f32_16x16x32_bf16 v[160:163], a[160:163], v[200:203], v[160:163]
    v_exp_f32 v219, v219
    v_mfma_f32_16x16x32_bf16 v[164:167], a[164:167], v[200:203], v[164:167]
    v_add_f32 v243, v243, v217
    v_cvt_pk_bf16_f32 v216, v216, v217
    v_mfma_f32_16x16x32_bf16 v[168:171], a[168:171], v[200:203], v[168:171]
    ds_read_b128 a[152:155], v224 offset:55296
    ds_read_b128 a[156:159], v225 offset:55296
    v_mfma_f32_16x16x32_bf16 v[172:175], a[172:175], v[200:203], v[172:175]
    v_exp_f32 v212, v212
    v_mfma_f32_16x16x32_bf16 v[176:179], a[176:179], v[200:203], v[176:179]
    v_add_f32 v243, v243, v218
    v_mfma_f32_16x16x32_bf16 v[180:183], a[180:183], v[200:203], v[180:183]
    v_exp_f32 v213, v213
    v_mfma_f32_16x16x32_bf16 v[184:187], a[184:187], v[200:203], v[184:187]
    v_add_f32 v243, v243, v219
    v_cvt_pk_bf16_f32 v217, v218, v219
    v_mfma_f32_16x16x32_bf16 v[188:191], a[188:191], v[200:203], v[188:191]
    s_waitcnt lgkmcnt(2)
    v_exp_f32 v214, v214
    v_mfma_f32_16x16x32_bf16 v[192:195], a[128:131], a[0:3], v[232:235]
    v_add_f32 v242, v242, v212
    v_exp_f32 v215, v215
    v_mfma_f32_16x16x32_bf16 v[200:203], a[128:131], a[16:19], v[232:235]
    v_add_f32 v242, v242, v213
    v_cvt_pk_bf16_f32 v210, v212, v213
    v_mfma_f32_16x16x32_bf16 v[192:195], a[132:135], a[4:7], v[192:195]
    v_exp_f32 v220, v220
    v_mfma_f32_16x16x32_bf16 v[200:203], a[132:135], a[20:23], v[200:203]
    v_add_f32 v242, v242, v214
    v_mfma_f32_16x16x32_bf16 v[192:195], a[136:139], a[8:11], v[192:195]
    v_exp_f32 v221, v221
    v_mfma_f32_16x16x32_bf16 v[200:203], a[136:139], a[24:27], v[200:203]
    v_add_f32 v242, v242, v215
    v_cvt_pk_bf16_f32 v211, v214, v215
    v_mfma_f32_16x16x32_bf16 v[192:195], a[140:143], a[12:15], v[192:195]
    v_exp_f32 v222, v222
    v_mfma_f32_16x16x32_bf16 v[200:203], a[140:143], a[28:31], v[200:203]
    v_add_f32 v243, v243, v220
    v_mfma_f32_16x16x32_bf16 a[192:195], a[160:163], v[208:211], a[192:195]
    v_exp_f32 v223, v223
    v_mfma_f32_16x16x32_bf16 a[196:199], a[164:167], v[208:211], a[196:199]
    v_add_f32 v243, v243, v221
    v_cvt_pk_bf16_f32 v218, v220, v221
    v_mfma_f32_16x16x32_bf16 a[200:203], a[168:171], v[208:211], a[200:203]
    v_add_f32 v243, v243, v222
    v_add_f32 v243, v243, v223
    v_mfma_f32_16x16x32_bf16 a[204:207], a[172:175], v[208:211], a[204:207]
    v_cvt_pk_bf16_f32 v219, v222, v223
    v_mfma_f32_16x16x32_bf16 a[208:211], a[176:179], v[208:211], a[208:211]
    v_exp_f32 v192, v192
    v_mfma_f32_16x16x32_bf16 a[212:215], a[180:183], v[208:211], a[212:215]
    v_exp_f32 v193, v193
    v_mfma_f32_16x16x32_bf16 a[216:219], a[184:187], v[208:211], a[216:219]
    v_exp_f32 v194, v194
    v_mfma_f32_16x16x32_bf16 a[220:223], a[188:191], v[208:211], a[220:223]
    v_add_f32 v236, v236, v192
    v_mfma_f32_16x16x32_bf16 v[196:199], a[144:147], a[0:3], v[232:235]
    v_exp_f32 v195, v195
    v_mfma_f32_16x16x32_bf16 v[204:207], a[144:147], a[16:19], v[232:235]
    v_add_f32 v236, v236, v193
    v_cvt_pk_bf16_f32 v192, v192, v193
    v_mfma_f32_16x16x32_bf16 v[196:199], a[148:151], a[4:7], v[196:199]
    v_exp_f32 v200, v200
    v_mfma_f32_16x16x32_bf16 v[204:207], a[148:151], a[20:23], v[204:207]
    s_waitcnt lgkmcnt(0)
    v_add_f32 v236, v236, v194
    v_mfma_f32_16x16x32_bf16 v[196:199], a[152:155], a[8:11], v[196:199]
    v_exp_f32 v201, v201
    v_mfma_f32_16x16x32_bf16 v[204:207], a[152:155], a[24:27], v[204:207]
    v_add_f32 v236, v236, v195
    v_cvt_pk_bf16_f32 v193, v194, v195
    v_mfma_f32_16x16x32_bf16 v[196:199], a[156:159], a[12:15], v[196:199]
    v_exp_f32 v202, v202
    v_mfma_f32_16x16x32_bf16 v[204:207], a[156:159], a[28:31], v[204:207]
    v_add_f32 v237, v237, v200
    v_mfma_f32_16x16x32_bf16 a[224:227], a[160:163], v[216:219], a[224:227]
    ds_read_b64_tr_b16 a[160:161], v226 offset:57344
    ds_read_b64_tr_b16 a[162:163], v226 offset:59392
    v_mfma_f32_16x16x32_bf16 a[228:231], a[164:167], v[216:219], a[228:231]
    v_exp_f32 v203, v203
    v_mfma_f32_16x16x32_bf16 a[232:235], a[168:171], v[216:219], a[232:235]
    ds_read_b64_tr_b16 a[164:165], v227 offset:57344
    v_add_f32 v237, v237, v201
    v_mfma_f32_16x16x32_bf16 a[236:239], a[172:175], v[216:219], a[236:239]
    ds_read_b64_tr_b16 a[166:167], v227 offset:59392
    v_cvt_pk_bf16_f32 v200, v200, v201
    v_mfma_f32_16x16x32_bf16 a[240:243], a[176:179], v[216:219], a[240:243]
    ds_read_b64_tr_b16 a[168:169], v228 offset:57344
    v_exp_f32 v196, v196
    v_mfma_f32_16x16x32_bf16 a[244:247], a[180:183], v[216:219], a[244:247]
    ds_read_b64_tr_b16 a[170:171], v228 offset:59392
    v_add_f32 v237, v237, v202
    v_mfma_f32_16x16x32_bf16 a[248:251], a[184:187], v[216:219], a[248:251]
    ds_read_b64_tr_b16 a[172:173], v229 offset:57344
    v_exp_f32 v197, v197
    v_add_f32 v237, v237, v203
    v_mfma_f32_16x16x32_bf16 a[252:255], a[188:191], v[216:219], a[252:255]
    ds_read_b64_tr_b16 a[174:175], v229 offset:59392
    v_cvt_pk_bf16_f32 v201, v202, v203
    v_mfma_f32_16x16x32_bf16 v[208:211], a[128:131], a[32:35], v[232:235]
    ds_read_b64_tr_b16 a[176:177], v226 offset:61440
    v_exp_f32 v198, v198
    v_add_f32 v236, v236, v196
    v_mfma_f32_16x16x32_bf16 v[216:219], a[128:131], a[48:51], v[232:235]
    ds_read_b64_tr_b16 a[178:179], v226 offset:63488
    v_exp_f32 v199, v199
    v_mfma_f32_16x16x32_bf16 v[208:211], a[132:135], a[36:39], v[208:211]
    ds_read_b64_tr_b16 a[180:181], v227 offset:61440
    v_add_f32 v236, v236, v197
    v_cvt_pk_bf16_f32 v194, v196, v197
    v_mfma_f32_16x16x32_bf16 v[216:219], a[132:135], a[52:55], v[216:219]
    ds_read_b64_tr_b16 a[182:183], v227 offset:63488
    v_exp_f32 v204, v204
    v_mfma_f32_16x16x32_bf16 v[208:211], a[136:139], a[40:43], v[208:211]
    ds_read_b64_tr_b16 a[184:185], v228 offset:61440
    v_add_f32 v236, v236, v198
    v_mfma_f32_16x16x32_bf16 v[216:219], a[136:139], a[56:59], v[216:219]
    ds_read_b64_tr_b16 a[186:187], v228 offset:63488
    v_exp_f32 v205, v205
    v_add_f32 v236, v236, v199
    v_mfma_f32_16x16x32_bf16 v[208:211], a[140:143], a[44:47], v[208:211]
    ds_read_b64_tr_b16 a[188:189], v229 offset:61440
    v_cvt_pk_bf16_f32 v195, v198, v199
    v_mfma_f32_16x16x32_bf16 v[216:219], a[140:143], a[60:63], v[216:219]
    s_waitcnt lgkmcnt(4)
    ds_read_b64_tr_b16 a[190:191], v229 offset:63488
    v_mfma_f32_16x16x32_bf16 v[0:3], a[160:163], v[192:195], v[0:3]
    v_exp_f32 v206, v206
    v_mfma_f32_16x16x32_bf16 v[4:7], a[164:167], v[192:195], v[4:7]
    v_add_f32 v237, v237, v204
    v_mfma_f32_16x16x32_bf16 v[8:11], a[168:171], v[192:195], v[8:11]
    v_exp_f32 v207, v207
    v_mfma_f32_16x16x32_bf16 v[12:15], a[172:175], v[192:195], v[12:15]
    v_add_f32 v237, v237, v205
    v_cvt_pk_bf16_f32 v202, v204, v205
    v_mfma_f32_16x16x32_bf16 v[16:19], a[176:179], v[192:195], v[16:19]
    s_waitcnt lgkmcnt(1)
    v_add_f32 v237, v237, v206
    v_add_f32 v237, v237, v207
    v_mfma_f32_16x16x32_bf16 v[20:23], a[180:183], v[192:195], v[20:23]
    v_cvt_pk_bf16_f32 v203, v206, v207
    v_mfma_f32_16x16x32_bf16 v[24:27], a[184:187], v[192:195], v[24:27]
    s_waitcnt lgkmcnt(0)
    v_exp_f32 v208, v208
    v_mfma_f32_16x16x32_bf16 v[28:31], a[188:191], v[192:195], v[28:31]
    v_exp_f32 v209, v209
    v_mfma_f32_16x16x32_bf16 v[212:215], a[144:147], a[32:35], v[232:235]
    v_exp_f32 v210, v210
    v_mfma_f32_16x16x32_bf16 v[220:223], a[144:147], a[48:51], v[232:235]
    v_add_f32 v238, v238, v208
    v_mfma_f32_16x16x32_bf16 v[212:215], a[148:151], a[36:39], v[212:215]
    v_exp_f32 v211, v211
    v_mfma_f32_16x16x32_bf16 v[220:223], a[148:151], a[52:55], v[220:223]
    v_add_f32 v238, v238, v209
    v_cvt_pk_bf16_f32 v208, v208, v209
    v_mfma_f32_16x16x32_bf16 v[212:215], a[152:155], a[40:43], v[212:215]
    v_exp_f32 v216, v216
    v_mfma_f32_16x16x32_bf16 v[220:223], a[152:155], a[56:59], v[220:223]
    v_add_f32 v238, v238, v210
    v_mfma_f32_16x16x32_bf16 v[212:215], a[156:159], a[44:47], v[212:215]
    v_exp_f32 v217, v217
    v_mfma_f32_16x16x32_bf16 v[220:223], a[156:159], a[60:63], v[220:223]
    s_mov_b32 s60, 0x4e800000
    s_mov_b32 s61, 0x2b800000
    v_add_f32 v238, v238, v211
    v_mfma_f32_16x16x32_bf16 v[32:35], a[160:163], v[200:203], v[32:35]
    v_cvt_pk_bf16_f32 v209, v210, v211
    v_mov_b32 v230, v236
    v_mfma_f32_16x16x32_bf16 v[36:39], a[164:167], v[200:203], v[36:39]
    v_mov_b32 v231, v237
    v_exp_f32 v218, v218
    v_add_f32 v239, v239, v216
    v_mfma_f32_16x16x32_bf16 v[40:43], a[168:171], v[200:203], v[40:43]
    v_permlane32_swap_b32 v230, v236
    v_permlane32_swap_b32 v231, v237
    v_exp_f32 v219, v219
    v_mfma_f32_16x16x32_bf16 v[44:47], a[172:175], v[200:203], v[44:47]
    v_add_f32 v236, v236, v230
    v_add_f32 v237, v237, v231
    v_add_f32 v239, v239, v217
    v_cvt_pk_bf16_f32 v216, v216, v217
    v_mfma_f32_16x16x32_bf16 v[48:51], a[176:179], v[200:203], v[48:51]
    v_mov_b32 v230, v236
    v_mov_b32 v231, v237
    v_exp_f32 v212, v212
    v_mfma_f32_16x16x32_bf16 v[52:55], a[180:183], v[200:203], v[52:55]
    v_permlane16_swap_b32 v230, v236
    v_permlane16_swap_b32 v231, v237
    v_add_f32 v239, v239, v218
    v_mfma_f32_16x16x32_bf16 v[56:59], a[184:187], v[200:203], v[56:59]
    v_add_f32 v236, v236, v230
    v_add_f32 v237, v237, v231
    v_exp_f32 v213, v213
    v_add_f32 v239, v239, v219
    v_mfma_f32_16x16x32_bf16 v[60:63], a[188:191], v[200:203], v[60:63]
    v_min_f32 v230, s60, v236
    v_min_f32 v231, s60, v237
    v_cvt_pk_bf16_f32 v217, v218, v219
    v_mfma_f32_16x16x32_bf16 v[192:195], a[128:131], a[64:67], v[232:235]
    v_max_f32 v230, s61, v230
    v_max_f32 v231, s61, v231
    v_exp_f32 v214, v214
    v_add_f32 v238, v238, v212
    v_mfma_f32_16x16x32_bf16 v[200:203], a[128:131], a[80:83], v[232:235]
    v_cmp_neq_f32 s[56:57], v230, v236
    v_cmp_neq_f32 s[58:59], v231, v237
    v_exp_f32 v215, v215
    v_mfma_f32_16x16x32_bf16 v[192:195], a[132:135], a[68:71], v[192:195]
    v_rcp_f32 v236, v236
    v_rcp_f32 v237, v237
    v_add_f32 v238, v238, v213
    v_cvt_pk_bf16_f32 v210, v212, v213
    v_mfma_f32_16x16x32_bf16 v[200:203], a[132:135], a[84:87], v[200:203]
    s_or_b32 s24, s24, s56
    s_or_b32 s24, s24, s58
    v_exp_f32 v220, v220
    v_mfma_f32_16x16x32_bf16 v[192:195], a[136:139], a[72:75], v[192:195]
    s_or_b32 s24, s24, s57
    s_or_b32 s24, s24, s59
    v_add_f32 v238, v238, v214
    v_mfma_f32_16x16x32_bf16 v[200:203], a[136:139], a[88:91], v[200:203]
    v_mul_f32 v0, v0, v236
    v_exp_f32 v221, v221
    v_add_f32 v238, v238, v215
    v_mfma_f32_16x16x32_bf16 v[192:195], a[140:143], a[76:79], v[192:195]
    v_mul_f32 v1, v1, v236
    v_cvt_pk_bf16_f32 v211, v214, v215
    v_mfma_f32_16x16x32_bf16 v[200:203], a[140:143], a[92:95], v[200:203]
    v_mul_f32 v2, v2, v236
    v_mul_f32 v3, v3, v236
    v_mfma_f32_16x16x32_bf16 v[64:67], a[160:163], v[208:211], v[64:67]
    v_cvt_pk_bf16_f32 v0, v0, v1
    v_cvt_pk_bf16_f32 v1, v2, v3
    v_mfma_f32_16x16x32_bf16 v[68:71], a[164:167], v[208:211], v[68:71]
    v_mul_f32 v4, v4, v236
    v_mul_f32 v5, v5, v236
    v_mfma_f32_16x16x32_bf16 v[72:75], a[168:171], v[208:211], v[72:75]
    v_mul_f32 v6, v6, v236
    v_mul_f32 v7, v7, v236
    v_mfma_f32_16x16x32_bf16 v[76:79], a[172:175], v[208:211], v[76:79]
    v_exp_f32 v222, v222
    v_add_f32 v239, v239, v220
    v_mfma_f32_16x16x32_bf16 v[80:83], a[176:179], v[208:211], v[80:83]
    v_cvt_pk_bf16_f32 v4, v4, v5
    v_exp_f32 v223, v223
    v_mfma_f32_16x16x32_bf16 v[84:87], a[180:183], v[208:211], v[84:87]
    ds_write_b64 v246, v[0:1] offset:0
    v_add_f32 v239, v239, v221
    v_cvt_pk_bf16_f32 v218, v220, v221
    v_mfma_f32_16x16x32_bf16 v[88:91], a[184:187], v[208:211], v[88:91]
    v_cvt_pk_bf16_f32 v5, v6, v7
    v_add_f32 v239, v239, v222
    v_add_f32 v239, v239, v223
    v_mfma_f32_16x16x32_bf16 v[92:95], a[188:191], v[208:211], v[92:95]
    v_mul_f32 v8, v8, v236
    v_mul_f32 v9, v9, v236
    v_cvt_pk_bf16_f32 v219, v222, v223
    v_mfma_f32_16x16x32_bf16 v[196:199], a[144:147], a[64:67], v[232:235]
    v_mul_f32 v10, v10, v236
    v_exp_f32 v192, v192
    v_mfma_f32_16x16x32_bf16 v[204:207], a[144:147], a[80:83], v[232:235]
    v_mul_f32 v11, v11, v236
    v_cvt_pk_bf16_f32 v8, v8, v9
    v_exp_f32 v193, v193
    v_mfma_f32_16x16x32_bf16 v[196:199], a[148:151], a[68:71], v[196:199]
    ds_write_b64 v246, v[4:5] offset:1024
    v_exp_f32 v194, v194
    v_add_f32 v240, v240, v192
    v_mfma_f32_16x16x32_bf16 v[204:207], a[148:151], a[84:87], v[204:207]
    v_cvt_pk_bf16_f32 v9, v10, v11
    v_exp_f32 v195, v195
    v_mfma_f32_16x16x32_bf16 v[196:199], a[152:155], a[72:75], v[196:199]
    v_mul_f32 v12, v12, v236
    v_mul_f32 v13, v13, v236
    v_add_f32 v240, v240, v193
    v_cvt_pk_bf16_f32 v192, v192, v193
    v_mfma_f32_16x16x32_bf16 v[204:207], a[152:155], a[88:91], v[204:207]
    v_mul_f32 v14, v14, v236
    v_exp_f32 v200, v200
    v_mfma_f32_16x16x32_bf16 v[196:199], a[156:159], a[76:79], v[196:199]
    v_mul_f32 v15, v15, v236
    v_cvt_pk_bf16_f32 v12, v12, v13
    v_add_f32 v240, v240, v194
    v_mfma_f32_16x16x32_bf16 v[204:207], a[156:159], a[92:95], v[204:207]
    ds_write_b64 v246, v[8:9] offset:2048
    v_exp_f32 v201, v201
    v_add_f32 v240, v240, v195
    v_mfma_f32_16x16x32_bf16 v[96:99], a[160:163], v[216:219], v[96:99]
    s_mov_b32 s60, 0x4e800000
    s_mov_b32 s61, 0x2b800000
    v_cvt_pk_bf16_f32 v13, v14, v15
    v_cvt_pk_bf16_f32 v193, v194, v195
    v_mfma_f32_16x16x32_bf16 v[100:103], a[164:167], v[216:219], v[100:103]
    v_mov_b32 v230, v238
    v_mov_b32 v231, v239
    v_mul_f32 v16, v16, v236
    v_mul_f32 v17, v17, v236
    v_exp_f32 v202, v202
    v_add_f32 v241, v241, v200
    v_mfma_f32_16x16x32_bf16 v[104:107], a[168:171], v[216:219], v[104:107]
    v_permlane32_swap_b32 v230, v238
    v_permlane32_swap_b32 v231, v239
    v_mul_f32 v18, v18, v236
    v_exp_f32 v203, v203
    v_mfma_f32_16x16x32_bf16 v[108:111], a[172:175], v[216:219], v[108:111]
    v_add_f32 v238, v238, v230
    v_add_f32 v239, v239, v231
    v_mul_f32 v19, v19, v236
    v_cvt_pk_bf16_f32 v16, v16, v17
    v_add_f32 v241, v241, v201
    v_cvt_pk_bf16_f32 v200, v200, v201
    v_mfma_f32_16x16x32_bf16 v[112:115], a[176:179], v[216:219], v[112:115]
    ds_write_b64 v246, v[12:13] offset:3072
    v_mov_b32 v230, v238
    v_mov_b32 v231, v239
    v_exp_f32 v196, v196
    v_mfma_f32_16x16x32_bf16 v[116:119], a[180:183], v[216:219], v[116:119]
    v_permlane16_swap_b32 v230, v238
    v_permlane16_swap_b32 v231, v239
    v_cvt_pk_bf16_f32 v17, v18, v19
    v_add_f32 v241, v241, v202
    v_mfma_f32_16x16x32_bf16 v[120:123], a[184:187], v[216:219], v[120:123]
    v_add_f32 v238, v238, v230
    v_add_f32 v239, v239, v231
    v_mul_f32 v20, v20, v236
    v_mul_f32 v21, v21, v236
    v_exp_f32 v197, v197
    v_add_f32 v241, v241, v203
    v_mfma_f32_16x16x32_bf16 v[124:127], a[188:191], v[216:219], v[124:127]
    v_min_f32 v230, s60, v238
    v_min_f32 v231, s60, v239
    v_mul_f32 v22, v22, v236
    v_cvt_pk_bf16_f32 v201, v202, v203
    v_mfma_f32_16x16x32_bf16 v[208:211], a[128:131], a[96:99], v[232:235]
    v_max_f32 v230, s61, v230
    v_max_f32 v231, s61, v231
    v_mul_f32 v23, v23, v236
    v_cvt_pk_bf16_f32 v20, v20, v21
    v_exp_f32 v198, v198
    v_add_f32 v240, v240, v196
    v_mfma_f32_16x16x32_bf16 v[216:219], a[128:131], a[112:115], v[232:235]
    ds_write_b64 v246, v[16:17] offset:4096
    v_cmp_neq_f32 s[56:57], v230, v238
    v_cmp_neq_f32 s[58:59], v231, v239
    v_exp_f32 v199, v199
    v_mfma_f32_16x16x32_bf16 v[208:211], a[132:135], a[100:103], v[208:211]
    v_rcp_f32 v238, v238
    v_rcp_f32 v239, v239
    v_cvt_pk_bf16_f32 v21, v22, v23
    v_add_f32 v240, v240, v197
    v_cvt_pk_bf16_f32 v194, v196, v197
    v_mfma_f32_16x16x32_bf16 v[216:219], a[132:135], a[116:119], v[216:219]
    s_or_b32 s24, s24, s56
    s_or_b32 s24, s24, s58
    v_mul_f32 v24, v24, v236
    v_mul_f32 v25, v25, v236
    v_exp_f32 v204, v204
    v_mfma_f32_16x16x32_bf16 v[208:211], a[136:139], a[104:107], v[208:211]
    s_or_b32 s24, s24, s57
    s_or_b32 s24, s24, s59
    v_mul_f32 v26, v26, v236
    v_add_f32 v240, v240, v198
    v_mfma_f32_16x16x32_bf16 v[216:219], a[136:139], a[120:123], v[216:219]
    v_mul_f32 v27, v27, v236
    v_cvt_pk_bf16_f32 v24, v24, v25
    v_exp_f32 v205, v205
    v_add_f32 v240, v240, v199
    v_mfma_f32_16x16x32_bf16 v[208:211], a[140:143], a[108:111], v[208:211]
    ds_write_b64 v246, v[20:21] offset:5120
    v_cvt_pk_bf16_f32 v195, v198, v199
    v_mfma_f32_16x16x32_bf16 v[216:219], a[140:143], a[124:127], v[216:219]
    v_cvt_pk_bf16_f32 v25, v26, v27
    v_mul_f32 v28, v28, v236
    v_mfma_f32_16x16x32_bf16 v[128:131], a[160:163], v[192:195], v[128:131]
    v_mul_f32 v29, v29, v236
    v_mul_f32 v30, v30, v236
    v_mfma_f32_16x16x32_bf16 v[132:135], a[164:167], v[192:195], v[132:135]
    v_mul_f32 v31, v31, v236
    v_cvt_pk_bf16_f32 v28, v28, v29
    v_mfma_f32_16x16x32_bf16 v[136:139], a[168:171], v[192:195], v[136:139]
    v_exp_f32 v206, v206
    v_mfma_f32_16x16x32_bf16 v[140:143], a[172:175], v[192:195], v[140:143]
    ds_write_b64 v246, v[24:25] offset:6144
    v_add_f32 v241, v241, v204
    v_mfma_f32_16x16x32_bf16 v[144:147], a[176:179], v[192:195], v[144:147]
    v_cvt_pk_bf16_f32 v29, v30, v31
    v_exp_f32 v207, v207
    v_mfma_f32_16x16x32_bf16 v[148:151], a[180:183], v[192:195], v[148:151]
    v_mul_f32 v32, v32, v237
    v_mul_f32 v33, v33, v237
    v_add_f32 v241, v241, v205
    v_cvt_pk_bf16_f32 v202, v204, v205
    v_mfma_f32_16x16x32_bf16 v[152:155], a[184:187], v[192:195], v[152:155]
    v_mul_f32 v34, v34, v237
    v_add_f32 v241, v241, v206
    v_add_f32 v241, v241, v207
    v_mfma_f32_16x16x32_bf16 v[156:159], a[188:191], v[192:195], v[156:159]
    v_mul_f32 v35, v35, v237
    v_cvt_pk_bf16_f32 v32, v32, v33
    v_cvt_pk_bf16_f32 v203, v206, v207
    v_mfma_f32_16x16x32_bf16 v[212:215], a[144:147], a[96:99], v[232:235]
    ds_write_b64 v246, v[28:29] offset:7168
    v_add_u32 v224, 4294901760, v224
    v_add_u32 v225, 4294901760, v225
    v_exp_f32 v208, v208
    v_mfma_f32_16x16x32_bf16 v[220:223], a[144:147], a[112:115], v[232:235]
    v_cvt_pk_bf16_f32 v33, v34, v35
    v_exp_f32 v209, v209
    v_mfma_f32_16x16x32_bf16 v[212:215], a[148:151], a[100:103], v[212:215]
    v_mul_f32 v36, v36, v237
    v_mul_f32 v37, v37, v237
    v_exp_f32 v210, v210
    v_add_f32 v242, v242, v208
    v_mfma_f32_16x16x32_bf16 v[220:223], a[148:151], a[116:119], v[220:223]
    v_mul_f32 v38, v38, v237
    v_exp_f32 v211, v211
    v_mfma_f32_16x16x32_bf16 v[212:215], a[152:155], a[104:107], v[212:215]
    v_mul_f32 v39, v39, v237
    v_cvt_pk_bf16_f32 v36, v36, v37
    v_add_f32 v242, v242, v209
    v_cvt_pk_bf16_f32 v208, v208, v209
    v_mfma_f32_16x16x32_bf16 v[220:223], a[152:155], a[120:123], v[220:223]
    ds_write_b64 v246, v[32:33] offset:512
    v_exp_f32 v216, v216
    v_mfma_f32_16x16x32_bf16 v[212:215], a[156:159], a[108:111], v[212:215]
    v_cvt_pk_bf16_f32 v37, v38, v39
    v_add_f32 v242, v242, v210
    v_mfma_f32_16x16x32_bf16 v[220:223], a[156:159], a[124:127], v[220:223]
    v_mul_f32 v40, v40, v237
    v_mul_f32 v41, v41, v237
    v_exp_f32 v217, v217
    v_add_f32 v242, v242, v211
    v_mfma_f32_16x16x32_bf16 v[160:163], a[160:163], v[200:203], v[160:163]
    ds_read_b128 a[128:131], v224 offset:0
    v_mul_f32 v42, v42, v237
    v_cvt_pk_bf16_f32 v209, v210, v211
    v_mfma_f32_16x16x32_bf16 v[164:167], a[164:167], v[200:203], v[164:167]
    v_mul_f32 v43, v43, v237
    v_cvt_pk_bf16_f32 v40, v40, v41
    v_exp_f32 v218, v218
    v_add_f32 v243, v243, v216
    v_mfma_f32_16x16x32_bf16 v[168:171], a[168:171], v[200:203], v[168:171]
    ds_write_b64 v246, v[36:37] offset:1536
    ds_read_b128 a[132:135], v225 offset:0
    v_exp_f32 v219, v219
    v_mfma_f32_16x16x32_bf16 v[172:175], a[172:175], v[200:203], v[172:175]
    v_cvt_pk_bf16_f32 v41, v42, v43
    v_add_f32 v243, v243, v217
    v_cvt_pk_bf16_f32 v216, v216, v217
    v_mfma_f32_16x16x32_bf16 v[176:179], a[176:179], v[200:203], v[176:179]
    ds_read_b128 a[136:139], v224 offset:4096
    v_mul_f32 v44, v44, v237
    v_mul_f32 v45, v45, v237
    v_exp_f32 v212, v212
    v_mfma_f32_16x16x32_bf16 v[180:183], a[180:183], v[200:203], v[180:183]
    v_mul_f32 v46, v46, v237
    v_add_f32 v243, v243, v218
    v_mfma_f32_16x16x32_bf16 v[184:187], a[184:187], v[200:203], v[184:187]
    ds_read_b128 a[140:143], v225 offset:4096
    v_mul_f32 v47, v47, v237
    v_cvt_pk_bf16_f32 v44, v44, v45
    v_exp_f32 v213, v213
    v_add_f32 v243, v243, v219
    v_mfma_f32_16x16x32_bf16 v[188:191], a[188:191], v[200:203], v[188:191]
    s_waitcnt lgkmcnt(1)
    ds_write_b64 v246, v[40:41] offset:2560
    v_cvt_pk_bf16_f32 v217, v218, v219
    v_mfma_f32_16x16x32_bf16 v[192:195], a[128:131], a[64:67], v[232:235]
    v_cvt_pk_bf16_f32 v45, v46, v47
    v_exp_f32 v214, v214
    v_add_f32 v242, v242, v212
    v_mfma_f32_16x16x32_bf16 v[200:203], a[128:131], a[80:83], v[232:235]
    v_mul_f32 v48, v48, v237
    v_mul_f32 v49, v49, v237
    v_exp_f32 v215, v215
    v_mfma_f32_16x16x32_bf16 v[192:195], a[132:135], a[68:71], v[192:195]
    v_mul_f32 v50, v50, v237
    v_add_f32 v242, v242, v213
    v_cvt_pk_bf16_f32 v210, v212, v213
    v_mfma_f32_16x16x32_bf16 v[200:203], a[132:135], a[84:87], v[200:203]
    v_mul_f32 v51, v51, v237
    v_cvt_pk_bf16_f32 v48, v48, v49
    v_exp_f32 v220, v220
    v_mfma_f32_16x16x32_bf16 v[192:195], a[136:139], a[72:75], v[192:195]
    ds_write_b64 v246, v[44:45] offset:3584
    v_add_f32 v242, v242, v214
    v_mfma_f32_16x16x32_bf16 v[200:203], a[136:139], a[88:91], v[200:203]
    s_waitcnt lgkmcnt(1)
    v_cvt_pk_bf16_f32 v49, v50, v51
    v_exp_f32 v221, v221
    v_add_f32 v242, v242, v215
    v_mfma_f32_16x16x32_bf16 v[192:195], a[140:143], a[76:79], v[192:195]
    v_mul_f32 v52, v52, v237
    v_mul_f32 v53, v53, v237
    v_cvt_pk_bf16_f32 v211, v214, v215
    v_mfma_f32_16x16x32_bf16 v[200:203], a[140:143], a[92:95], v[200:203]
    v_mul_f32 v54, v54, v237
    v_mul_f32 v55, v55, v237
    v_mfma_f32_16x16x32_bf16 a[192:195], a[160:163], v[208:211], a[192:195]
    ds_read_b128 a[144:147], v224 offset:2048
    v_cvt_pk_bf16_f32 v52, v52, v53
    v_mfma_f32_16x16x32_bf16 a[196:199], a[164:167], v[208:211], a[196:199]
    ds_write_b64 v246, v[48:49] offset:4608
    v_mfma_f32_16x16x32_bf16 a[200:203], a[168:171], v[208:211], a[200:203]
    ds_read_b128 a[148:151], v225 offset:2048
    v_cvt_pk_bf16_f32 v53, v54, v55
    v_mfma_f32_16x16x32_bf16 a[204:207], a[172:175], v[208:211], a[204:207]
    v_mul_f32 v56, v56, v237
    v_mul_f32 v57, v57, v237
    v_exp_f32 v222, v222
    v_add_f32 v243, v243, v220
    v_mfma_f32_16x16x32_bf16 a[208:211], a[176:179], v[208:211], a[208:211]
    ds_read_b128 a[152:155], v224 offset:6144
    v_mul_f32 v58, v58, v237
    v_exp_f32 v223, v223
    v_mfma_f32_16x16x32_bf16 a[212:215], a[180:183], v[208:211], a[212:215]
    v_mul_f32 v59, v59, v237
    v_cvt_pk_bf16_f32 v56, v56, v57
    v_add_f32 v243, v243, v221
    v_cvt_pk_bf16_f32 v218, v220, v221
    v_mfma_f32_16x16x32_bf16 a[216:219], a[184:187], v[208:211], a[216:219]
    ds_write_b64 v246, v[52:53] offset:5632
    ds_read_b128 a[156:159], v225 offset:6144
    v_add_f32 v243, v243, v222
    v_add_f32 v243, v243, v223
    v_mfma_f32_16x16x32_bf16 a[220:223], a[188:191], v[208:211], a[220:223]
    s_waitcnt lgkmcnt(2)
    v_cvt_pk_bf16_f32 v57, v58, v59
    v_cvt_pk_bf16_f32 v219, v222, v223
    v_mfma_f32_16x16x32_bf16 v[196:199], a[144:147], a[64:67], v[232:235]
    v_mul_f32 v60, v60, v237
    v_mul_f32 v61, v61, v237
    v_exp_f32 v192, v192
    v_mfma_f32_16x16x32_bf16 v[204:207], a[144:147], a[80:83], v[232:235]
    v_mul_f32 v62, v62, v237
    v_exp_f32 v193, v193
    v_mfma_f32_16x16x32_bf16 v[196:199], a[148:151], a[68:71], v[196:199]
    v_mul_f32 v63, v63, v237
    v_cvt_pk_bf16_f32 v60, v60, v61
    v_exp_f32 v194, v194
    v_add_f32 v240, v240, v192
    v_mfma_f32_16x16x32_bf16 v[204:207], a[148:151], a[84:87], v[204:207]
    ds_write_b64 v246, v[56:57] offset:6656
    v_exp_f32 v195, v195
    v_mfma_f32_16x16x32_bf16 v[196:199], a[152:155], a[72:75], v[196:199]
    v_cvt_pk_bf16_f32 v61, v62, v63
    v_add_f32 v240, v240, v193
    v_cvt_pk_bf16_f32 v192, v192, v193
    v_mfma_f32_16x16x32_bf16 v[204:207], a[152:155], a[88:91], v[204:207]
    s_waitcnt lgkmcnt(1)
    ds_write_b64 v246, v[60:61] offset:7680
    v_exp_f32 v200, v200
    v_mfma_f32_16x16x32_bf16 v[196:199], a[156:159], a[76:79], v[196:199]
    ds_read_b128 a[0:3], v247 offset:0
    ds_read_b128 a[8:11], v247 offset:256
    v_add_f32 v240, v240, v194
    v_mfma_f32_16x16x32_bf16 v[204:207], a[156:159], a[92:95], v[204:207]
    ds_read_b128 a[16:19], v247 offset:512
    ds_read_b128 a[24:27], v247 offset:768
    v_exp_f32 v201, v201
    v_add_f32 v240, v240, v195
    v_add_u32 v226, 4294901760, v226
    v_add_u32 v227, 4294901760, v227
    v_add_u32 v228, 4294901760, v228
    v_add_u32 v229, 4294901760, v229
    v_mfma_f32_16x16x32_bf16 a[224:227], a[160:163], v[216:219], a[224:227]
    v_xor_b32 v247, 16, v247
    ds_read_b128 a[4:7], v247 offset:128
    v_cvt_pk_bf16_f32 v193, v194, v195
    v_mfma_f32_16x16x32_bf16 a[228:231], a[164:167], v[216:219], a[228:231]
    ds_read_b128 a[12:15], v247 offset:384
    ds_read_b128 a[20:23], v247 offset:640
    ds_read_b64_tr_b16 a[160:161], v226 offset:8192
    ds_read_b64_tr_b16 a[162:163], v226 offset:10240
    v_exp_f32 v202, v202
    v_add_f32 v241, v241, v200
    v_mfma_f32_16x16x32_bf16 a[232:235], a[168:171], v[216:219], a[232:235]
    ds_read_b128 a[28:31], v247 offset:896
    ds_read_b64_tr_b16 a[164:165], v227 offset:8192
    v_xor_b32 v247, 16, v247
    v_exp_f32 v203, v203
    v_mfma_f32_16x16x32_bf16 a[236:239], a[172:175], v[216:219], a[236:239]
    ds_read_b64_tr_b16 a[166:167], v227 offset:10240
    v_add_f32 v241, v241, v201
    v_cvt_pk_bf16_f32 v200, v200, v201
    v_mfma_f32_16x16x32_bf16 a[240:243], a[176:179], v[216:219], a[240:243]
    ds_read_b64_tr_b16 a[168:169], v228 offset:8192
    v_exp_f32 v196, v196
    v_mfma_f32_16x16x32_bf16 a[244:247], a[180:183], v[216:219], a[244:247]
    s_waitcnt lgkmcnt(4)
    ds_read_b64_tr_b16 a[170:171], v228 offset:10240
    v_mul_f32 v64, v64, v238
    v_add_f32 v241, v241, v202
    v_mfma_f32_16x16x32_bf16 a[248:251], a[184:187], v[216:219], a[248:251]
    ds_read_b64_tr_b16 a[172:173], v229 offset:8192
    v_mul_f32 v65, v65, v238
    v_exp_f32 v197, v197
    v_add_f32 v241, v241, v203
    v_mfma_f32_16x16x32_bf16 a[252:255], a[188:191], v[216:219], a[252:255]
    ds_read_b64_tr_b16 a[174:175], v229 offset:10240
    v_mul_f32 v66, v66, v238
    v_mul_f32 v67, v67, v238
    v_cvt_pk_bf16_f32 v201, v202, v203
    v_mfma_f32_16x16x32_bf16 v[208:211], a[128:131], a[96:99], v[232:235]
    s_add_u32 s48, s47, 0
    ds_read_b64_tr_b16 a[176:177], v226 offset:12288
    v_cvt_pk_bf16_f32 v64, v64, v65
    v_exp_f32 v198, v198
    v_add_f32 v240, v240, v196
    v_mfma_f32_16x16x32_bf16 v[216:219], a[128:131], a[112:115], v[232:235]
    ds_read_b64_tr_b16 a[178:179], v226 offset:14336
    v_cvt_pk_bf16_f32 v65, v66, v67
    v_exp_f32 v199, v199
    v_mfma_f32_16x16x32_bf16 v[208:211], a[132:135], a[100:103], v[208:211]
    s_add_u32 s49, s48, 4096
    ds_read_b64_tr_b16 a[180:181], v227 offset:12288
    v_mul_f32 v68, v68, v238
    v_mul_f32 v69, v69, v238
    v_add_f32 v240, v240, v197
    v_cvt_pk_bf16_f32 v194, v196, v197
    v_mfma_f32_16x16x32_bf16 v[216:219], a[132:135], a[116:119], v[216:219]
    ds_read_b64_tr_b16 a[182:183], v227 offset:14336
    v_mul_f32 v70, v70, v238
    v_exp_f32 v204, v204
    v_mfma_f32_16x16x32_bf16 v[208:211], a[136:139], a[104:107], v[208:211]
    buffer_store_dwordx4 a[0:3], v248, s[16:19], s48 offen offset:0 nt
    ds_read_b64_tr_b16 a[184:185], v228 offset:12288
    v_mul_f32 v71, v71, v238
    v_cvt_pk_bf16_f32 v68, v68, v69
    v_add_f32 v240, v240, v198
    v_mfma_f32_16x16x32_bf16 v[216:219], a[136:139], a[120:123], v[216:219]
    ds_write_b64 v246, v[64:65] offset:0
    ds_read_b64_tr_b16 a[186:187], v228 offset:14336
    v_exp_f32 v205, v205
    v_add_f32 v240, v240, v199
    v_mfma_f32_16x16x32_bf16 v[208:211], a[140:143], a[108:111], v[208:211]
    buffer_store_dwordx4 a[8:11], v248, s[16:19], s48 offen offset:2048 nt
    ds_read_b64_tr_b16 a[188:189], v229 offset:12288
    v_cvt_pk_bf16_f32 v69, v70, v71
    v_cvt_pk_bf16_f32 v195, v198, v199
    v_mfma_f32_16x16x32_bf16 v[216:219], a[140:143], a[124:127], v[216:219]
    s_waitcnt lgkmcnt(3)
    ds_read_b64_tr_b16 a[190:191], v229 offset:14336
    v_mul_f32 v72, v72, v238
    v_mul_f32 v73, v73, v238
    v_mfma_f32_16x16x32_bf16 v[128:131], a[160:163], v[192:195], v[128:131]
    buffer_store_dwordx4 a[16:19], v248, s[16:19], s49 offen offset:0 nt
    v_mul_f32 v74, v74, v238
    v_mfma_f32_16x16x32_bf16 v[132:135], a[164:167], v[192:195], v[132:135]
    v_mul_f32 v75, v75, v238
    v_cvt_pk_bf16_f32 v72, v72, v73
    v_mfma_f32_16x16x32_bf16 v[136:139], a[168:171], v[192:195], v[136:139]
    ds_write_b64 v246, v[68:69] offset:1024
    buffer_store_dwordx4 a[24:27], v248, s[16:19], s49 offen offset:2048 nt
    v_mfma_f32_16x16x32_bf16 v[140:143], a[172:175], v[192:195], v[140:143]
    v_cvt_pk_bf16_f32 v73, v74, v75
    v_exp_f32 v206, v206
    v_add_f32 v241, v241, v204
    v_mfma_f32_16x16x32_bf16 v[144:147], a[176:179], v[192:195], v[144:147]
    buffer_store_dwordx4 a[4:7], v248, s[16:19], s48 offen offset:1024 nt
    v_mul_f32 v76, v76, v238
    v_mul_f32 v77, v77, v238
    v_exp_f32 v207, v207
    v_mfma_f32_16x16x32_bf16 v[148:151], a[180:183], v[192:195], v[148:151]
    s_waitcnt lgkmcnt(1)
    v_mul_f32 v78, v78, v238
    v_add_f32 v241, v241, v205
    v_cvt_pk_bf16_f32 v202, v204, v205
    v_mfma_f32_16x16x32_bf16 v[152:155], a[184:187], v[192:195], v[152:155]
    buffer_store_dwordx4 a[12:15], v248, s[16:19], s48 offen offset:3072 nt
    v_mul_f32 v79, v79, v238
    v_cvt_pk_bf16_f32 v76, v76, v77
    v_add_f32 v241, v241, v206
    v_add_f32 v241, v241, v207
    v_mfma_f32_16x16x32_bf16 v[156:159], a[188:191], v[192:195], v[156:159]
    ds_write_b64 v246, v[72:73] offset:2048
    v_cvt_pk_bf16_f32 v203, v206, v207
    v_mfma_f32_16x16x32_bf16 v[212:215], a[144:147], a[96:99], v[232:235]
    buffer_store_dwordx4 a[20:23], v248, s[16:19], s49 offen offset:1024 nt
    v_cvt_pk_bf16_f32 v77, v78, v79
    v_exp_f32 v208, v208
    v_mfma_f32_16x16x32_bf16 v[220:223], a[144:147], a[112:115], v[232:235]
    v_mul_f32 v80, v80, v238
    v_mul_f32 v81, v81, v238
    v_exp_f32 v209, v209
    v_mfma_f32_16x16x32_bf16 v[212:215], a[148:151], a[100:103], v[212:215]
    buffer_store_dwordx4 a[28:31], v248, s[16:19], s49 offen offset:3072 nt
    v_mul_f32 v82, v82, v238
    v_exp_f32 v210, v210
    v_add_f32 v242, v242, v208
    v_mfma_f32_16x16x32_bf16 v[220:223], a[148:151], a[116:119], v[220:223]
    v_mul_f32 v83, v83, v238
    v_cvt_pk_bf16_f32 v80, v80, v81
    v_exp_f32 v211, v211
    v_mfma_f32_16x16x32_bf16 v[212:215], a[152:155], a[104:107], v[212:215]
    ds_write_b64 v246, v[76:77] offset:3072
    v_add_f32 v242, v242, v209
    v_cvt_pk_bf16_f32 v208, v208, v209
    v_mfma_f32_16x16x32_bf16 v[220:223], a[152:155], a[120:123], v[220:223]
    v_cvt_pk_bf16_f32 v81, v82, v83
    v_exp_f32 v216, v216
    v_mfma_f32_16x16x32_bf16 v[212:215], a[156:159], a[108:111], v[212:215]
    v_mul_f32 v84, v84, v238
    v_mul_f32 v85, v85, v238
    v_add_f32 v242, v242, v210
    v_mfma_f32_16x16x32_bf16 v[220:223], a[156:159], a[124:127], v[220:223]
    v_mul_f32 v86, v86, v238
    v_exp_f32 v217, v217
    v_add_f32 v242, v242, v211
    v_mfma_f32_16x16x32_bf16 v[160:163], a[160:163], v[200:203], v[160:163]
    ds_read_b128 a[128:131], v224 offset:16384
    v_mul_f32 v87, v87, v238
    v_cvt_pk_bf16_f32 v84, v84, v85
    v_cvt_pk_bf16_f32 v209, v210, v211
    v_mfma_f32_16x16x32_bf16 v[164:167], a[164:167], v[200:203], v[164:167]
    ds_write_b64 v246, v[80:81] offset:4096
    v_exp_f32 v218, v218
    v_add_f32 v243, v243, v216
    v_mfma_f32_16x16x32_bf16 v[168:171], a[168:171], v[200:203], v[168:171]
    ds_read_b128 a[132:135], v225 offset:16384
    v_cvt_pk_bf16_f32 v85, v86, v87
    v_exp_f32 v219, v219
    v_mfma_f32_16x16x32_bf16 v[172:175], a[172:175], v[200:203], v[172:175]
    v_mul_f32 v88, v88, v238
    v_mul_f32 v89, v89, v238
    v_add_f32 v243, v243, v217
    v_cvt_pk_bf16_f32 v216, v216, v217
    v_mfma_f32_16x16x32_bf16 v[176:179], a[176:179], v[200:203], v[176:179]
    ds_read_b128 a[136:139], v224 offset:20480
    v_mul_f32 v90, v90, v238
    v_exp_f32 v212, v212
    v_mfma_f32_16x16x32_bf16 v[180:183], a[180:183], v[200:203], v[180:183]
    v_mul_f32 v91, v91, v238
    v_cvt_pk_bf16_f32 v88, v88, v89
    v_add_f32 v243, v243, v218
    v_mfma_f32_16x16x32_bf16 v[184:187], a[184:187], v[200:203], v[184:187]
    ds_write_b64 v246, v[84:85] offset:5120
    ds_read_b128 a[140:143], v225 offset:20480
    v_exp_f32 v213, v213
    v_add_f32 v243, v243, v219
    v_mfma_f32_16x16x32_bf16 v[188:191], a[188:191], v[200:203], v[188:191]
    s_waitcnt lgkmcnt(3)
    v_cvt_pk_bf16_f32 v89, v90, v91
    v_cvt_pk_bf16_f32 v217, v218, v219
    v_mfma_f32_16x16x32_bf16 v[192:195], a[128:131], a[64:67], v[232:235]
    v_mul_f32 v92, v92, v238
    v_mul_f32 v93, v93, v238
    v_exp_f32 v214, v214
    v_add_f32 v242, v242, v212
    v_mfma_f32_16x16x32_bf16 v[200:203], a[128:131], a[80:83], v[232:235]
    v_mul_f32 v94, v94, v238
    v_exp_f32 v215, v215
    v_mfma_f32_16x16x32_bf16 v[192:195], a[132:135], a[68:71], v[192:195]
    v_mul_f32 v95, v95, v238
    v_cvt_pk_bf16_f32 v92, v92, v93
    v_add_f32 v242, v242, v213
    v_cvt_pk_bf16_f32 v210, v212, v213
    v_mfma_f32_16x16x32_bf16 v[200:203], a[132:135], a[84:87], v[200:203]
    s_waitcnt lgkmcnt(0)
    ds_write_b64 v246, v[88:89] offset:6144
    v_exp_f32 v220, v220
    v_mfma_f32_16x16x32_bf16 v[192:195], a[136:139], a[72:75], v[192:195]
    v_cvt_pk_bf16_f32 v93, v94, v95
    v_add_f32 v242, v242, v214
    v_mfma_f32_16x16x32_bf16 v[200:203], a[136:139], a[88:91], v[200:203]
    v_mul_f32 v96, v96, v239
    v_mul_f32 v97, v97, v239
    v_exp_f32 v221, v221
    v_add_f32 v242, v242, v215
    v_mfma_f32_16x16x32_bf16 v[192:195], a[140:143], a[76:79], v[192:195]
    v_mul_f32 v98, v98, v239
    v_cvt_pk_bf16_f32 v211, v214, v215
    v_mfma_f32_16x16x32_bf16 v[200:203], a[140:143], a[92:95], v[200:203]
    v_mul_f32 v99, v99, v239
    v_cvt_pk_bf16_f32 v96, v96, v97
    v_mfma_f32_16x16x32_bf16 a[192:195], a[160:163], v[208:211], a[192:195]
    ds_write_b64 v246, v[92:93] offset:7168
    ds_read_b128 a[144:147], v224 offset:18432
    v_mfma_f32_16x16x32_bf16 a[196:199], a[164:167], v[208:211], a[196:199]
    v_cvt_pk_bf16_f32 v97, v98, v99
    v_mul_f32 v100, v100, v239
    v_mfma_f32_16x16x32_bf16 a[200:203], a[168:171], v[208:211], a[200:203]
    ds_read_b128 a[148:151], v225 offset:18432
    v_mul_f32 v101, v101, v239
    v_mfma_f32_16x16x32_bf16 a[204:207], a[172:175], v[208:211], a[204:207]
    v_mul_f32 v102, v102, v239
    v_exp_f32 v222, v222
    v_add_f32 v243, v243, v220
    v_mfma_f32_16x16x32_bf16 a[208:211], a[176:179], v[208:211], a[208:211]
    ds_read_b128 a[152:155], v224 offset:22528
    v_mul_f32 v103, v103, v239
    v_cvt_pk_bf16_f32 v100, v100, v101
    v_exp_f32 v223, v223
    v_mfma_f32_16x16x32_bf16 a[212:215], a[180:183], v[208:211], a[212:215]
    ds_write_b64 v246, v[96:97] offset:512
    v_add_f32 v243, v243, v221
    v_cvt_pk_bf16_f32 v218, v220, v221
    v_mfma_f32_16x16x32_bf16 a[216:219], a[184:187], v[208:211], a[216:219]
    ds_read_b128 a[156:159], v225 offset:22528
    v_cvt_pk_bf16_f32 v101, v102, v103
    v_add_f32 v243, v243, v222
    v_add_f32 v243, v243, v223
    v_mfma_f32_16x16x32_bf16 a[220:223], a[188:191], v[208:211], a[220:223]
    s_waitcnt lgkmcnt(2)
    v_mul_f32 v104, v104, v239
    v_mul_f32 v105, v105, v239
    v_cvt_pk_bf16_f32 v219, v222, v223
    v_mfma_f32_16x16x32_bf16 v[196:199], a[144:147], a[64:67], v[232:235]
    v_mul_f32 v106, v106, v239
    v_exp_f32 v192, v192
    v_mfma_f32_16x16x32_bf16 v[204:207], a[144:147], a[80:83], v[232:235]
    v_mul_f32 v107, v107, v239
    v_cvt_pk_bf16_f32 v104, v104, v105
    v_exp_f32 v193, v193
    v_mfma_f32_16x16x32_bf16 v[196:199], a[148:151], a[68:71], v[196:199]
    ds_write_b64 v246, v[100:101] offset:1536
    v_exp_f32 v194, v194
    v_add_f32 v240, v240, v192
    v_mfma_f32_16x16x32_bf16 v[204:207], a[148:151], a[84:87], v[204:207]
    v_cvt_pk_bf16_f32 v105, v106, v107
    v_exp_f32 v195, v195
    v_mfma_f32_16x16x32_bf16 v[196:199], a[152:155], a[72:75], v[196:199]
    v_mul_f32 v108, v108, v239
    v_mul_f32 v109, v109, v239
    v_accvgpr_read_b32 v0, a192
    v_add_f32 v240, v240, v193
    v_cvt_pk_bf16_f32 v192, v192, v193
    v_mfma_f32_16x16x32_bf16 v[204:207], a[152:155], a[88:91], v[204:207]
    s_waitcnt lgkmcnt(1)
    v_mul_f32 v110, v110, v239
    v_accvgpr_read_b32 v1, a193
    v_exp_f32 v200, v200
    v_mfma_f32_16x16x32_bf16 v[196:199], a[156:159], a[76:79], v[196:199]
    v_mul_f32 v111, v111, v239
    v_cvt_pk_bf16_f32 v108, v108, v109
    v_accvgpr_read_b32 v2, a194
    v_add_f32 v240, v240, v194
    v_mfma_f32_16x16x32_bf16 v[204:207], a[156:159], a[92:95], v[204:207]
    ds_write_b64 v246, v[104:105] offset:2560
    v_accvgpr_read_b32 v3, a195
    v_exp_f32 v201, v201
    v_add_f32 v240, v240, v195
    v_mfma_f32_16x16x32_bf16 a[224:227], a[160:163], v[216:219], a[224:227]
    v_cvt_pk_bf16_f32 v109, v110, v111
    v_accvgpr_read_b32 v4, a196
    v_cvt_pk_bf16_f32 v193, v194, v195
    v_mfma_f32_16x16x32_bf16 a[228:231], a[164:167], v[216:219], a[228:231]
    ds_read_b64_tr_b16 a[160:161], v226 offset:24576
    ds_read_b64_tr_b16 a[162:163], v226 offset:26624
    v_mul_f32 v112, v112, v239
    v_mul_f32 v113, v113, v239
    v_accvgpr_read_b32 v5, a197
    v_exp_f32 v202, v202
    v_add_f32 v241, v241, v200
    v_mfma_f32_16x16x32_bf16 a[232:235], a[168:171], v[216:219], a[232:235]
    ds_read_b64_tr_b16 a[164:165], v227 offset:24576
    v_mul_f32 v114, v114, v239
    v_accvgpr_read_b32 v6, a198
    v_exp_f32 v203, v203
    v_mfma_f32_16x16x32_bf16 a[236:239], a[172:175], v[216:219], a[236:239]
    ds_read_b64_tr_b16 a[166:167], v227 offset:26624
    v_mul_f32 v115, v115, v239
    v_cvt_pk_bf16_f32 v112, v112, v113
    v_accvgpr_read_b32 v7, a199
    v_add_f32 v241, v241, v201
    v_cvt_pk_bf16_f32 v200, v200, v201
    v_mfma_f32_16x16x32_bf16 a[240:243], a[176:179], v[216:219], a[240:243]
    ds_write_b64 v246, v[108:109] offset:3584
    ds_read_b64_tr_b16 a[168:169], v228 offset:24576
    v_accvgpr_read_b32 v8, a200
    v_exp_f32 v196, v196
    v_mfma_f32_16x16x32_bf16 a[244:247], a[180:183], v[216:219], a[244:247]
    ds_read_b64_tr_b16 a[170:171], v228 offset:26624
    v_cvt_pk_bf16_f32 v113, v114, v115
    v_accvgpr_read_b32 v9, a201
    v_add_f32 v241, v241, v202
    v_mfma_f32_16x16x32_bf16 a[248:251], a[184:187], v[216:219], a[248:251]
    ds_read_b64_tr_b16 a[172:173], v229 offset:24576
    v_mul_f32 v116, v116, v239
    v_mul_f32 v117, v117, v239
    v_accvgpr_read_b32 v10, a202
    v_exp_f32 v197, v197
    v_add_f32 v241, v241, v203
    v_mfma_f32_16x16x32_bf16 a[252:255], a[188:191], v[216:219], a[252:255]
    ds_read_b64_tr_b16 a[174:175], v229 offset:26624
    v_mul_f32 v118, v118, v239
    v_accvgpr_read_b32 v11, a203
    v_cvt_pk_bf16_f32 v201, v202, v203
    v_mfma_f32_16x16x32_bf16 v[208:211], a[128:131], a[96:99], v[232:235]
    ds_read_b64_tr_b16 a[176:177], v226 offset:28672
    v_mul_f32 v119, v119, v239
    v_cvt_pk_bf16_f32 v116, v116, v117
    v_accvgpr_read_b32 v12, a204
    v_exp_f32 v198, v198
    v_add_f32 v240, v240, v196
    v_mfma_f32_16x16x32_bf16 v[216:219], a[128:131], a[112:115], v[232:235]
    ds_write_b64 v246, v[112:113] offset:4608
    ds_read_b64_tr_b16 a[178:179], v226 offset:30720
    v_accvgpr_read_b32 v13, a205
    v_exp_f32 v199, v199
    v_mfma_f32_16x16x32_bf16 v[208:211], a[132:135], a[100:103], v[208:211]
    ds_read_b64_tr_b16 a[180:181], v227 offset:28672
    v_cvt_pk_bf16_f32 v117, v118, v119
    v_accvgpr_read_b32 v14, a206
    v_add_f32 v240, v240, v197
    v_cvt_pk_bf16_f32 v194, v196, v197
    v_mfma_f32_16x16x32_bf16 v[216:219], a[132:135], a[116:119], v[216:219]
    s_waitcnt lgkmcnt(3)
    ds_read_b64_tr_b16 a[182:183], v227 offset:30720
    v_mul_f32 v120, v120, v239
    v_mul_f32 v121, v121, v239
    v_exp_f32 v204, v204
    v_mfma_f32_16x16x32_bf16 v[208:211], a[136:139], a[104:107], v[208:211]
    ds_read_b64_tr_b16 a[184:185], v228 offset:28672
    v_mul_f32 v122, v122, v239
    v_accvgpr_read_b32 v15, a207
    v_add_f32 v240, v240, v198
    v_mfma_f32_16x16x32_bf16 v[216:219], a[136:139], a[120:123], v[216:219]
    ds_read_b64_tr_b16 a[186:187], v228 offset:30720
    v_mul_f32 v123, v123, v239
    v_cvt_pk_bf16_f32 v120, v120, v121
    v_accvgpr_read_b32 v16, a208
    v_exp_f32 v205, v205
    v_add_f32 v240, v240, v199
    v_mfma_f32_16x16x32_bf16 v[208:211], a[140:143], a[108:111], v[208:211]
    ds_write_b64 v246, v[116:117] offset:5632
    ds_read_b64_tr_b16 a[188:189], v229 offset:28672
    v_accvgpr_read_b32 v17, a209
    v_cvt_pk_bf16_f32 v195, v198, v199
    v_mfma_f32_16x16x32_bf16 v[216:219], a[140:143], a[124:127], v[216:219]
    ds_read_b64_tr_b16 a[190:191], v229 offset:30720
    v_cvt_pk_bf16_f32 v121, v122, v123
    v_accvgpr_read_b32 v18, a210
    v_mfma_f32_16x16x32_bf16 v[128:131], a[160:163], v[192:195], v[128:131]
    v_mul_f32 v124, v124, v239
    v_mul_f32 v125, v125, v239
    v_accvgpr_read_b32 v19, a211
    v_mfma_f32_16x16x32_bf16 v[132:135], a[164:167], v[192:195], v[132:135]
    v_mul_f32 v126, v126, v239
    v_accvgpr_read_b32 v20, a212
    v_mfma_f32_16x16x32_bf16 v[136:139], a[168:171], v[192:195], v[136:139]
    v_mul_f32 v127, v127, v239
    v_cvt_pk_bf16_f32 v124, v124, v125
    v_accvgpr_read_b32 v21, a213
    v_mfma_f32_16x16x32_bf16 v[140:143], a[172:175], v[192:195], v[140:143]
    s_waitcnt lgkmcnt(0)
    ds_write_b64 v246, v[120:121] offset:6656
    v_accvgpr_read_b32 v22, a214
    v_exp_f32 v206, v206
    v_add_f32 v241, v241, v204
    v_mfma_f32_16x16x32_bf16 v[144:147], a[176:179], v[192:195], v[144:147]
    v_cvt_pk_bf16_f32 v125, v126, v127
    v_accvgpr_read_b32 v23, a215
    v_exp_f32 v207, v207
    v_mfma_f32_16x16x32_bf16 v[148:151], a[180:183], v[192:195], v[148:151]
    ds_write_b64 v246, v[124:125] offset:7680
    v_accvgpr_read_b32 v24, a216
    v_add_f32 v241, v241, v205
    v_cvt_pk_bf16_f32 v202, v204, v205
    v_mfma_f32_16x16x32_bf16 v[152:155], a[184:187], v[192:195], v[152:155]
    ds_read_b128 a[32:35], v247 offset:0
    ds_read_b128 a[40:43], v247 offset:256
    v_accvgpr_read_b32 v25, a217
    v_add_f32 v241, v241, v206
    v_add_f32 v241, v241, v207
    v_mfma_f32_16x16x32_bf16 v[156:159], a[188:191], v[192:195], v[156:159]
    ds_read_b128 a[48:51], v247 offset:512
    ds_read_b128 a[56:59], v247 offset:768
    v_accvgpr_read_b32 v26, a218
    v_cvt_pk_bf16_f32 v203, v206, v207
    v_mfma_f32_16x16x32_bf16 v[212:215], a[144:147], a[96:99], v[232:235]
    v_xor_b32 v247, 16, v247
    ds_read_b128 a[36:39], v247 offset:128
    v_accvgpr_read_b32 v27, a219
    v_exp_f32 v208, v208
    v_mfma_f32_16x16x32_bf16 v[220:223], a[144:147], a[112:115], v[232:235]
    ds_read_b128 a[44:47], v247 offset:384
    ds_read_b128 a[52:55], v247 offset:640
    v_accvgpr_read_b32 v28, a220
    v_exp_f32 v209, v209
    v_mfma_f32_16x16x32_bf16 v[212:215], a[148:151], a[100:103], v[212:215]
    ds_read_b128 a[60:63], v247 offset:896
    v_xor_b32 v247, 16, v247
    v_accvgpr_read_b32 v29, a221
    v_exp_f32 v210, v210
    v_add_f32 v242, v242, v208
    v_mfma_f32_16x16x32_bf16 v[220:223], a[148:151], a[116:119], v[220:223]
    v_accvgpr_read_b32 v30, a222
    v_exp_f32 v211, v211
    v_mfma_f32_16x16x32_bf16 v[212:215], a[152:155], a[104:107], v[212:215]
    v_accvgpr_read_b32 v31, a223
    v_accvgpr_read_b32 v32, a224
    v_add_f32 v242, v242, v209
    v_cvt_pk_bf16_f32 v208, v208, v209
    v_mfma_f32_16x16x32_bf16 v[220:223], a[152:155], a[120:123], v[220:223]
    v_accvgpr_read_b32 v33, a225
    v_exp_f32 v216, v216
    v_mfma_f32_16x16x32_bf16 v[212:215], a[156:159], a[108:111], v[212:215]
    v_accvgpr_read_b32 v34, a226
    v_add_f32 v242, v242, v210
    v_mfma_f32_16x16x32_bf16 v[220:223], a[156:159], a[124:127], v[220:223]
    v_accvgpr_read_b32 v35, a227
    v_exp_f32 v217, v217
    v_add_f32 v242, v242, v211
    v_mfma_f32_16x16x32_bf16 v[160:163], a[160:163], v[200:203], v[160:163]
    s_mov_b32 s60, 0x4e800000
    s_mov_b32 s61, 0x2b800000
    s_add_u32 s48, s47, 32768
    ds_read_b128 a[128:131], v224 offset:32768
    v_accvgpr_read_b32 v36, a228
    v_cvt_pk_bf16_f32 v209, v210, v211
    v_mfma_f32_16x16x32_bf16 v[164:167], a[164:167], v[200:203], v[164:167]
    v_mov_b32 v230, v240
    v_mov_b32 v231, v241
    v_accvgpr_read_b32 v37, a229
    v_exp_f32 v218, v218
    v_add_f32 v243, v243, v216
    v_mfma_f32_16x16x32_bf16 v[168:171], a[168:171], v[200:203], v[168:171]
    s_add_u32 s49, s48, 4096
    ds_read_b128 a[132:135], v225 offset:32768
    v_permlane32_swap_b32 v230, v240
    v_permlane32_swap_b32 v231, v241
    v_accvgpr_read_b32 v38, a230
    v_exp_f32 v219, v219
    v_mfma_f32_16x16x32_bf16 v[172:175], a[172:175], v[200:203], v[172:175]
    v_add_f32 v240, v240, v230
    v_add_f32 v241, v241, v231
    v_accvgpr_read_b32 v39, a231
    v_add_f32 v243, v243, v217
    v_cvt_pk_bf16_f32 v216, v216, v217
    v_mfma_f32_16x16x32_bf16 v[176:179], a[176:179], v[200:203], v[176:179]
    s_waitcnt lgkmcnt(1)
    buffer_store_dwordx4 a[32:35], v248, s[16:19], s48 offen offset:0 nt
    ds_read_b128 a[136:139], v224 offset:36864
    v_mov_b32 v230, v240
    v_mov_b32 v231, v241
    v_accvgpr_read_b32 v40, a232
    v_exp_f32 v212, v212
    v_mfma_f32_16x16x32_bf16 v[180:183], a[180:183], v[200:203], v[180:183]
    v_permlane16_swap_b32 v230, v240
    v_permlane16_swap_b32 v231, v241
    v_accvgpr_read_b32 v41, a233
    v_add_f32 v243, v243, v218
    v_mfma_f32_16x16x32_bf16 v[184:187], a[184:187], v[200:203], v[184:187]
    buffer_store_dwordx4 a[40:43], v248, s[16:19], s48 offen offset:2048 nt
    ds_read_b128 a[140:143], v225 offset:36864
    v_add_f32 v240, v240, v230
    v_add_f32 v241, v241, v231
    v_accvgpr_read_b32 v42, a234
    v_exp_f32 v213, v213
    v_add_f32 v243, v243, v219
    v_mfma_f32_16x16x32_bf16 v[188:191], a[188:191], v[200:203], v[188:191]
    v_min_f32 v230, s60, v240
    v_min_f32 v231, s60, v241
    v_accvgpr_read_b32 v43, a235
    v_cvt_pk_bf16_f32 v217, v218, v219
    v_mfma_f32_16x16x32_bf16 v[192:195], a[128:131], a[96:99], v[232:235]
    buffer_store_dwordx4 a[48:51], v248, s[16:19], s49 offen offset:0 nt
    v_max_f32 v230, s61, v230
    v_max_f32 v231, s61, v231
    v_accvgpr_read_b32 v44, a236
    v_exp_f32 v214, v214
    v_add_f32 v242, v242, v212
    v_mfma_f32_16x16x32_bf16 v[200:203], a[128:131], a[112:115], v[232:235]
    s_waitcnt lgkmcnt(0)
    v_cmp_neq_f32 s[56:57], v230, v240
    v_cmp_neq_f32 s[58:59], v231, v241
    v_accvgpr_read_b32 v45, a237
    v_exp_f32 v215, v215
    v_mfma_f32_16x16x32_bf16 v[192:195], a[132:135], a[100:103], v[192:195]
    buffer_store_dwordx4 a[56:59], v248, s[16:19], s49 offen offset:2048 nt
    v_rcp_f32 v240, v240
    v_rcp_f32 v241, v241
    v_accvgpr_read_b32 v46, a238
    v_add_f32 v242, v242, v213
    v_cvt_pk_bf16_f32 v210, v212, v213
    v_mfma_f32_16x16x32_bf16 v[200:203], a[132:135], a[116:119], v[200:203]
    s_or_b32 s24, s24, s56
    s_or_b32 s24, s24, s58
    v_exp_f32 v220, v220
    v_mfma_f32_16x16x32_bf16 v[192:195], a[136:139], a[104:107], v[192:195]
    s_or_b32 s24, s24, s57
    s_or_b32 s24, s24, s59
    buffer_store_dwordx4 a[36:39], v248, s[16:19], s48 offen offset:1024 nt
    v_accvgpr_read_b32 v47, a239
    v_add_f32 v242, v242, v214
    v_mfma_f32_16x16x32_bf16 v[200:203], a[136:139], a[120:123], v[200:203]
    v_mul_f32 v128, v128, v240
    v_mul_f32 v129, v129, v240
    v_mul_f32 v130, v130, v240
    v_accvgpr_read_b32 v48, a240
    v_exp_f32 v221, v221
    v_add_f32 v242, v242, v215
    v_mfma_f32_16x16x32_bf16 v[192:195], a[140:143], a[108:111], v[192:195]
    buffer_store_dwordx4 a[44:47], v248, s[16:19], s48 offen offset:3072 nt
    v_mul_f32 v131, v131, v240
    v_cvt_pk_bf16_f32 v128, v128, v129
    v_cvt_pk_bf16_f32 v129, v130, v131
    v_mul_f32 v132, v132, v240
    v_accvgpr_read_b32 v49, a241
    v_cvt_pk_bf16_f32 v211, v214, v215
    v_mfma_f32_16x16x32_bf16 v[200:203], a[140:143], a[124:127], v[200:203]
    v_mul_f32 v133, v133, v240
    v_mul_f32 v134, v134, v240
    v_mul_f32 v135, v135, v240
    v_cvt_pk_bf16_f32 v132, v132, v133
    v_accvgpr_read_b32 v50, a242
    v_mfma_f32_16x16x32_bf16 v[0:3], a[160:163], v[208:211], v[0:3]
    ds_write_b64 v246, v[128:129] offset:0
    buffer_store_dwordx4 a[52:55], v248, s[16:19], s49 offen offset:1024 nt
    ds_read_b128 a[144:147], v224 offset:34816
    v_cvt_pk_bf16_f32 v133, v134, v135
    v_mul_f32 v136, v136, v240
    v_accvgpr_read_b32 v51, a243
    v_mfma_f32_16x16x32_bf16 v[4:7], a[164:167], v[208:211], v[4:7]
    v_mul_f32 v137, v137, v240
    v_mul_f32 v138, v138, v240
    v_mul_f32 v139, v139, v240
    v_cvt_pk_bf16_f32 v136, v136, v137
    v_accvgpr_read_b32 v52, a244
    v_mfma_f32_16x16x32_bf16 v[8:11], a[168:171], v[208:211], v[8:11]
    ds_write_b64 v246, v[132:133] offset:1024
    buffer_store_dwordx4 a[60:63], v248, s[16:19], s49 offen offset:3072 nt
    ds_read_b128 a[148:151], v225 offset:34816
    v_cvt_pk_bf16_f32 v137, v138, v139
    v_mul_f32 v140, v140, v240
    v_mul_f32 v141, v141, v240
    v_accvgpr_read_b32 v53, a245
    v_mfma_f32_16x16x32_bf16 v[12:15], a[172:175], v[208:211], v[12:15]
    ds_write_b64 v246, v[136:137] offset:2048
    v_mul_f32 v142, v142, v240
    v_mul_f32 v143, v143, v240
    v_cvt_pk_bf16_f32 v140, v140, v141
    v_accvgpr_read_b32 v54, a246
    v_exp_f32 v222, v222
    v_add_f32 v243, v243, v220
    v_mfma_f32_16x16x32_bf16 v[16:19], a[176:179], v[208:211], v[16:19]
    ds_read_b128 a[152:155], v224 offset:38912
    v_cvt_pk_bf16_f32 v141, v142, v143
    v_mul_f32 v144, v144, v240
    v_mul_f32 v145, v145, v240
    v_accvgpr_read_b32 v55, a247
    v_exp_f32 v223, v223
    v_mfma_f32_16x16x32_bf16 v[20:23], a[180:183], v[208:211], v[20:23]
    ds_write_b64 v246, v[140:141] offset:3072
    v_mul_f32 v146, v146, v240
    v_mul_f32 v147, v147, v240
    v_cvt_pk_bf16_f32 v144, v144, v145
    v_accvgpr_read_b32 v56, a248
    v_add_f32 v243, v243, v221
    v_cvt_pk_bf16_f32 v218, v220, v221
    v_mfma_f32_16x16x32_bf16 v[24:27], a[184:187], v[208:211], v[24:27]
    ds_read_b128 a[156:159], v225 offset:38912
    v_cvt_pk_bf16_f32 v145, v146, v147
    v_mul_f32 v148, v148, v240
    v_mul_f32 v149, v149, v240
    v_mul_f32 v150, v150, v240
    v_accvgpr_read_b32 v57, a249
    v_add_f32 v243, v243, v222
    v_add_f32 v243, v243, v223
    v_mfma_f32_16x16x32_bf16 v[28:31], a[188:191], v[208:211], v[28:31]
    s_waitcnt lgkmcnt(1)
    ds_write_b64 v246, v[144:145] offset:4096
    v_mul_f32 v151, v151, v240
    v_cvt_pk_bf16_f32 v148, v148, v149
    v_cvt_pk_bf16_f32 v149, v150, v151
    v_accvgpr_read_b32 v58, a250
    v_cvt_pk_bf16_f32 v219, v222, v223
    v_mfma_f32_16x16x32_bf16 v[196:199], a[144:147], a[96:99], v[232:235]
    v_mul_f32 v152, v152, v240
    v_mul_f32 v153, v153, v240
    v_mul_f32 v154, v154, v240
    v_accvgpr_read_b32 v59, a251
    v_exp_f32 v192, v192
    v_mfma_f32_16x16x32_bf16 v[204:207], a[144:147], a[112:115], v[232:235]
    ds_write_b64 v246, v[148:149] offset:5120
    v_mul_f32 v155, v155, v240
    v_cvt_pk_bf16_f32 v152, v152, v153
    v_cvt_pk_bf16_f32 v153, v154, v155
    v_accvgpr_read_b32 v60, a252
    v_exp_f32 v193, v193
    v_mfma_f32_16x16x32_bf16 v[196:199], a[148:151], a[100:103], v[196:199]
    v_mul_f32 v156, v156, v240
    v_mul_f32 v157, v157, v240
    v_mul_f32 v158, v158, v240
    v_mul_f32 v159, v159, v240
    v_accvgpr_read_b32 v61, a253
    v_exp_f32 v194, v194
    v_add_f32 v242, v242, v192
    v_mfma_f32_16x16x32_bf16 v[204:207], a[148:151], a[116:119], v[204:207]
    ds_write_b64 v246, v[152:153] offset:6144
    v_cvt_pk_bf16_f32 v156, v156, v157
    v_cvt_pk_bf16_f32 v157, v158, v159
    v_accvgpr_read_b32 v62, a254
    v_exp_f32 v195, v195
    v_mfma_f32_16x16x32_bf16 v[196:199], a[152:155], a[104:107], v[196:199]
    v_mul_f32 v160, v160, v241
    v_mul_f32 v161, v161, v241
    v_mul_f32 v162, v162, v241
    v_mul_f32 v163, v163, v241
    v_add_f32 v242, v242, v193
    v_cvt_pk_bf16_f32 v192, v192, v193
    v_mfma_f32_16x16x32_bf16 v[204:207], a[152:155], a[120:123], v[204:207]
    s_waitcnt lgkmcnt(1)
    ds_write_b64 v246, v[156:157] offset:7168
    v_cvt_pk_bf16_f32 v160, v160, v161
    v_cvt_pk_bf16_f32 v161, v162, v163
    v_mul_f32 v164, v164, v241
    v_accvgpr_read_b32 v63, a255
    v_exp_f32 v200, v200
    v_mfma_f32_16x16x32_bf16 v[196:199], a[156:159], a[108:111], v[196:199]
    v_mul_f32 v165, v165, v241
    v_mul_f32 v166, v166, v241
    v_mul_f32 v167, v167, v241
    v_cvt_pk_bf16_f32 v164, v164, v165
    v_add_f32 v242, v242, v194
    v_mfma_f32_16x16x32_bf16 v[204:207], a[156:159], a[124:127], v[204:207]
    ds_write_b64 v246, v[160:161] offset:512
    v_cvt_pk_bf16_f32 v165, v166, v167
    v_mul_f32 v168, v168, v241
    v_exp_f32 v201, v201
    v_add_f32 v242, v242, v195
    v_mfma_f32_16x16x32_bf16 v[32:35], a[160:163], v[216:219], v[32:35]
    ds_read_b128 a[128:131], v224 offset:49152
    v_mul_f32 v169, v169, v241
    v_mul_f32 v170, v170, v241
    v_mul_f32 v171, v171, v241
    v_cvt_pk_bf16_f32 v168, v168, v169
    v_cvt_pk_bf16_f32 v193, v194, v195
    v_mfma_f32_16x16x32_bf16 v[36:39], a[164:167], v[216:219], v[36:39]
    ds_write_b64 v246, v[164:165] offset:1536
    ds_read_b64_tr_b16 a[160:161], v226 offset:40960
    ds_read_b64_tr_b16 a[162:163], v226 offset:43008
    v_cvt_pk_bf16_f32 v169, v170, v171
    v_mul_f32 v172, v172, v241
    v_mul_f32 v173, v173, v241
    v_exp_f32 v202, v202
    v_add_f32 v243, v243, v200
    v_mfma_f32_16x16x32_bf16 v[40:43], a[168:171], v[216:219], v[40:43]
    ds_write_b64 v246, v[168:169] offset:2560
    ds_read_b128 a[132:135], v225 offset:49152
    ds_read_b64_tr_b16 a[164:165], v227 offset:40960
    v_mul_f32 v174, v174, v241
    v_mul_f32 v175, v175, v241
    v_cvt_pk_bf16_f32 v172, v172, v173
    v_exp_f32 v203, v203
    v_mfma_f32_16x16x32_bf16 v[44:47], a[172:175], v[216:219], v[44:47]
    ds_read_b64_tr_b16 a[166:167], v227 offset:43008
    v_cvt_pk_bf16_f32 v173, v174, v175
    v_mul_f32 v176, v176, v241
    v_mul_f32 v177, v177, v241
    v_add_f32 v243, v243, v201
    v_cvt_pk_bf16_f32 v200, v200, v201
    v_mfma_f32_16x16x32_bf16 v[48:51], a[176:179], v[216:219], v[48:51]
    ds_write_b64 v246, v[172:173] offset:3584
    ds_read_b128 a[136:139], v224 offset:53248
    ds_read_b64_tr_b16 a[168:169], v228 offset:40960
    v_mul_f32 v178, v178, v241
    v_mul_f32 v179, v179, v241
    v_cvt_pk_bf16_f32 v176, v176, v177
    v_exp_f32 v196, v196
    v_mfma_f32_16x16x32_bf16 v[52:55], a[180:183], v[216:219], v[52:55]
    ds_read_b64_tr_b16 a[170:171], v228 offset:43008
    v_cvt_pk_bf16_f32 v177, v178, v179
    v_mul_f32 v180, v180, v241
    v_mul_f32 v181, v181, v241
    v_mul_f32 v182, v182, v241
    v_add_f32 v243, v243, v202
    v_mfma_f32_16x16x32_bf16 v[56:59], a[184:187], v[216:219], v[56:59]
    s_waitcnt lgkmcnt(2)
    ds_write_b64 v246, v[176:177] offset:4608
    ds_read_b128 a[140:143], v225 offset:53248
    ds_read_b64_tr_b16 a[172:173], v229 offset:40960
    v_mul_f32 v183, v183, v241
    v_cvt_pk_bf16_f32 v180, v180, v181
    v_cvt_pk_bf16_f32 v181, v182, v183
    v_exp_f32 v197, v197
    v_add_f32 v243, v243, v203
    v_mfma_f32_16x16x32_bf16 v[60:63], a[188:191], v[216:219], v[60:63]
    ds_read_b64_tr_b16 a[174:175], v229 offset:43008
    v_mul_f32 v184, v184, v241
    v_mul_f32 v185, v185, v241
    v_mul_f32 v186, v186, v241
    v_cvt_pk_bf16_f32 v201, v202, v203
    v_mfma_f32_16x16x32_bf16 v[208:211], a[128:131], a[96:99], v[232:235]
    ds_write_b64 v246, v[180:181] offset:5632
    ds_read_b64_tr_b16 a[176:177], v226 offset:45056
    v_mul_f32 v187, v187, v241
    v_cvt_pk_bf16_f32 v184, v184, v185
    v_cvt_pk_bf16_f32 v185, v186, v187
    v_exp_f32 v198, v198
    v_add_f32 v242, v242, v196
    v_mfma_f32_16x16x32_bf16 v[216:219], a[128:131], a[112:115], v[232:235]
    ds_read_b64_tr_b16 a[178:179], v226 offset:47104
    v_mul_f32 v188, v188, v241
    v_mul_f32 v189, v189, v241
    v_mul_f32 v190, v190, v241
    v_mul_f32 v191, v191, v241
    v_exp_f32 v199, v199
    v_mfma_f32_16x16x32_bf16 v[208:211], a[132:135], a[100:103], v[208:211]
    ds_write_b64 v246, v[184:185] offset:6656
    ds_read_b64_tr_b16 a[180:181], v227 offset:45056
    v_cvt_pk_bf16_f32 v188, v188, v189
    v_cvt_pk_bf16_f32 v189, v190, v191
    v_add_f32 v242, v242, v197
    v_cvt_pk_bf16_f32 v194, v196, v197
    v_mfma_f32_16x16x32_bf16 v[216:219], a[132:135], a[116:119], v[216:219]
    ds_write_b64 v246, v[188:189] offset:7680
    ds_read_b64_tr_b16 a[182:183], v227 offset:47104
    v_exp_f32 v204, v204
    v_mfma_f32_16x16x32_bf16 v[208:211], a[136:139], a[104:107], v[208:211]
    ds_read_b128 a[0:3], v247 offset:0
    ds_read_b128 a[8:11], v247 offset:256
    s_waitcnt lgkmcnt(6)
    ds_read_b64_tr_b16 a[184:185], v228 offset:45056
    v_add_f32 v242, v242, v198
    v_mfma_f32_16x16x32_bf16 v[216:219], a[136:139], a[120:123], v[216:219]
    ds_read_b128 a[16:19], v247 offset:512
    ds_read_b128 a[24:27], v247 offset:768
    ds_read_b64_tr_b16 a[186:187], v228 offset:47104
    v_exp_f32 v205, v205
    v_add_f32 v242, v242, v199
    v_mfma_f32_16x16x32_bf16 v[208:211], a[140:143], a[108:111], v[208:211]
    ds_read_b64_tr_b16 a[188:189], v229 offset:45056
    v_xor_b32 v247, 16, v247
    ds_read_b128 a[4:7], v247 offset:128
    v_cvt_pk_bf16_f32 v195, v198, v199
    v_mfma_f32_16x16x32_bf16 v[216:219], a[140:143], a[124:127], v[216:219]
    ds_read_b128 a[12:15], v247 offset:384
    ds_read_b128 a[20:23], v247 offset:640
    ds_read_b64_tr_b16 a[190:191], v229 offset:47104
    v_mfma_f32_16x16x32_bf16 v[0:3], a[160:163], v[192:195], v[0:3]
    s_waitcnt lgkmcnt(6)
    ds_read_b128 a[28:31], v247 offset:896
    ds_read_b128 a[144:147], v224 offset:51200
    v_xor_b32 v247, 16, v247
    v_mfma_f32_16x16x32_bf16 v[4:7], a[164:167], v[192:195], v[4:7]
    ds_read_b128 a[148:151], v225 offset:51200
    ds_read_b128 a[152:155], v224 offset:55296
    v_mfma_f32_16x16x32_bf16 v[8:11], a[168:171], v[192:195], v[8:11]
    ds_read_b128 a[156:159], v225 offset:55296
    v_mfma_f32_16x16x32_bf16 v[12:15], a[172:175], v[192:195], v[12:15]
    v_exp_f32 v206, v206
    v_mfma_f32_16x16x32_bf16 v[16:19], a[176:179], v[192:195], v[16:19]
    v_add_f32 v243, v243, v204
    v_mfma_f32_16x16x32_bf16 v[20:23], a[180:183], v[192:195], v[20:23]
    s_waitcnt lgkmcnt(5)
    s_add_u32 s48, s47, 65536
    v_exp_f32 v207, v207
    v_mfma_f32_16x16x32_bf16 v[24:27], a[184:187], v[192:195], v[24:27]
    v_add_f32 v243, v243, v205
    v_cvt_pk_bf16_f32 v202, v204, v205
    v_mfma_f32_16x16x32_bf16 v[28:31], a[188:191], v[192:195], v[28:31]
    s_waitcnt lgkmcnt(1)
    s_add_u32 s49, s48, 4096
    v_add_f32 v243, v243, v206
    v_add_f32 v243, v243, v207
    v_mfma_f32_16x16x32_bf16 v[212:215], a[144:147], a[96:99], v[232:235]
    v_cvt_pk_bf16_f32 v203, v206, v207
    v_mfma_f32_16x16x32_bf16 v[220:223], a[144:147], a[112:115], v[232:235]
    v_exp_f32 v208, v208
    v_mfma_f32_16x16x32_bf16 v[212:215], a[148:151], a[100:103], v[212:215]
    buffer_store_dwordx4 a[0:3], v248, s[16:19], s48 offen offset:0 nt
    v_mfma_f32_16x16x32_bf16 v[220:223], a[148:151], a[116:119], v[220:223]
    v_exp_f32 v209, v209
    v_mfma_f32_16x16x32_bf16 v[212:215], a[152:155], a[104:107], v[212:215]
    buffer_store_dwordx4 a[8:11], v248, s[16:19], s48 offen offset:2048 nt
    v_mfma_f32_16x16x32_bf16 v[220:223], a[152:155], a[120:123], v[220:223]
    s_waitcnt lgkmcnt(0)
    v_exp_f32 v210, v210
    v_mfma_f32_16x16x32_bf16 v[212:215], a[156:159], a[108:111], v[212:215]
    buffer_store_dwordx4 a[16:19], v248, s[16:19], s49 offen offset:0 nt
    v_mfma_f32_16x16x32_bf16 v[220:223], a[156:159], a[124:127], v[220:223]
    buffer_store_dwordx4 a[24:27], v248, s[16:19], s49 offen offset:2048 nt
    v_add_f32 v242, v242, v208
    v_mfma_f32_16x16x32_bf16 v[32:35], a[160:163], v[200:203], v[32:35]
    ds_read_b64_tr_b16 a[160:161], v226 offset:57344
    ds_read_b64_tr_b16 a[162:163], v226 offset:59392
    v_mfma_f32_16x16x32_bf16 v[36:39], a[164:167], v[200:203], v[36:39]
    ds_read_b64_tr_b16 a[164:165], v227 offset:57344
    ds_read_b64_tr_b16 a[166:167], v227 offset:59392
    v_exp_f32 v211, v211
    v_add_f32 v242, v242, v209
    v_mfma_f32_16x16x32_bf16 v[40:43], a[168:171], v[200:203], v[40:43]
    buffer_store_dwordx4 a[4:7], v248, s[16:19], s48 offen offset:1024 nt
    ds_read_b64_tr_b16 a[168:169], v228 offset:57344
    ds_read_b64_tr_b16 a[170:171], v228 offset:59392
    v_cvt_pk_bf16_f32 v208, v208, v209
    v_mfma_f32_16x16x32_bf16 v[44:47], a[172:175], v[200:203], v[44:47]
    ds_read_b64_tr_b16 a[172:173], v229 offset:57344
    ds_read_b64_tr_b16 a[174:175], v229 offset:59392
    v_exp_f32 v212, v212
    v_add_f32 v242, v242, v210
    v_exp_f32 v213, v213
    v_add_f32 v242, v242, v211
    v_cvt_pk_bf16_f32 v209, v210, v211
    v_exp_f32 v214, v214
    v_add_f32 v242, v242, v212
    v_exp_f32 v215, v215
    v_add_f32 v242, v242, v213
    v_cvt_pk_bf16_f32 v210, v212, v213
    v_exp_f32 v216, v216
    v_add_f32 v242, v242, v214
    v_exp_f32 v217, v217
    v_add_f32 v242, v242, v215
    v_cvt_pk_bf16_f32 v211, v214, v215
    v_exp_f32 v218, v218
    v_add_f32 v243, v243, v216
    v_mfma_f32_16x16x32_bf16 v[48:51], a[176:179], v[200:203], v[48:51]
    buffer_store_dwordx4 a[12:15], v248, s[16:19], s48 offen offset:3072 nt
    ds_read_b64_tr_b16 a[176:177], v226 offset:61440
    ds_read_b64_tr_b16 a[178:179], v226 offset:63488
    v_exp_f32 v219, v219
    v_mfma_f32_16x16x32_bf16 v[52:55], a[180:183], v[200:203], v[52:55]
    ds_read_b64_tr_b16 a[180:181], v227 offset:61440
    ds_read_b64_tr_b16 a[182:183], v227 offset:63488
    v_add_f32 v243, v243, v217
    v_cvt_pk_bf16_f32 v216, v216, v217
    v_mfma_f32_16x16x32_bf16 v[56:59], a[184:187], v[200:203], v[56:59]
    buffer_store_dwordx4 a[20:23], v248, s[16:19], s49 offen offset:1024 nt
    ds_read_b64_tr_b16 a[184:185], v228 offset:61440
    ds_read_b64_tr_b16 a[186:187], v228 offset:63488
    v_exp_f32 v220, v220
    v_mfma_f32_16x16x32_bf16 v[60:63], a[188:191], v[200:203], v[60:63]
    s_waitcnt lgkmcnt(5)
    ds_read_b64_tr_b16 a[188:189], v229 offset:61440
    ds_read_b64_tr_b16 a[190:191], v229 offset:63488
    v_add_f32 v243, v243, v218
    v_mfma_f32_16x16x32_bf16 v[0:3], a[160:163], v[208:211], v[0:3]
    buffer_store_dwordx4 a[28:31], v248, s[16:19], s49 offen offset:3072 nt
    v_exp_f32 v221, v221
    v_add_f32 v243, v243, v219
    v_mfma_f32_16x16x32_bf16 v[4:7], a[164:167], v[208:211], v[4:7]
    v_cvt_pk_bf16_f32 v217, v218, v219
    v_exp_f32 v222, v222
    v_mfma_f32_16x16x32_bf16 v[8:11], a[168:171], v[208:211], v[8:11]
    v_add_f32 v243, v243, v220
    v_exp_f32 v223, v223
    v_mfma_f32_16x16x32_bf16 v[12:15], a[172:175], v[208:211], v[12:15]
    s_waitcnt lgkmcnt(1)
    v_add_f32 v243, v243, v221
    v_cvt_pk_bf16_f32 v218, v220, v221
    v_mfma_f32_16x16x32_bf16 v[16:19], a[176:179], v[208:211], v[16:19]
    v_add_f32 v243, v243, v222
    v_add_f32 v243, v243, v223
    v_mfma_f32_16x16x32_bf16 v[20:23], a[180:183], v[208:211], v[20:23]
    v_cvt_pk_bf16_f32 v219, v222, v223
    v_mfma_f32_16x16x32_bf16 v[24:27], a[184:187], v[208:211], v[24:27]
    s_waitcnt lgkmcnt(0)
    v_mfma_f32_16x16x32_bf16 v[28:31], a[188:191], v[208:211], v[28:31]
    v_mfma_f32_16x16x32_bf16 v[32:35], a[160:163], v[216:219], v[32:35]
    v_mfma_f32_16x16x32_bf16 v[36:39], a[164:167], v[216:219], v[36:39]
    v_mfma_f32_16x16x32_bf16 v[40:43], a[168:171], v[216:219], v[40:43]
    v_mfma_f32_16x16x32_bf16 v[44:47], a[172:175], v[216:219], v[44:47]
    v_mfma_f32_16x16x32_bf16 v[48:51], a[176:179], v[216:219], v[48:51]
    v_mfma_f32_16x16x32_bf16 v[52:55], a[180:183], v[216:219], v[52:55]
    v_mfma_f32_16x16x32_bf16 v[56:59], a[184:187], v[216:219], v[56:59]
    v_mfma_f32_16x16x32_bf16 v[60:63], a[188:191], v[216:219], v[60:63]
    s_mov_b32 s60, 0x4e800000
    s_mov_b32 s61, 0x2b800000
    v_mov_b32 v230, v242
    v_mov_b32 v231, v243
    s_nop 0
    v_permlane32_swap_b32 v230, v242
    v_permlane32_swap_b32 v231, v243
    v_add_f32 v242, v242, v230
    v_add_f32 v243, v243, v231
    v_mov_b32 v230, v242
    v_mov_b32 v231, v243
    s_nop 0
    v_permlane16_swap_b32 v230, v242
    v_permlane16_swap_b32 v231, v243
    v_add_f32 v242, v242, v230
    v_add_f32 v243, v243, v231
    v_min_f32 v230, s60, v242
    v_min_f32 v231, s60, v243
    v_max_f32 v230, s61, v230
    v_max_f32 v231, s61, v231
    v_cmp_neq_f32 s[56:57], v230, v242
    v_cmp_neq_f32 s[58:59], v231, v243
    v_rcp_f32 v242, v242
    v_rcp_f32 v243, v243
    s_or_b32 s24, s24, s56
    s_or_b32 s24, s24, s58
    s_or_b32 s24, s24, s57
    s_or_b32 s24, s24, s59
    s_add_u32 s48, s47, 98304
    s_add_u32 s49, s48, 4096
    v_pk_mul_f32 v[0:1], v[0:1], v[242:243] op_sel:[0,0] op_sel_hi:[1,0]
    v_pk_mul_f32 v[2:3], v[2:3], v[242:243] op_sel:[0,0] op_sel_hi:[1,0]
    v_cvt_pk_bf16_f32 v0, v0, v1
    v_cvt_pk_bf16_f32 v1, v2, v3
    ds_write_b64 v246, v[0:1] offset:0
    v_pk_mul_f32 v[4:5], v[4:5], v[242:243] op_sel:[0,0] op_sel_hi:[1,0]
    v_pk_mul_f32 v[6:7], v[6:7], v[242:243] op_sel:[0,0] op_sel_hi:[1,0]
    v_cvt_pk_bf16_f32 v4, v4, v5
    v_cvt_pk_bf16_f32 v5, v6, v7
    ds_write_b64 v246, v[4:5] offset:1024
    v_pk_mul_f32 v[8:9], v[8:9], v[242:243] op_sel:[0,0] op_sel_hi:[1,0]
    v_pk_mul_f32 v[10:11], v[10:11], v[242:243] op_sel:[0,0] op_sel_hi:[1,0]
    v_cvt_pk_bf16_f32 v8, v8, v9
    v_cvt_pk_bf16_f32 v9, v10, v11
    ds_write_b64 v246, v[8:9] offset:2048
    v_pk_mul_f32 v[12:13], v[12:13], v[242:243] op_sel:[0,0] op_sel_hi:[1,0]
    v_pk_mul_f32 v[14:15], v[14:15], v[242:243] op_sel:[0,0] op_sel_hi:[1,0]
    v_cvt_pk_bf16_f32 v12, v12, v13
    v_cvt_pk_bf16_f32 v13, v14, v15
    ds_write_b64 v246, v[12:13] offset:3072
    v_pk_mul_f32 v[16:17], v[16:17], v[242:243] op_sel:[0,0] op_sel_hi:[1,0]
    v_pk_mul_f32 v[18:19], v[18:19], v[242:243] op_sel:[0,0] op_sel_hi:[1,0]
    v_cvt_pk_bf16_f32 v16, v16, v17
    v_cvt_pk_bf16_f32 v17, v18, v19
    ds_write_b64 v246, v[16:17] offset:4096
    v_pk_mul_f32 v[20:21], v[20:21], v[242:243] op_sel:[0,0] op_sel_hi:[1,0]
    v_pk_mul_f32 v[22:23], v[22:23], v[242:243] op_sel:[0,0] op_sel_hi:[1,0]
    v_cvt_pk_bf16_f32 v20, v20, v21
    v_cvt_pk_bf16_f32 v21, v22, v23
    ds_write_b64 v246, v[20:21] offset:5120
    v_pk_mul_f32 v[24:25], v[24:25], v[242:243] op_sel:[0,0] op_sel_hi:[1,0]
    v_pk_mul_f32 v[26:27], v[26:27], v[242:243] op_sel:[0,0] op_sel_hi:[1,0]
    v_cvt_pk_bf16_f32 v24, v24, v25
    v_cvt_pk_bf16_f32 v25, v26, v27
    ds_write_b64 v246, v[24:25] offset:6144
    v_pk_mul_f32 v[28:29], v[28:29], v[242:243] op_sel:[0,0] op_sel_hi:[1,0]
    v_pk_mul_f32 v[30:31], v[30:31], v[242:243] op_sel:[0,0] op_sel_hi:[1,0]
    v_cvt_pk_bf16_f32 v28, v28, v29
    v_cvt_pk_bf16_f32 v29, v30, v31
    ds_write_b64 v246, v[28:29] offset:7168
    ds_read_b128 v[64:67], v247 offset:0
    ds_read_b128 v[72:75], v247 offset:256
    v_xor_b32 v247, 16, v247
    ds_read_b128 v[68:71], v247 offset:128
    ds_read_b128 v[76:79], v247 offset:384
    v_pk_mul_f32 v[32:33], v[32:33], v[242:243] op_sel:[0,1] op_sel_hi:[1,1]
    v_pk_mul_f32 v[34:35], v[34:35], v[242:243] op_sel:[0,1] op_sel_hi:[1,1]
    v_cvt_pk_bf16_f32 v32, v32, v33
    v_cvt_pk_bf16_f32 v33, v34, v35
    ds_write_b64 v246, v[32:33] offset:512
    v_pk_mul_f32 v[36:37], v[36:37], v[242:243] op_sel:[0,1] op_sel_hi:[1,1]
    v_pk_mul_f32 v[38:39], v[38:39], v[242:243] op_sel:[0,1] op_sel_hi:[1,1]
    v_cvt_pk_bf16_f32 v36, v36, v37
    v_cvt_pk_bf16_f32 v37, v38, v39
    ds_write_b64 v246, v[36:37] offset:1536
    v_pk_mul_f32 v[40:41], v[40:41], v[242:243] op_sel:[0,1] op_sel_hi:[1,1]
    v_pk_mul_f32 v[42:43], v[42:43], v[242:243] op_sel:[0,1] op_sel_hi:[1,1]
    v_cvt_pk_bf16_f32 v40, v40, v41
    s_waitcnt lgkmcnt(2)
    buffer_store_dwordx4 v[64:67], v248, s[16:19], s48 offen offset:0 nt
    buffer_store_dwordx4 v[72:75], v248, s[16:19], s48 offen offset:2048 nt
    buffer_store_dwordx4 v[68:71], v248, s[16:19], s48 offen offset:1024 nt
    buffer_store_dwordx4 v[76:79], v248, s[16:19], s48 offen offset:3072 nt
    v_cvt_pk_bf16_f32 v41, v42, v43
    ds_write_b64 v246, v[40:41] offset:2560
    v_pk_mul_f32 v[44:45], v[44:45], v[242:243] op_sel:[0,1] op_sel_hi:[1,1]
    v_pk_mul_f32 v[46:47], v[46:47], v[242:243] op_sel:[0,1] op_sel_hi:[1,1]
    v_cvt_pk_bf16_f32 v44, v44, v45
    v_cvt_pk_bf16_f32 v45, v46, v47
    ds_write_b64 v246, v[44:45] offset:3584
    v_pk_mul_f32 v[48:49], v[48:49], v[242:243] op_sel:[0,1] op_sel_hi:[1,1]
    v_pk_mul_f32 v[50:51], v[50:51], v[242:243] op_sel:[0,1] op_sel_hi:[1,1]
    v_cvt_pk_bf16_f32 v48, v48, v49
    v_cvt_pk_bf16_f32 v49, v50, v51
    ds_write_b64 v246, v[48:49] offset:4608
    v_pk_mul_f32 v[52:53], v[52:53], v[242:243] op_sel:[0,1] op_sel_hi:[1,1]
    v_pk_mul_f32 v[54:55], v[54:55], v[242:243] op_sel:[0,1] op_sel_hi:[1,1]
    v_cvt_pk_bf16_f32 v52, v52, v53
    v_cvt_pk_bf16_f32 v53, v54, v55
    ds_write_b64 v246, v[52:53] offset:5632
    v_pk_mul_f32 v[56:57], v[56:57], v[242:243] op_sel:[0,1] op_sel_hi:[1,1]
    v_pk_mul_f32 v[58:59], v[58:59], v[242:243] op_sel:[0,1] op_sel_hi:[1,1]
    v_cvt_pk_bf16_f32 v56, v56, v57
    v_cvt_pk_bf16_f32 v57, v58, v59
    ds_write_b64 v246, v[56:57] offset:6656
    v_pk_mul_f32 v[60:61], v[60:61], v[242:243] op_sel:[0,1] op_sel_hi:[1,1]
    v_pk_mul_f32 v[62:63], v[62:63], v[242:243] op_sel:[0,1] op_sel_hi:[1,1]
    v_cvt_pk_bf16_f32 v60, v60, v61
    v_cvt_pk_bf16_f32 v61, v62, v63
    ds_write_b64 v246, v[60:61] offset:7680
    ds_read_b128 v[84:87], v247 offset:640
    ds_read_b128 v[92:95], v247 offset:896
    v_xor_b32 v247, 16, v247
    ds_read_b128 v[80:83], v247 offset:512
    ds_read_b128 v[88:91], v247 offset:768
    s_waitcnt lgkmcnt(3)
    buffer_store_dwordx4 v[84:87], v248, s[16:19], s49 offen offset:1024 nt
    s_waitcnt lgkmcnt(2)
    buffer_store_dwordx4 v[92:95], v248, s[16:19], s49 offen offset:3072 nt
    s_waitcnt lgkmcnt(1)
    buffer_store_dwordx4 v[80:83], v248, s[16:19], s49 offen offset:0 nt
    s_waitcnt lgkmcnt(0)
    buffer_store_dwordx4 v[88:91], v248, s[16:19], s49 offen offset:2048 nt
    s_cmp_eq_u32 s24, 0
    s_cbranch_scc1 L_end
    s_waitcnt vmcnt(0) lgkmcnt(0)
    v_mbcnt_lo_u32_b32 v99, -1, 0
    v_mbcnt_hi_u32_b32 v99, -1, v99
    v_and_b32 v100, 15, v99
    v_lshlrev_b32 v100, 8, v100
    v_lshrrev_b32 v101, 4, v99
    v_lshl_add_u32 v100, v101, 5, v100
    v_lshlrev_b32 v103, 1, v101
    v_and_b32 v102, 7, v99
    v_xor_b32 v102, v102, v103
    v_lshlrev_b32 v102, 4, v102
    v_lshrrev_b32 v103, 3, v99
    v_lshl_add_u32 v102, v103, 8, v102
    v_xor_b32 v103, 16, v102
    v_add_u32 v101, 0x1000, v100
    s_sub_u32 s43, s25, 0
    v_add_u32 v104, s43, v226
    v_add_u32 v105, s43, v227
    v_add_u32 v106, s43, v228
    v_add_u32 v107, s43, v229
    s_lshl_b32 s42, s20, 13
    s_mov_b32 s40, 0
    s_waitcnt vmcnt(0) lgkmcnt(0)
    s_nop 15
L_fb_t:
    buffer_load_dwordx4 a[0:3], v100, s[4:7], s42 offen offset:0
    buffer_load_dwordx4 a[4:7], v100, s[4:7], s42 offen offset:16
    buffer_load_dwordx4 a[8:11], v100, s[4:7], s42 offen offset:128
    buffer_load_dwordx4 a[12:15], v100, s[4:7], s42 offen offset:144
    buffer_load_dwordx4 a[16:19], v101, s[4:7], s42 offen offset:0
    buffer_load_dwordx4 a[20:23], v101, s[4:7], s42 offen offset:16
    buffer_load_dwordx4 a[24:27], v101, s[4:7], s42 offen offset:128
    buffer_load_dwordx4 a[28:31], v101, s[4:7], s42 offen offset:144
    v_mov_b32 v110, 0xff800000
    v_mov_b32 v111, 0xff800000
    s_mov_b32 s41, 0
    s_waitcnt vmcnt(0) lgkmcnt(0)
    s_nop 15
L_fb_p1:
    buffer_load_dwordx4 v[64:67], v100, s[8:11], s41 offen offset:0
    buffer_load_dwordx4 v[68:71], v100, s[8:11], s41 offen offset:16
    buffer_load_dwordx4 v[72:75], v100, s[8:11], s41 offen offset:128
    buffer_load_dwordx4 v[76:79], v100, s[8:11], s41 offen offset:144
    buffer_load_dwordx4 v[80:83], v101, s[8:11], s41 offen offset:0
    buffer_load_dwordx4 v[84:87], v101, s[8:11], s41 offen offset:16
    buffer_load_dwordx4 v[88:91], v101, s[8:11], s41 offen offset:128
    buffer_load_dwordx4 v[92:95], v101, s[8:11], s41 offen offset:144
    s_waitcnt vmcnt(7)
    v_mfma_f32_16x16x32_bf16 v[192:195], v[64:67], a[0:3], 0
    v_mfma_f32_16x16x32_bf16 v[200:203], v[64:67], a[16:19], 0
    s_waitcnt vmcnt(6)
    v_mfma_f32_16x16x32_bf16 v[192:195], v[68:71], a[4:7], v[192:195]
    v_mfma_f32_16x16x32_bf16 v[200:203], v[68:71], a[20:23], v[200:203]
    s_waitcnt vmcnt(5)
    v_mfma_f32_16x16x32_bf16 v[192:195], v[72:75], a[8:11], v[192:195]
    v_mfma_f32_16x16x32_bf16 v[200:203], v[72:75], a[24:27], v[200:203]
    s_waitcnt vmcnt(4)
    v_mfma_f32_16x16x32_bf16 v[192:195], v[76:79], a[12:15], v[192:195]
    v_mfma_f32_16x16x32_bf16 v[200:203], v[76:79], a[28:31], v[200:203]
    s_waitcnt vmcnt(3)
    v_mfma_f32_16x16x32_bf16 v[196:199], v[80:83], a[0:3], 0
    v_mfma_f32_16x16x32_bf16 v[204:207], v[80:83], a[16:19], 0
    s_waitcnt vmcnt(2)
    v_mfma_f32_16x16x32_bf16 v[196:199], v[84:87], a[4:7], v[196:199]
    v_mfma_f32_16x16x32_bf16 v[204:207], v[84:87], a[20:23], v[204:207]
    s_waitcnt vmcnt(1)
    v_mfma_f32_16x16x32_bf16 v[196:199], v[88:91], a[8:11], v[196:199]
    v_mfma_f32_16x16x32_bf16 v[204:207], v[88:91], a[24:27], v[204:207]
    s_waitcnt vmcnt(0)
    v_mfma_f32_16x16x32_bf16 v[196:199], v[92:95], a[12:15], v[196:199]
    v_mfma_f32_16x16x32_bf16 v[204:207], v[92:95], a[28:31], v[204:207]
    v_max3_f32 v110, v110, v192, v193
    v_max3_f32 v110, v110, v194, v195
    s_nop 4
    v_max3_f32 v110, v110, v196, v197
    v_max3_f32 v110, v110, v198, v199
    v_max3_f32 v111, v111, v200, v201
    v_max3_f32 v111, v111, v202, v203
    v_max3_f32 v111, v111, v204, v205
    v_max3_f32 v111, v111, v206, v207
    s_add_u32 s41, s41, 8192
    s_waitcnt vmcnt(0) lgkmcnt(0)
    s_nop 15
    s_cmp_lt_u32 s41, 131072
    s_cbranch_scc1 L_fb_p1
    v_mov_b32 v108, v110
    s_nop 1
    v_permlane32_swap_b32 v108, v110
    v_max_f32 v110, v110, v108
    v_mov_b32 v108, v110
    s_nop 1
    v_permlane16_swap_b32 v108, v110
    v_max_f32 v110, v110, v108
    v_mul_f32 v110, s22, v110
    v_mov_b32 v108, v111
    s_nop 1
    v_permlane32_swap_b32 v108, v111
    v_max_f32 v111, v111, v108
    v_mov_b32 v108, v111
    s_nop 1
    v_permlane16_swap_b32 v108, v111
    v_max_f32 v111, v111, v108
    v_mul_f32 v111, s22, v111
    v_mov_b32 v108, 0
    v_mov_b32 v109, 0
    v_mov_b32 v0, 0
    v_mov_b32 v1, 0
    v_mov_b32 v2, 0
    v_mov_b32 v3, 0
    v_mov_b32 v4, 0
    v_mov_b32 v5, 0
    v_mov_b32 v6, 0
    v_mov_b32 v7, 0
    v_mov_b32 v8, 0
    v_mov_b32 v9, 0
    v_mov_b32 v10, 0
    v_mov_b32 v11, 0
    v_mov_b32 v12, 0
    v_mov_b32 v13, 0
    v_mov_b32 v14, 0
    v_mov_b32 v15, 0
    v_mov_b32 v16, 0
    v_mov_b32 v17, 0
    v_mov_b32 v18, 0
    v_mov_b32 v19, 0
    v_mov_b32 v20, 0
    v_mov_b32 v21, 0
    v_mov_b32 v22, 0
    v_mov_b32 v23, 0
    v_mov_b32 v24, 0
    v_mov_b32 v25, 0
    v_mov_b32 v26, 0
    v_mov_b32 v27, 0
    v_mov_b32 v28, 0
    v_mov_b32 v29, 0
    v_mov_b32 v30, 0
    v_mov_b32 v31, 0
    v_mov_b32 v32, 0
    v_mov_b32 v33, 0
    v_mov_b32 v34, 0
    v_mov_b32 v35, 0
    v_mov_b32 v36, 0
    v_mov_b32 v37, 0
    v_mov_b32 v38, 0
    v_mov_b32 v39, 0
    v_mov_b32 v40, 0
    v_mov_b32 v41, 0
    v_mov_b32 v42, 0
    v_mov_b32 v43, 0
    v_mov_b32 v44, 0
    v_mov_b32 v45, 0
    v_mov_b32 v46, 0
    v_mov_b32 v47, 0
    v_mov_b32 v48, 0
    v_mov_b32 v49, 0
    v_mov_b32 v50, 0
    v_mov_b32 v51, 0
    v_mov_b32 v52, 0
    v_mov_b32 v53, 0
    v_mov_b32 v54, 0
    v_mov_b32 v55, 0
    v_mov_b32 v56, 0
    v_mov_b32 v57, 0
    v_mov_b32 v58, 0
    v_mov_b32 v59, 0
    v_mov_b32 v60, 0
    v_mov_b32 v61, 0
    v_mov_b32 v62, 0
    v_mov_b32 v63, 0
    s_mov_b32 s41, 0
    s_waitcnt vmcnt(0) lgkmcnt(0)
    s_nop 15
L_fb_p2:
    buffer_load_dwordx4 v[64:67], v100, s[8:11], s41 offen offset:0
    buffer_load_dwordx4 v[68:71], v100, s[8:11], s41 offen offset:16
    buffer_load_dwordx4 v[72:75], v100, s[8:11], s41 offen offset:128
    buffer_load_dwordx4 v[76:79], v100, s[8:11], s41 offen offset:144
    buffer_load_dwordx4 v[80:83], v101, s[8:11], s41 offen offset:0
    buffer_load_dwordx4 v[84:87], v101, s[8:11], s41 offen offset:16
    buffer_load_dwordx4 v[88:91], v101, s[8:11], s41 offen offset:128
    buffer_load_dwordx4 v[92:95], v101, s[8:11], s41 offen offset:144
    s_add_u32 s43, s41, 0
    s_add_u32 m0, s25, 0
    s_nop 0
    buffer_load_dwordx4 v102, s[12:15], s43 offen offset:0 lds
    s_add_u32 m0, s25, 3968
    s_nop 0
    buffer_load_dwordx4 v102, s[12:15], s43 offen offset:128 lds
    s_add_u32 s43, s41, 2048
    s_add_u32 m0, s25, 1024
    s_nop 0
    buffer_load_dwordx4 v103, s[12:15], s43 offen offset:0 lds
    s_add_u32 m0, s25, 4992
    s_nop 0
    buffer_load_dwordx4 v103, s[12:15], s43 offen offset:128 lds
    s_add_u32 s43, s41, 4096
    s_add_u32 m0, s25, 2048
    s_nop 0
    buffer_load_dwordx4 v102, s[12:15], s43 offen offset:0 lds
    s_add_u32 m0, s25, 6016
    s_nop 0
    buffer_load_dwordx4 v102, s[12:15], s43 offen offset:128 lds
    s_add_u32 s43, s41, 6144
    s_add_u32 m0, s25, 3072
    s_nop 0
    buffer_load_dwordx4 v103, s[12:15], s43 offen offset:0 lds
    s_add_u32 m0, s25, 7040
    s_nop 0
    buffer_load_dwordx4 v103, s[12:15], s43 offen offset:128 lds
    s_waitcnt vmcnt(15)
    v_mfma_f32_16x16x32_bf16 v[192:195], v[64:67], a[0:3], 0
    v_mfma_f32_16x16x32_bf16 v[200:203], v[64:67], a[16:19], 0
    s_waitcnt vmcnt(14)
    v_mfma_f32_16x16x32_bf16 v[192:195], v[68:71], a[4:7], v[192:195]
    v_mfma_f32_16x16x32_bf16 v[200:203], v[68:71], a[20:23], v[200:203]
    s_waitcnt vmcnt(13)
    v_mfma_f32_16x16x32_bf16 v[192:195], v[72:75], a[8:11], v[192:195]
    v_mfma_f32_16x16x32_bf16 v[200:203], v[72:75], a[24:27], v[200:203]
    s_waitcnt vmcnt(12)
    v_mfma_f32_16x16x32_bf16 v[192:195], v[76:79], a[12:15], v[192:195]
    v_mfma_f32_16x16x32_bf16 v[200:203], v[76:79], a[28:31], v[200:203]
    s_waitcnt vmcnt(11)
    v_mfma_f32_16x16x32_bf16 v[196:199], v[80:83], a[0:3], 0
    v_mfma_f32_16x16x32_bf16 v[204:207], v[80:83], a[16:19], 0
    s_waitcnt vmcnt(10)
    v_mfma_f32_16x16x32_bf16 v[196:199], v[84:87], a[4:7], v[196:199]
    v_mfma_f32_16x16x32_bf16 v[204:207], v[84:87], a[20:23], v[204:207]
    s_waitcnt vmcnt(9)
    v_mfma_f32_16x16x32_bf16 v[196:199], v[88:91], a[8:11], v[196:199]
    v_mfma_f32_16x16x32_bf16 v[204:207], v[88:91], a[24:27], v[204:207]
    s_waitcnt vmcnt(8)
    v_mfma_f32_16x16x32_bf16 v[196:199], v[92:95], a[12:15], v[196:199]
    v_mfma_f32_16x16x32_bf16 v[204:207], v[92:95], a[28:31], v[204:207]
    s_waitcnt vmcnt(0)
    ds_read_b64_tr_b16 a[96:97], v104 offset:0
    ds_read_b64_tr_b16 a[98:99], v104 offset:2048
    ds_read_b64_tr_b16 a[100:101], v105 offset:0
    ds_read_b64_tr_b16 a[102:103], v105 offset:2048
    ds_read_b64_tr_b16 a[104:105], v106 offset:0
    ds_read_b64_tr_b16 a[106:107], v106 offset:2048
    ds_read_b64_tr_b16 a[108:109], v107 offset:0
    ds_read_b64_tr_b16 a[110:111], v107 offset:2048
    ds_read_b64_tr_b16 a[112:113], v104 offset:4096
    ds_read_b64_tr_b16 a[114:115], v104 offset:6144
    ds_read_b64_tr_b16 a[116:117], v105 offset:4096
    ds_read_b64_tr_b16 a[118:119], v105 offset:6144
    ds_read_b64_tr_b16 a[120:121], v106 offset:4096
    ds_read_b64_tr_b16 a[122:123], v106 offset:6144
    ds_read_b64_tr_b16 a[124:125], v107 offset:4096
    s_waitcnt lgkmcnt(9)
    ds_read_b64_tr_b16 a[126:127], v107 offset:6144
    v_fma_f32 v192, v192, s22, -v110
    v_fma_f32 v193, v193, s22, -v110
    v_fma_f32 v194, v194, s22, -v110
    v_fma_f32 v195, v195, s22, -v110
    v_fma_f32 v196, v196, s22, -v110
    v_fma_f32 v197, v197, s22, -v110
    v_fma_f32 v198, v198, s22, -v110
    v_fma_f32 v199, v199, s22, -v110
    v_fma_f32 v200, v200, s22, -v111
    v_fma_f32 v201, v201, s22, -v111
    v_fma_f32 v202, v202, s22, -v111
    v_fma_f32 v203, v203, s22, -v111
    v_fma_f32 v204, v204, s22, -v111
    v_fma_f32 v205, v205, s22, -v111
    v_fma_f32 v206, v206, s22, -v111
    v_fma_f32 v207, v207, s22, -v111
    v_exp_f32 v192, v192
    v_exp_f32 v193, v193
    v_exp_f32 v194, v194
    v_exp_f32 v195, v195
    v_exp_f32 v196, v196
    v_exp_f32 v197, v197
    v_exp_f32 v198, v198
    v_exp_f32 v199, v199
    v_exp_f32 v200, v200
    v_exp_f32 v201, v201
    v_exp_f32 v202, v202
    v_exp_f32 v203, v203
    v_exp_f32 v204, v204
    v_exp_f32 v205, v205
    v_exp_f32 v206, v206
    v_exp_f32 v207, v207
    v_add_f32 v108, v108, v192
    v_add_f32 v108, v108, v193
    v_add_f32 v108, v108, v194
    v_add_f32 v108, v108, v195
    v_add_f32 v108, v108, v196
    v_add_f32 v108, v108, v197
    v_add_f32 v108, v108, v198
    v_add_f32 v108, v108, v199
    v_add_f32 v109, v109, v200
    v_add_f32 v109, v109, v201
    v_add_f32 v109, v109, v202
    v_add_f32 v109, v109, v203
    v_add_f32 v109, v109, v204
    v_add_f32 v109, v109, v205
    v_add_f32 v109, v109, v206
    v_add_f32 v109, v109, v207
    v_cvt_pk_bf16_f32 v192, v192, v193
    v_cvt_pk_bf16_f32 v193, v194, v195
    v_cvt_pk_bf16_f32 v194, v196, v197
    v_cvt_pk_bf16_f32 v195, v198, v199
    v_cvt_pk_bf16_f32 v200, v200, v201
    v_cvt_pk_bf16_f32 v201, v202, v203
    v_cvt_pk_bf16_f32 v202, v204, v205
    v_cvt_pk_bf16_f32 v203, v206, v207
    v_mfma_f32_16x16x32_bf16 v[0:3], a[96:99], v[192:195], v[0:3]
    v_mfma_f32_16x16x32_bf16 v[4:7], a[100:103], v[192:195], v[4:7]
    v_mfma_f32_16x16x32_bf16 v[8:11], a[104:107], v[192:195], v[8:11]
    s_waitcnt lgkmcnt(0)
    v_mfma_f32_16x16x32_bf16 v[12:15], a[108:111], v[192:195], v[12:15]
    v_mfma_f32_16x16x32_bf16 v[16:19], a[112:115], v[192:195], v[16:19]
    v_mfma_f32_16x16x32_bf16 v[20:23], a[116:119], v[192:195], v[20:23]
    v_mfma_f32_16x16x32_bf16 v[24:27], a[120:123], v[192:195], v[24:27]
    v_mfma_f32_16x16x32_bf16 v[28:31], a[124:127], v[192:195], v[28:31]
    v_mfma_f32_16x16x32_bf16 v[32:35], a[96:99], v[200:203], v[32:35]
    v_mfma_f32_16x16x32_bf16 v[36:39], a[100:103], v[200:203], v[36:39]
    v_mfma_f32_16x16x32_bf16 v[40:43], a[104:107], v[200:203], v[40:43]
    v_mfma_f32_16x16x32_bf16 v[44:47], a[108:111], v[200:203], v[44:47]
    v_mfma_f32_16x16x32_bf16 v[48:51], a[112:115], v[200:203], v[48:51]
    v_mfma_f32_16x16x32_bf16 v[52:55], a[116:119], v[200:203], v[52:55]
    v_mfma_f32_16x16x32_bf16 v[56:59], a[120:123], v[200:203], v[56:59]
    v_mfma_f32_16x16x32_bf16 v[60:63], a[124:127], v[200:203], v[60:63]
    s_add_u32 s41, s41, 8192
    s_waitcnt vmcnt(0) lgkmcnt(0)
    s_nop 15
    s_cmp_lt_u32 s41, 131072
    s_cbranch_scc1 L_fb_p2
    s_mov_b32 s60, 0x4e800000
    s_mov_b32 s61, 0x2b800000
    v_mov_b32 v110, v108
    v_mov_b32 v111, v109
    s_nop 0
    v_permlane32_swap_b32 v110, v108
    v_permlane32_swap_b32 v111, v109
    v_add_f32 v108, v108, v110
    v_add_f32 v109, v109, v111
    v_mov_b32 v110, v108
    v_mov_b32 v111, v109
    s_nop 0
    v_permlane16_swap_b32 v110, v108
    v_permlane16_swap_b32 v111, v109
    v_add_f32 v108, v108, v110
    v_add_f32 v109, v109, v111
    v_min_f32 v110, s60, v108
    v_min_f32 v111, s60, v109
    v_max_f32 v110, s61, v110
    v_max_f32 v111, s61, v111
    v_cmp_neq_f32 s[56:57], v110, v108
    v_cmp_neq_f32 s[58:59], v111, v109
    v_rcp_f32 v108, v108
    v_rcp_f32 v109, v109
    s_or_b32 s24, s24, s56
    s_or_b32 s24, s24, s58
    s_or_b32 s24, s24, s57
    s_or_b32 s24, s24, s59
    v_mul_f32 v0, v0, v108
    v_mul_f32 v1, v1, v108
    v_mul_f32 v2, v2, v108
    v_mul_f32 v3, v3, v108
    v_cvt_pk_bf16_f32 v0, v0, v1
    v_cvt_pk_bf16_f32 v1, v2, v3
    ds_write_b64 v246, v[0:1] offset:0
    v_mul_f32 v4, v4, v108
    v_mul_f32 v5, v5, v108
    v_mul_f32 v6, v6, v108
    v_mul_f32 v7, v7, v108
    v_cvt_pk_bf16_f32 v4, v4, v5
    v_cvt_pk_bf16_f32 v5, v6, v7
    ds_write_b64 v246, v[4:5] offset:1024
    v_mul_f32 v8, v8, v108
    v_mul_f32 v9, v9, v108
    v_mul_f32 v10, v10, v108
    v_mul_f32 v11, v11, v108
    v_cvt_pk_bf16_f32 v8, v8, v9
    v_cvt_pk_bf16_f32 v9, v10, v11
    ds_write_b64 v246, v[8:9] offset:2048
    v_mul_f32 v12, v12, v108
    v_mul_f32 v13, v13, v108
    v_mul_f32 v14, v14, v108
    v_mul_f32 v15, v15, v108
    v_cvt_pk_bf16_f32 v12, v12, v13
    v_cvt_pk_bf16_f32 v13, v14, v15
    ds_write_b64 v246, v[12:13] offset:3072
    v_mul_f32 v16, v16, v108
    v_mul_f32 v17, v17, v108
    v_mul_f32 v18, v18, v108
    v_mul_f32 v19, v19, v108
    v_cvt_pk_bf16_f32 v16, v16, v17
    v_cvt_pk_bf16_f32 v17, v18, v19
    ds_write_b64 v246, v[16:17] offset:4096
    v_mul_f32 v20, v20, v108
    v_mul_f32 v21, v21, v108
    v_mul_f32 v22, v22, v108
    v_mul_f32 v23, v23, v108
    v_cvt_pk_bf16_f32 v20, v20, v21
    v_cvt_pk_bf16_f32 v21, v22, v23
    ds_write_b64 v246, v[20:21] offset:5120
    v_mul_f32 v24, v24, v108
    v_mul_f32 v25, v25, v108
    v_mul_f32 v26, v26, v108
    v_mul_f32 v27, v27, v108
    v_cvt_pk_bf16_f32 v24, v24, v25
    v_cvt_pk_bf16_f32 v25, v26, v27
    ds_write_b64 v246, v[24:25] offset:6144
    v_mul_f32 v28, v28, v108
    v_mul_f32 v29, v29, v108
    v_mul_f32 v30, v30, v108
    v_mul_f32 v31, v31, v108
    v_cvt_pk_bf16_f32 v28, v28, v29
    v_cvt_pk_bf16_f32 v29, v30, v31
    ds_write_b64 v246, v[28:29] offset:7168
    v_mul_f32 v32, v32, v109
    v_mul_f32 v33, v33, v109
    v_mul_f32 v34, v34, v109
    v_mul_f32 v35, v35, v109
    v_cvt_pk_bf16_f32 v32, v32, v33
    v_cvt_pk_bf16_f32 v33, v34, v35
    ds_write_b64 v246, v[32:33] offset:512
    v_mul_f32 v36, v36, v109
    v_mul_f32 v37, v37, v109
    v_mul_f32 v38, v38, v109
    v_mul_f32 v39, v39, v109
    v_cvt_pk_bf16_f32 v36, v36, v37
    v_cvt_pk_bf16_f32 v37, v38, v39
    ds_write_b64 v246, v[36:37] offset:1536
    v_mul_f32 v40, v40, v109
    v_mul_f32 v41, v41, v109
    v_mul_f32 v42, v42, v109
    v_mul_f32 v43, v43, v109
    v_cvt_pk_bf16_f32 v40, v40, v41
    v_cvt_pk_bf16_f32 v41, v42, v43
    ds_write_b64 v246, v[40:41] offset:2560
    v_mul_f32 v44, v44, v109
    v_mul_f32 v45, v45, v109
    v_mul_f32 v46, v46, v109
    v_mul_f32 v47, v47, v109
    v_cvt_pk_bf16_f32 v44, v44, v45
    v_cvt_pk_bf16_f32 v45, v46, v47
    ds_write_b64 v246, v[44:45] offset:3584
    v_mul_f32 v48, v48, v109
    v_mul_f32 v49, v49, v109
    v_mul_f32 v50, v50, v109
    v_mul_f32 v51, v51, v109
    v_cvt_pk_bf16_f32 v48, v48, v49
    v_cvt_pk_bf16_f32 v49, v50, v51
    ds_write_b64 v246, v[48:49] offset:4608
    v_mul_f32 v52, v52, v109
    v_mul_f32 v53, v53, v109
    v_mul_f32 v54, v54, v109
    v_mul_f32 v55, v55, v109
    v_cvt_pk_bf16_f32 v52, v52, v53
    v_cvt_pk_bf16_f32 v53, v54, v55
    ds_write_b64 v246, v[52:53] offset:5632
    v_mul_f32 v56, v56, v109
    v_mul_f32 v57, v57, v109
    v_mul_f32 v58, v58, v109
    v_mul_f32 v59, v59, v109
    v_cvt_pk_bf16_f32 v56, v56, v57
    v_cvt_pk_bf16_f32 v57, v58, v59
    ds_write_b64 v246, v[56:57] offset:6656
    v_mul_f32 v60, v60, v109
    v_mul_f32 v61, v61, v109
    v_mul_f32 v62, v62, v109
    v_mul_f32 v63, v63, v109
    v_cvt_pk_bf16_f32 v60, v60, v61
    v_cvt_pk_bf16_f32 v61, v62, v63
    s_waitcnt lgkmcnt(1)
    ds_write_b64 v246, v[60:61] offset:7680
    ds_read_b128 v[64:67], v247 offset:0
    ds_read_b128 v[72:75], v247 offset:256
    ds_read_b128 v[80:83], v247 offset:512
    ds_read_b128 v[88:91], v247 offset:768
    v_xor_b32 v247, 16, v247
    ds_read_b128 v[68:71], v247 offset:128
    ds_read_b128 v[76:79], v247 offset:384
    ds_read_b128 v[84:87], v247 offset:640
    ds_read_b128 v[92:95], v247 offset:896
    v_xor_b32 v247, 16, v247
    s_mov_b32 s48, s42
    s_add_u32 s49, s48, 4096
    s_waitcnt lgkmcnt(5)
    buffer_store_dwordx4 v[64:67], v248, s[16:19], s48 offen offset:0 nt
    buffer_store_dwordx4 v[72:75], v248, s[16:19], s48 offen offset:2048 nt
    buffer_store_dwordx4 v[80:83], v248, s[16:19], s49 offen offset:0 nt
    s_waitcnt lgkmcnt(2)
    buffer_store_dwordx4 v[88:91], v248, s[16:19], s49 offen offset:2048 nt
    buffer_store_dwordx4 v[68:71], v248, s[16:19], s48 offen offset:1024 nt
    buffer_store_dwordx4 v[76:79], v248, s[16:19], s48 offen offset:3072 nt
    s_waitcnt lgkmcnt(0)
    buffer_store_dwordx4 v[84:87], v248, s[16:19], s49 offen offset:1024 nt
    buffer_store_dwordx4 v[92:95], v248, s[16:19], s49 offen offset:3072 nt
    s_add_u32 s42, s42, 32768
    s_add_u32 s40, s40, 1
    s_waitcnt vmcnt(0) lgkmcnt(0)
    s_nop 15
    s_cmp_lt_u32 s40, 4
    s_cbranch_scc1 L_fb_t
L_end:
    s_endpgm
.section .rodata,"a"
.p2align 6
.amdhsa_kernel standalone__mha_softmax__near_ridge_kernel
  .amdhsa_next_free_vgpr 512
  .amdhsa_next_free_sgpr 102
  .amdhsa_accum_offset 256
  .amdhsa_group_segment_fixed_size 0
  .amdhsa_kernarg_size 48
  .amdhsa_user_sgpr_count 2
  .amdhsa_user_sgpr_kernarg_segment_ptr 1
  .amdhsa_system_sgpr_workgroup_id_x 1
.end_amdhsa_kernel
```
